```python
import torch

def _softmax(x, axis=-1):
    return torch.softmax(x, dim=axis)

def _gelu(x):
    return torch.nn.functional.gelu(x, approximate='tanh')

def _silu(x):
    return torch.nn.functional.silu(x)

def _sigmoid(x):
    return torch.sigmoid(x)

def _layernorm(x, axis=-1, eps=1e-05):
    m = x.mean(dim=axis, keepdim=True)
    v = x.var(dim=axis, keepdim=True, unbiased=False)
    return (x - m) / torch.sqrt(v + eps)

def _scatter_add(tgt, idx, src, axis=0):
    return tgt.clone().index_add_(axis, idx, src)

def _segment_sum(src, seg, n):
    out = torch.zeros((n,) + src.shape[1:], dtype=src.dtype)
    return out.index_add_(0, seg, src)

def _pad(x, pw):
    flat = tuple((v for pair in reversed(pw) for v in pair))
    return torch.nn.functional.pad(x, flat)
kernel_name = 'gated_mix__memory_aug_recurrent_mem_tr__glu_gated_swiglu__prompt'

def setup_inputs():

    _w = lambda a: (lambda t: t.to(torch.bfloat16) if t.is_floating_point() else t)(torch.as_tensor(a))

    def _A_setup():
        B, S, Dm = (1, 2048, 640)
        H, Dh = (32, 128)
        M, seg = (8, 32)
        seg = min(seg, S)
        S = S // seg * seg
        return {'x': _w((lambda *s: torch.randn(*s, dtype=torch.bfloat16) * 0.05)(B, S, Dm)), 'mem0': _w((lambda *s: torch.randn(*s, dtype=torch.bfloat16) * 0.8)(B, M, Dm)), 'Wq': _w((lambda *s: torch.randn(*s, dtype=torch.bfloat16) * 1.6)(Dm, H, Dh) * Dm ** (-0.5)), 'Wk': _w((lambda *s: torch.randn(*s, dtype=torch.bfloat16) * 1.6)(Dm, H, Dh) * Dm ** (-0.5)), 'Wv': _w((lambda *s: torch.randn(*s, dtype=torch.bfloat16) * 0.8)(Dm, H, Dh) * Dm ** (-0.5)), 'Wo': _w((lambda *s: torch.randn(*s, dtype=torch.bfloat16) * 0.8)(H, Dh, Dm) * (H * Dh) ** (-0.5)), 'seg_len': seg}
    _A_in = _A_setup()

    def _B_setup():
        B, S, D, F = (1, 2048, 640, 1728)
        return {'x': _w((lambda *s: torch.randn(*s, dtype=torch.bfloat16) * 0.05)(B, S, D)), 'w1': _w((lambda *s: torch.randn(*s, dtype=torch.bfloat16) * 3.2)(D, F) * (2.0 / D) ** 0.5), 'w3': _w((lambda *s: torch.randn(*s, dtype=torch.bfloat16) * 3.2)(D, F) * (2.0 / D) ** 0.5), 'w2': _w((lambda *s: torch.randn(*s, dtype=torch.bfloat16) * 3.2)(F, D) * (2.0 / F) ** 0.5)}
    _B_in = _B_setup()
    return {'A_x': _A_in['x'], 'A_mem0': _A_in['mem0'], 'A_Wq': _A_in['Wq'], 'A_Wk': _A_in['Wk'], 'A_Wv': _A_in['Wv'], 'A_Wo': _A_in['Wo'], 'A_seg_len': _A_in['seg_len'], 'B_x': _B_in['x'], 'B_w1': _B_in['w1'], 'B_w3': _B_in['w3'], 'B_w2': _B_in['w2'], 'gate_w': _w((lambda *s: torch.randn(*s, dtype=torch.bfloat16) * 0.05)(640) * 16.0)}

def reference(A_x, A_mem0, A_Wq, A_Wk, A_Wv, A_Wo, A_seg_len, B_x, B_w1, B_w3, B_w2, gate_w):

    def _A_ref(x, mem0, Wq, Wk, Wv, Wo, seg_len):
        B, S, Dm = x.shape
        H, Dh = (Wq.shape[1], Wq.shape[2])
        M = mem0.shape[1]
        scale = Dh ** (-0.5)
        n_seg = S // seg_len
        L = M + seg_len
        idx = torch.arange(L)
        mask = (idx[:, None] < M) | (idx[:, None] >= idx[None, :])
        mem = mem0
        outs = []
        for s in range(n_seg):
            xs = x[:, s * seg_len:(s + 1) * seg_len, :].clone()
            h = torch.concatenate([mem, xs], axis=1)
            q = torch.einsum('btd,dhe->bhte', h, Wq)
            k = torch.einsum('btd,dhe->bhte', h, Wk)
            v = torch.einsum('btd,dhe->bhte', h, Wv)
            scores = torch.einsum('bhqe,bhke->bhqk', q, k) * scale
            scores = torch.where(mask[None, None], scores, -1000000000.0)
            p = _softmax(scores, axis=-1)
            o = torch.einsum('bhqk,bhke->bhqe', p, v)
            o = torch.einsum('bhte,hed->btd', o, Wo)
            mem = o[:, :M, :].clone()
            outs.append(o[:, M:, :])
        return torch.concatenate(outs, axis=1)

    def _B_ref(x, w1, w3, w2):
        gate = torch.einsum('bsd,df->bsf', x, w1)
        up = torch.einsum('bsd,df->bsf', x, w3)
        h = _silu(gate) * up
        out = torch.einsum('bsf,fd->bsd', h, w2)
        return out
    x = A_x
    g = _sigmoid((x * gate_w).sum(-1, keepdims=True))
    a = _A_ref(x, A_mem0, A_Wq, A_Wk, A_Wv, A_Wo, A_seg_len)
    b = _B_ref(x, B_w1, B_w3, B_w2)
    return g * a + (1 - g) * b
```

```asm
; @launch grid=(256,1,1) block=(256,1,1) lds=163840
.amdgcn_target "amdgcn-amd-amdhsa--gfx950"
.text
.globl gated_mix__memory_aug_recurrent_mem_tr__glu_gated_swiglu__prompt_kernel
.p2align 8
.type gated_mix__memory_aug_recurrent_mem_tr__glu_gated_swiglu__prompt_kernel,@function
gated_mix__memory_aug_recurrent_mem_tr__glu_gated_swiglu__prompt_kernel:
    s_load_dwordx2 s[4:5], s[0:1], 104
    s_load_dwordx2 s[6:7], s[0:1], 112
    s_cmp_ge_u32 s2, 256
    s_cbranch_scc1 LC_end
    s_waitcnt lgkmcnt(0)
    s_mov_b32 s8, s4
    s_mov_b32 s9, s5
    s_mov_b32 s10, 0x100
    s_mov_b32 s11, 0x00020000
    s_mov_b32 s12, s6
    s_mov_b32 s13, s7
    s_mov_b32 s14, 0x10000000
    s_mov_b32 s15, 0x00020000
    s_lshr_b32 s30, s2, 3
    s_mov_b32 s101, 0
    v_mov_b32 v94, v0
    v_mov_b32 v14, 0
    s_and_b32 s35, s2, 7
    s_mov_b32 s3, 0
    s_cmp_eq_u32 s35, 1
    s_cbranch_scc1 L_chain
    s_cmp_ge_u32 s35, 3
    s_cbranch_scc1 L_w0
    s_getreg_b32 s34, hwreg(HW_REG_XCC_ID)
    s_lshr_b32 s36, s35, 1
    s_xor_b32 s34, s34, s36
    s_and_b32 s36, s34, 1
    s_lshl_b32 s34, s36, 2
    s_add_u32 s34, s34, 208
    s_lshl_b32 s37, 1, s30
    v_lshlrev_b32 v15, 12, v0
    v_mov_b32 v14, s37
    s_mov_b64 exec, 1
    buffer_atomic_or v14, v15, s[8:11], s34 offen sc0
    s_mov_b64 exec, -1
    s_mov_b32 s3, 1
    s_mov_b32 s101, 1
    s_cmp_eq_u32 s36, 0
    s_cbranch_scc1 L_chain
    s_waitcnt vmcnt(0)
    v_readfirstlane_b32 s34, v14
    s_nop 1
    v_mov_b32 v14, s34
    v_mov_b32 v15, 15360
    v_cmp_gt_u32 vcc, 64, v94
    s_nop 0
    s_cbranch_vccz L_rs1
    ds_write_b32 v15, v14
L_rs1:
    s_waitcnt lgkmcnt(0)
    s_barrier
    ds_read_b32 v14, v15
    s_waitcnt lgkmcnt(0)
    v_readfirstlane_b32 s34, v14
    s_nop 0
    s_bitcmp1_b32 s34, s30
    s_mov_b32 s101, 0
    s_cbranch_scc1 L_chain
L_wlost:
    s_mov_b32 s35, 2
    v_mov_b32 v0, v94
L_w0:
    s_sub_u32 s35, s35, 2
    s_lshl_b32 s35, s35, 5
    s_add_u32 s30, s30, s35
    s_load_dwordx2 s[20:21], s[0:1], 0
    s_load_dwordx4 s[24:27], s[0:1], 24
    s_load_dwordx2 s[22:23], s[0:1], 16
    s_load_dwordx4 s[60:63], s[0:1], 64
    s_load_dwordx2 s[64:65], s[0:1], 88
    s_load_dwordx2 s[28:29], s[0:1], 40
    v_lshrrev_b32 v16, 6, v0
    s_nop 0
    v_readfirstlane_b32 s31, v16
    v_and_b32 v17, 63, v0
    v_lshlrev_b32 v0, 4, v17
    v_lshrrev_b32 v18, 4, v17
    v_lshlrev_b32 v18, 1, v18
    v_mov_b32 v19, 0x78
    v_lshrrev_b32 v19, v18, v19
    v_xor_b32 v19, v19, v17
    v_and_b32 v19, 3, v19
    v_lshrrev_b32 v20, 2, v17
    v_mul_u32_u24 v2, 1280, v20
    v_lshl_add_u32 v2, v19, 4, v2
    v_bfe_u32 v18, v17, 2, 2
    v_lshlrev_b32 v18, 1, v18
    v_mov_b32 v19, 0x78
    v_lshrrev_b32 v19, v18, v19
    v_lshrrev_b32 v21, 4, v17
    v_xor_b32 v19, v19, v21
    v_and_b32 v19, 3, v19
    v_and_b32 v20, 15, v17
    v_lshlrev_b32 v3, 6, v20
    v_lshl_add_u32 v3, v19, 4, v3
    s_mov_b32 s75, 0
    v_mov_b32 v4, 0
    v_lshrrev_b32 v5, 2, v0
    s_lshl_b32 s34, s30, 7
    s_add_u32 s34, s34, 115343360
    s_mov_b64 exec, 0xffffffff
    buffer_store_dword v4, v5, s[12:15], s34 offen sc1
    s_mov_b64 exec, -1
    s_waitcnt lgkmcnt(0)
    s_mov_b32 s16, s20
    s_mov_b32 s17, s21
    s_mov_b32 s18, 0x280000
    s_mov_b32 s19, 0x00020000
    s_mul_i32 s66, s30, 10923
    s_lshr_b32 s66, s66, 16
    s_mul_i32 s34, s66, 6
    s_sub_u32 s67, s30, s34
    s_mov_b32 s46, s67
    s_mov_b32 s47, 6
    s_and_b32 s68, s66, 15
    s_lshl_b32 s44, s68, 9
    s_add_u32 s45, s44, 256
    s_lshl_b32 s69, s68, 14
    s_mov_b32 s70, s31
    s_mov_b32 s59, 0
    s_cmp_ge_u32 s66, 16
    s_cbranch_scc1 LW_v
    s_mov_b32 s36, s24
    s_mov_b32 s37, s25
    s_mov_b32 s38, 0x500000
    s_mov_b32 s39, 0x00020000
    s_mov_b32 s40, s24
    s_mov_b32 s41, s25
    s_mov_b32 s42, 0x500000
    s_mov_b32 s43, 0x00020000
    s_lshl_b32 s48, s70, 10
    s_add_u32 s48, s48, s69
    s_add_u32 s48, s48, 0
    s_mov_b32 s71, 0
LW_kq:
    s_mul_i32 s33, s31, 28672
    s_add_u32 s33, s33, 40960
    s_lshr_b32 s34, s31, 1
    s_lshl_b32 s34, s34, 5
    s_and_b32 s35, s31, 1
    s_lshl_b32 s35, s35, 2
    s_add_u32 s34, s34, s35
    s_mul_i32 s34, s34, 8192
    s_add_u32 s76, s44, s34
    s_add_u32 s77, s45, s34
    s_mul_i32 s50, s31, 10240
    s_mul_i32 s51, s31, 320
    s_mul_i32 s52, s46, 40960
    s_add_u32 s52, s52, s51
    s_mul_i32 s54, s47, 40960
    s_mov_b32 s53, s50
    s_barrier
    s_add_u32 s34, s52, 0
    s_add_u32 m0, s53, 0
    s_nop 0
    buffer_load_dwordx4 v2, s[16:19], s34 offen lds
    s_add_u32 s34, s52, 20480
    s_add_u32 m0, s53, 1024
    s_nop 0
    buffer_load_dwordx4 v2, s[16:19], s34 offen lds
    s_add_u32 s34, s52, 64
    s_add_u32 m0, s53, 2048
    s_nop 0
    buffer_load_dwordx4 v2, s[16:19], s34 offen lds
    s_add_u32 s34, s52, 20544
    s_add_u32 m0, s53, 3072
    s_nop 0
    buffer_load_dwordx4 v2, s[16:19], s34 offen lds
    s_add_u32 s34, s52, 128
    s_add_u32 m0, s53, 4096
    s_nop 0
    buffer_load_dwordx4 v2, s[16:19], s34 offen lds
    s_add_u32 s34, s52, 20608
    s_add_u32 m0, s53, 5120
    s_nop 0
    buffer_load_dwordx4 v2, s[16:19], s34 offen lds
    s_add_u32 s34, s52, 192
    s_add_u32 m0, s53, 6144
    s_nop 0
    buffer_load_dwordx4 v2, s[16:19], s34 offen lds
    s_add_u32 s34, s52, 20672
    s_add_u32 m0, s53, 7168
    s_nop 0
    buffer_load_dwordx4 v2, s[16:19], s34 offen lds
    s_add_u32 s34, s52, 256
    s_add_u32 m0, s53, 8192
    s_nop 0
    buffer_load_dwordx4 v2, s[16:19], s34 offen lds
    s_add_u32 s34, s52, 20736
    s_add_u32 m0, s53, 9216
    s_nop 0
    buffer_load_dwordx4 v2, s[16:19], s34 offen lds
    v_lshrrev_b32 v4, 8, v0
    v_bfe_u32 v5, v0, 4, 4
    v_lshlrev_b32 v6, 1, v4
    v_xor_b32 v6, v6, v5
    v_xor_b32 v7, 8, v6
    v_mul_u32_u24 v4, 8192, v4
    v_lshl_add_u32 v104, v6, 4, v4
    v_lshl_add_u32 v105, v7, 4, v4
    s_add_u32 s34, s76, 0
    s_add_u32 m0, s33, 0
    s_nop 0
    buffer_load_dwordx4 v104, s[36:39], s34 offen lds
    s_add_u32 s34, s76, 65536
    s_add_u32 m0, s33, 1024
    s_nop 0
    buffer_load_dwordx4 v105, s[36:39], s34 offen lds
    s_add_u32 s34, s76, 131072
    s_add_u32 m0, s33, 2048
    s_nop 0
    buffer_load_dwordx4 v104, s[36:39], s34 offen lds
    s_add_u32 s34, s76, 196608
    s_add_u32 m0, s33, 3072
    s_nop 0
    buffer_load_dwordx4 v105, s[36:39], s34 offen lds
    s_add_u32 s34, s77, 0
    s_add_u32 m0, s33, 4096
    s_nop 0
    buffer_load_dwordx4 v104, s[40:43], s34 offen lds
    s_add_u32 s34, s77, 65536
    s_add_u32 m0, s33, 5120
    s_nop 0
    buffer_load_dwordx4 v105, s[40:43], s34 offen lds
    s_add_u32 s34, s77, 131072
    s_add_u32 m0, s33, 6144
    s_nop 0
    buffer_load_dwordx4 v104, s[40:43], s34 offen lds
    s_add_u32 s34, s77, 196608
    s_add_u32 m0, s33, 7168
    s_nop 0
    buffer_load_dwordx4 v105, s[40:43], s34 offen lds
    s_add_u32 s34, s76, 524288
    s_add_u32 m0, s33, 8192
    s_nop 0
    buffer_load_dwordx4 v104, s[36:39], s34 offen lds
    s_add_u32 s34, s76, 589824
    s_add_u32 m0, s33, 9216
    s_nop 0
    buffer_load_dwordx4 v105, s[36:39], s34 offen lds
    s_add_u32 s34, s76, 655360
    s_add_u32 m0, s33, 10240
    s_nop 0
    buffer_load_dwordx4 v104, s[36:39], s34 offen lds
    s_add_u32 s34, s76, 720896
    s_add_u32 m0, s33, 11264
    s_nop 0
    buffer_load_dwordx4 v105, s[36:39], s34 offen lds
    s_add_u32 s34, s77, 524288
    s_add_u32 m0, s33, 12288
    s_nop 0
    buffer_load_dwordx4 v104, s[40:43], s34 offen lds
    s_add_u32 s34, s77, 589824
    s_add_u32 m0, s33, 13312
    s_nop 0
    buffer_load_dwordx4 v105, s[40:43], s34 offen lds
    s_add_u32 s34, s77, 655360
    s_add_u32 m0, s33, 14336
    s_nop 0
    buffer_load_dwordx4 v104, s[40:43], s34 offen lds
    s_add_u32 s34, s77, 720896
    s_add_u32 m0, s33, 15360
    s_nop 0
    buffer_load_dwordx4 v105, s[40:43], s34 offen lds
    s_add_u32 s34, s76, 1048576
    s_add_u32 m0, s33, 16384
    s_nop 0
    buffer_load_dwordx4 v104, s[36:39], s34 offen lds
    s_add_u32 s34, s76, 1114112
    s_add_u32 m0, s33, 17408
    s_nop 0
    buffer_load_dwordx4 v105, s[36:39], s34 offen lds
    s_add_u32 s34, s76, 1179648
    s_add_u32 m0, s33, 18432
    s_nop 0
    buffer_load_dwordx4 v104, s[36:39], s34 offen lds
    s_add_u32 s34, s76, 1245184
    s_add_u32 m0, s33, 19456
    s_nop 0
    buffer_load_dwordx4 v105, s[36:39], s34 offen lds
    s_add_u32 s34, s77, 1048576
    s_add_u32 m0, s33, 20480
    s_nop 0
    buffer_load_dwordx4 v104, s[40:43], s34 offen lds
    s_add_u32 s34, s77, 1114112
    s_add_u32 m0, s33, 21504
    s_nop 0
    buffer_load_dwordx4 v105, s[40:43], s34 offen lds
    s_add_u32 s34, s77, 1179648
    s_add_u32 m0, s33, 22528
    s_nop 0
    buffer_load_dwordx4 v104, s[40:43], s34 offen lds
    s_add_u32 s34, s77, 1245184
    s_add_u32 m0, s33, 23552
    s_nop 0
    buffer_load_dwordx4 v105, s[40:43], s34 offen lds
    v_lshrrev_b32 v4, 6, v0
    v_and_b32 v5, 7, v4
    v_lshlrev_b32 v5, 1, v5
    v_bfe_u32 v6, v0, 4, 1
    v_lshlrev_b32 v6, 3, v6
    v_lshl_add_u32 v6, v4, 8, v6
    s_lshl_b32 s34, s31, 2
    v_bfe_u32 v7, v0, 5, 1
    v_add_u32 v7, s34, v7
    v_add_u32 v8, 0, v7
    v_xor_b32 v8, v8, v5
    v_lshl_add_u32 v8, v8, 4, v6
    v_add_u32 v96, 40960, v8
    v_add_u32 v97, 69632, v8
    v_add_u32 v98, 98304, v8
    v_add_u32 v99, 126976, v8
    v_add_u32 v8, 2, v7
    v_xor_b32 v8, v8, v5
    v_lshl_add_u32 v8, v8, 4, v6
    v_add_u32 v100, 40960, v8
    v_add_u32 v101, 69632, v8
    v_add_u32 v102, 98304, v8
    v_add_u32 v103, 126976, v8
    s_waitcnt vmcnt(20)
    s_waitcnt lgkmcnt(0)
    s_barrier
    s_add_u32 s34, s76, 1572864
    s_add_u32 m0, s33, 24576
    s_nop 0
    buffer_load_dwordx4 v104, s[36:39], s34 offen lds
    s_add_u32 s34, s76, 1638400
    s_add_u32 m0, s33, 25600
    s_nop 0
    buffer_load_dwordx4 v105, s[36:39], s34 offen lds
    s_add_u32 s34, s76, 1703936
    s_add_u32 m0, s33, 26624
    s_nop 0
    buffer_load_dwordx4 v104, s[36:39], s34 offen lds
    s_add_u32 s34, s76, 1769472
    s_add_u32 m0, s33, 27648
    s_nop 0
    buffer_load_dwordx4 v105, s[36:39], s34 offen lds
    ds_read_b64_tr_b16 a[0:1], v96 offset:0
    ds_read_b64_tr_b16 a[2:3], v97 offset:0
    ds_read_b64_tr_b16 a[4:5], v98 offset:0
    ds_read_b64_tr_b16 a[6:7], v99 offset:0
    ds_read_b64_tr_b16 a[8:9], v100 offset:0
    ds_read_b64_tr_b16 a[10:11], v101 offset:0
    ds_read_b64_tr_b16 a[12:13], v102 offset:0
    ds_read_b64_tr_b16 a[14:15], v103 offset:0
    s_waitcnt vmcnt(20)
    s_waitcnt lgkmcnt(0)
    s_barrier
    s_add_u32 s34, s77, 1572864
    s_add_u32 m0, s33, 0
    s_nop 0
    buffer_load_dwordx4 v104, s[40:43], s34 offen lds
    s_add_u32 s34, s77, 1638400
    s_add_u32 m0, s33, 1024
    s_nop 0
    buffer_load_dwordx4 v105, s[40:43], s34 offen lds
    s_add_u32 s34, s77, 1703936
    s_add_u32 m0, s33, 2048
    s_nop 0
    buffer_load_dwordx4 v104, s[40:43], s34 offen lds
    s_add_u32 s34, s77, 1769472
    s_add_u32 m0, s33, 3072
    s_nop 0
    buffer_load_dwordx4 v105, s[40:43], s34 offen lds
    ds_read_b64_tr_b16 a[16:17], v96 offset:4096
    ds_read_b64_tr_b16 a[18:19], v97 offset:4096
    ds_read_b64_tr_b16 a[20:21], v98 offset:4096
    ds_read_b64_tr_b16 a[22:23], v99 offset:4096
    ds_read_b64_tr_b16 a[24:25], v100 offset:4096
    ds_read_b64_tr_b16 a[26:27], v101 offset:4096
    ds_read_b64_tr_b16 a[28:29], v102 offset:4096
    ds_read_b64_tr_b16 a[30:31], v103 offset:4096
    s_waitcnt vmcnt(20)
    s_waitcnt lgkmcnt(0)
    s_barrier
    s_add_u32 s34, s76, 2097152
    s_add_u32 m0, s33, 4096
    s_nop 0
    buffer_load_dwordx4 v104, s[36:39], s34 offen lds
    s_add_u32 s34, s76, 2162688
    s_add_u32 m0, s33, 5120
    s_nop 0
    buffer_load_dwordx4 v105, s[36:39], s34 offen lds
    s_add_u32 s34, s76, 2228224
    s_add_u32 m0, s33, 6144
    s_nop 0
    buffer_load_dwordx4 v104, s[36:39], s34 offen lds
    s_add_u32 s34, s76, 2293760
    s_add_u32 m0, s33, 7168
    s_nop 0
    buffer_load_dwordx4 v105, s[36:39], s34 offen lds
    ds_read_b64_tr_b16 a[32:33], v96 offset:8192
    ds_read_b64_tr_b16 a[34:35], v97 offset:8192
    ds_read_b64_tr_b16 a[36:37], v98 offset:8192
    ds_read_b64_tr_b16 a[38:39], v99 offset:8192
    ds_read_b64_tr_b16 a[40:41], v100 offset:8192
    ds_read_b64_tr_b16 a[42:43], v101 offset:8192
    ds_read_b64_tr_b16 a[44:45], v102 offset:8192
    ds_read_b64_tr_b16 a[46:47], v103 offset:8192
    s_waitcnt vmcnt(20)
    s_waitcnt lgkmcnt(0)
    s_barrier
    s_add_u32 s34, s77, 2097152
    s_add_u32 m0, s33, 8192
    s_nop 0
    buffer_load_dwordx4 v104, s[40:43], s34 offen lds
    s_add_u32 s34, s77, 2162688
    s_add_u32 m0, s33, 9216
    s_nop 0
    buffer_load_dwordx4 v105, s[40:43], s34 offen lds
    s_add_u32 s34, s77, 2228224
    s_add_u32 m0, s33, 10240
    s_nop 0
    buffer_load_dwordx4 v104, s[40:43], s34 offen lds
    s_add_u32 s34, s77, 2293760
    s_add_u32 m0, s33, 11264
    s_nop 0
    buffer_load_dwordx4 v105, s[40:43], s34 offen lds
    ds_read_b64_tr_b16 a[48:49], v96 offset:12288
    ds_read_b64_tr_b16 a[50:51], v97 offset:12288
    ds_read_b64_tr_b16 a[52:53], v98 offset:12288
    ds_read_b64_tr_b16 a[54:55], v99 offset:12288
    ds_read_b64_tr_b16 a[56:57], v100 offset:12288
    ds_read_b64_tr_b16 a[58:59], v101 offset:12288
    ds_read_b64_tr_b16 a[60:61], v102 offset:12288
    ds_read_b64_tr_b16 a[62:63], v103 offset:12288
    s_waitcnt vmcnt(20)
    s_waitcnt lgkmcnt(0)
    s_barrier
    s_add_u32 s34, s76, 2621440
    s_add_u32 m0, s33, 12288
    s_nop 0
    buffer_load_dwordx4 v104, s[36:39], s34 offen lds
    s_add_u32 s34, s76, 2686976
    s_add_u32 m0, s33, 13312
    s_nop 0
    buffer_load_dwordx4 v105, s[36:39], s34 offen lds
    s_add_u32 s34, s76, 2752512
    s_add_u32 m0, s33, 14336
    s_nop 0
    buffer_load_dwordx4 v104, s[36:39], s34 offen lds
    s_add_u32 s34, s76, 2818048
    s_add_u32 m0, s33, 15360
    s_nop 0
    buffer_load_dwordx4 v105, s[36:39], s34 offen lds
    ds_read_b64_tr_b16 a[64:65], v96 offset:16384
    ds_read_b64_tr_b16 a[66:67], v97 offset:16384
    ds_read_b64_tr_b16 a[68:69], v98 offset:16384
    ds_read_b64_tr_b16 a[70:71], v99 offset:16384
    ds_read_b64_tr_b16 a[72:73], v100 offset:16384
    ds_read_b64_tr_b16 a[74:75], v101 offset:16384
    ds_read_b64_tr_b16 a[76:77], v102 offset:16384
    ds_read_b64_tr_b16 a[78:79], v103 offset:16384
    s_waitcnt vmcnt(20)
    s_waitcnt lgkmcnt(0)
    s_barrier
    s_add_u32 s34, s77, 2621440
    s_add_u32 m0, s33, 16384
    s_nop 0
    buffer_load_dwordx4 v104, s[40:43], s34 offen lds
    s_add_u32 s34, s77, 2686976
    s_add_u32 m0, s33, 17408
    s_nop 0
    buffer_load_dwordx4 v105, s[40:43], s34 offen lds
    s_add_u32 s34, s77, 2752512
    s_add_u32 m0, s33, 18432
    s_nop 0
    buffer_load_dwordx4 v104, s[40:43], s34 offen lds
    s_add_u32 s34, s77, 2818048
    s_add_u32 m0, s33, 19456
    s_nop 0
    buffer_load_dwordx4 v105, s[40:43], s34 offen lds
    ds_read_b64_tr_b16 a[80:81], v96 offset:20480
    ds_read_b64_tr_b16 a[82:83], v97 offset:20480
    ds_read_b64_tr_b16 a[84:85], v98 offset:20480
    ds_read_b64_tr_b16 a[86:87], v99 offset:20480
    ds_read_b64_tr_b16 a[88:89], v100 offset:20480
    ds_read_b64_tr_b16 a[90:91], v101 offset:20480
    ds_read_b64_tr_b16 a[92:93], v102 offset:20480
    ds_read_b64_tr_b16 a[94:95], v103 offset:20480
    s_waitcnt vmcnt(20)
    s_waitcnt lgkmcnt(0)
    s_barrier
    s_add_u32 s34, s76, 3145728
    s_add_u32 m0, s33, 20480
    s_nop 0
    buffer_load_dwordx4 v104, s[36:39], s34 offen lds
    s_add_u32 s34, s76, 3211264
    s_add_u32 m0, s33, 21504
    s_nop 0
    buffer_load_dwordx4 v105, s[36:39], s34 offen lds
    s_add_u32 s34, s76, 3276800
    s_add_u32 m0, s33, 22528
    s_nop 0
    buffer_load_dwordx4 v104, s[36:39], s34 offen lds
    s_add_u32 s34, s76, 3342336
    s_add_u32 m0, s33, 23552
    s_nop 0
    buffer_load_dwordx4 v105, s[36:39], s34 offen lds
    ds_read_b64_tr_b16 a[96:97], v96 offset:24576
    ds_read_b64_tr_b16 a[98:99], v97 offset:24576
    ds_read_b64_tr_b16 a[100:101], v98 offset:24576
    ds_read_b64_tr_b16 a[102:103], v99 offset:24576
    ds_read_b64_tr_b16 a[104:105], v100 offset:24576
    ds_read_b64_tr_b16 a[106:107], v101 offset:24576
    ds_read_b64_tr_b16 a[108:109], v102 offset:24576
    ds_read_b64_tr_b16 a[110:111], v103 offset:24576
    s_waitcnt vmcnt(20)
    s_waitcnt lgkmcnt(0)
    s_barrier
    s_add_u32 s34, s77, 3145728
    s_add_u32 m0, s33, 24576
    s_nop 0
    buffer_load_dwordx4 v104, s[40:43], s34 offen lds
    s_add_u32 s34, s77, 3211264
    s_add_u32 m0, s33, 25600
    s_nop 0
    buffer_load_dwordx4 v105, s[40:43], s34 offen lds
    s_add_u32 s34, s77, 3276800
    s_add_u32 m0, s33, 26624
    s_nop 0
    buffer_load_dwordx4 v104, s[40:43], s34 offen lds
    s_add_u32 s34, s77, 3342336
    s_add_u32 m0, s33, 27648
    s_nop 0
    buffer_load_dwordx4 v105, s[40:43], s34 offen lds
    ds_read_b64_tr_b16 a[112:113], v96 offset:0
    ds_read_b64_tr_b16 a[114:115], v97 offset:0
    ds_read_b64_tr_b16 a[116:117], v98 offset:0
    ds_read_b64_tr_b16 a[118:119], v99 offset:0
    ds_read_b64_tr_b16 a[120:121], v100 offset:0
    ds_read_b64_tr_b16 a[122:123], v101 offset:0
    ds_read_b64_tr_b16 a[124:125], v102 offset:0
    ds_read_b64_tr_b16 a[126:127], v103 offset:0
    s_waitcnt vmcnt(20)
    s_waitcnt lgkmcnt(0)
    s_barrier
    s_add_u32 s34, s76, 3670016
    s_add_u32 m0, s33, 0
    s_nop 0
    buffer_load_dwordx4 v104, s[36:39], s34 offen lds
    s_add_u32 s34, s76, 3735552
    s_add_u32 m0, s33, 1024
    s_nop 0
    buffer_load_dwordx4 v105, s[36:39], s34 offen lds
    s_add_u32 s34, s76, 3801088
    s_add_u32 m0, s33, 2048
    s_nop 0
    buffer_load_dwordx4 v104, s[36:39], s34 offen lds
    s_add_u32 s34, s76, 3866624
    s_add_u32 m0, s33, 3072
    s_nop 0
    buffer_load_dwordx4 v105, s[36:39], s34 offen lds
    ds_read_b64_tr_b16 a[128:129], v96 offset:4096
    ds_read_b64_tr_b16 a[130:131], v97 offset:4096
    ds_read_b64_tr_b16 a[132:133], v98 offset:4096
    ds_read_b64_tr_b16 a[134:135], v99 offset:4096
    ds_read_b64_tr_b16 a[136:137], v100 offset:4096
    ds_read_b64_tr_b16 a[138:139], v101 offset:4096
    ds_read_b64_tr_b16 a[140:141], v102 offset:4096
    ds_read_b64_tr_b16 a[142:143], v103 offset:4096
    s_waitcnt vmcnt(20)
    s_waitcnt lgkmcnt(0)
    s_barrier
    s_add_u32 s34, s77, 3670016
    s_add_u32 m0, s33, 4096
    s_nop 0
    buffer_load_dwordx4 v104, s[40:43], s34 offen lds
    s_add_u32 s34, s77, 3735552
    s_add_u32 m0, s33, 5120
    s_nop 0
    buffer_load_dwordx4 v105, s[40:43], s34 offen lds
    s_add_u32 s34, s77, 3801088
    s_add_u32 m0, s33, 6144
    s_nop 0
    buffer_load_dwordx4 v104, s[40:43], s34 offen lds
    s_add_u32 s34, s77, 3866624
    s_add_u32 m0, s33, 7168
    s_nop 0
    buffer_load_dwordx4 v105, s[40:43], s34 offen lds
    ds_read_b64_tr_b16 a[144:145], v96 offset:8192
    ds_read_b64_tr_b16 a[146:147], v97 offset:8192
    ds_read_b64_tr_b16 a[148:149], v98 offset:8192
    ds_read_b64_tr_b16 a[150:151], v99 offset:8192
    ds_read_b64_tr_b16 a[152:153], v100 offset:8192
    ds_read_b64_tr_b16 a[154:155], v101 offset:8192
    ds_read_b64_tr_b16 a[156:157], v102 offset:8192
    ds_read_b64_tr_b16 a[158:159], v103 offset:8192
    s_waitcnt vmcnt(20)
    s_waitcnt lgkmcnt(0)
    s_barrier
    s_add_u32 s34, s76, 4194304
    s_add_u32 m0, s33, 8192
    s_nop 0
    buffer_load_dwordx4 v104, s[36:39], s34 offen lds
    s_add_u32 s34, s76, 4259840
    s_add_u32 m0, s33, 9216
    s_nop 0
    buffer_load_dwordx4 v105, s[36:39], s34 offen lds
    s_add_u32 s34, s76, 4325376
    s_add_u32 m0, s33, 10240
    s_nop 0
    buffer_load_dwordx4 v104, s[36:39], s34 offen lds
    s_add_u32 s34, s76, 4390912
    s_add_u32 m0, s33, 11264
    s_nop 0
    buffer_load_dwordx4 v105, s[36:39], s34 offen lds
    ds_read_b64_tr_b16 a[160:161], v96 offset:12288
    ds_read_b64_tr_b16 a[162:163], v97 offset:12288
    ds_read_b64_tr_b16 a[164:165], v98 offset:12288
    ds_read_b64_tr_b16 a[166:167], v99 offset:12288
    ds_read_b64_tr_b16 a[168:169], v100 offset:12288
    ds_read_b64_tr_b16 a[170:171], v101 offset:12288
    ds_read_b64_tr_b16 a[172:173], v102 offset:12288
    ds_read_b64_tr_b16 a[174:175], v103 offset:12288
    s_waitcnt vmcnt(20)
    s_waitcnt lgkmcnt(0)
    s_barrier
    s_add_u32 s34, s77, 4194304
    s_add_u32 m0, s33, 12288
    s_nop 0
    buffer_load_dwordx4 v104, s[40:43], s34 offen lds
    s_add_u32 s34, s77, 4259840
    s_add_u32 m0, s33, 13312
    s_nop 0
    buffer_load_dwordx4 v105, s[40:43], s34 offen lds
    s_add_u32 s34, s77, 4325376
    s_add_u32 m0, s33, 14336
    s_nop 0
    buffer_load_dwordx4 v104, s[40:43], s34 offen lds
    s_add_u32 s34, s77, 4390912
    s_add_u32 m0, s33, 15360
    s_nop 0
    buffer_load_dwordx4 v105, s[40:43], s34 offen lds
    ds_read_b64_tr_b16 a[176:177], v96 offset:16384
    ds_read_b64_tr_b16 a[178:179], v97 offset:16384
    ds_read_b64_tr_b16 a[180:181], v98 offset:16384
    ds_read_b64_tr_b16 a[182:183], v99 offset:16384
    ds_read_b64_tr_b16 a[184:185], v100 offset:16384
    ds_read_b64_tr_b16 a[186:187], v101 offset:16384
    ds_read_b64_tr_b16 a[188:189], v102 offset:16384
    ds_read_b64_tr_b16 a[190:191], v103 offset:16384
    s_waitcnt vmcnt(20)
    s_waitcnt lgkmcnt(0)
    s_barrier
    s_add_u32 s34, s76, 4718592
    s_add_u32 m0, s33, 16384
    s_nop 0
    buffer_load_dwordx4 v104, s[36:39], s34 offen lds
    s_add_u32 s34, s76, 4784128
    s_add_u32 m0, s33, 17408
    s_nop 0
    buffer_load_dwordx4 v105, s[36:39], s34 offen lds
    s_add_u32 s34, s76, 4849664
    s_add_u32 m0, s33, 18432
    s_nop 0
    buffer_load_dwordx4 v104, s[36:39], s34 offen lds
    s_add_u32 s34, s76, 4915200
    s_add_u32 m0, s33, 19456
    s_nop 0
    buffer_load_dwordx4 v105, s[36:39], s34 offen lds
    ds_read_b64_tr_b16 a[192:193], v96 offset:20480
    ds_read_b64_tr_b16 a[194:195], v97 offset:20480
    ds_read_b64_tr_b16 a[196:197], v98 offset:20480
    ds_read_b64_tr_b16 a[198:199], v99 offset:20480
    ds_read_b64_tr_b16 a[200:201], v100 offset:20480
    ds_read_b64_tr_b16 a[202:203], v101 offset:20480
    ds_read_b64_tr_b16 a[204:205], v102 offset:20480
    ds_read_b64_tr_b16 a[206:207], v103 offset:20480
    s_waitcnt vmcnt(20)
    s_waitcnt lgkmcnt(0)
    s_barrier
    s_add_u32 s34, s77, 4718592
    s_add_u32 m0, s33, 20480
    s_nop 0
    buffer_load_dwordx4 v104, s[40:43], s34 offen lds
    s_add_u32 s34, s77, 4784128
    s_add_u32 m0, s33, 21504
    s_nop 0
    buffer_load_dwordx4 v105, s[40:43], s34 offen lds
    s_add_u32 s34, s77, 4849664
    s_add_u32 m0, s33, 22528
    s_nop 0
    buffer_load_dwordx4 v104, s[40:43], s34 offen lds
    s_add_u32 s34, s77, 4915200
    s_add_u32 m0, s33, 23552
    s_nop 0
    buffer_load_dwordx4 v105, s[40:43], s34 offen lds
    ds_read_b64_tr_b16 a[208:209], v96 offset:24576
    ds_read_b64_tr_b16 a[210:211], v97 offset:24576
    ds_read_b64_tr_b16 a[212:213], v98 offset:24576
    ds_read_b64_tr_b16 a[214:215], v99 offset:24576
    ds_read_b64_tr_b16 a[216:217], v100 offset:24576
    ds_read_b64_tr_b16 a[218:219], v101 offset:24576
    ds_read_b64_tr_b16 a[220:221], v102 offset:24576
    ds_read_b64_tr_b16 a[222:223], v103 offset:24576
    s_waitcnt vmcnt(20)
    s_waitcnt lgkmcnt(0)
    s_barrier
    ds_read_b64_tr_b16 a[224:225], v96 offset:0
    ds_read_b64_tr_b16 a[226:227], v97 offset:0
    ds_read_b64_tr_b16 a[228:229], v98 offset:0
    ds_read_b64_tr_b16 a[230:231], v99 offset:0
    ds_read_b64_tr_b16 a[232:233], v100 offset:0
    ds_read_b64_tr_b16 a[234:235], v101 offset:0
    ds_read_b64_tr_b16 a[236:237], v102 offset:0
    ds_read_b64_tr_b16 a[238:239], v103 offset:0
    s_waitcnt vmcnt(16)
    s_waitcnt lgkmcnt(0)
    s_barrier
    ds_read_b64_tr_b16 a[240:241], v96 offset:4096
    ds_read_b64_tr_b16 a[242:243], v97 offset:4096
    ds_read_b64_tr_b16 a[244:245], v98 offset:4096
    ds_read_b64_tr_b16 a[246:247], v99 offset:4096
    ds_read_b64_tr_b16 a[248:249], v100 offset:4096
    ds_read_b64_tr_b16 a[250:251], v101 offset:4096
    ds_read_b64_tr_b16 a[252:253], v102 offset:4096
    ds_read_b64_tr_b16 a[254:255], v103 offset:4096
    s_waitcnt vmcnt(12)
    s_waitcnt lgkmcnt(0)
    s_barrier
    ds_read_b64_tr_b16 v[192:193], v96 offset:8192
    ds_read_b64_tr_b16 v[194:195], v97 offset:8192
    ds_read_b64_tr_b16 v[196:197], v98 offset:8192
    ds_read_b64_tr_b16 v[198:199], v99 offset:8192
    ds_read_b64_tr_b16 v[200:201], v100 offset:8192
    ds_read_b64_tr_b16 v[202:203], v101 offset:8192
    ds_read_b64_tr_b16 v[204:205], v102 offset:8192
    ds_read_b64_tr_b16 v[206:207], v103 offset:8192
    s_waitcnt vmcnt(8)
    s_waitcnt lgkmcnt(0)
    s_barrier
    ds_read_b64_tr_b16 v[208:209], v96 offset:12288
    ds_read_b64_tr_b16 v[210:211], v97 offset:12288
    ds_read_b64_tr_b16 v[212:213], v98 offset:12288
    ds_read_b64_tr_b16 v[214:215], v99 offset:12288
    ds_read_b64_tr_b16 v[216:217], v100 offset:12288
    ds_read_b64_tr_b16 v[218:219], v101 offset:12288
    ds_read_b64_tr_b16 v[220:221], v102 offset:12288
    ds_read_b64_tr_b16 v[222:223], v103 offset:12288
    s_waitcnt vmcnt(4)
    s_waitcnt lgkmcnt(0)
    s_barrier
    ds_read_b64_tr_b16 v[224:225], v96 offset:16384
    ds_read_b64_tr_b16 v[226:227], v97 offset:16384
    ds_read_b64_tr_b16 v[228:229], v98 offset:16384
    ds_read_b64_tr_b16 v[230:231], v99 offset:16384
    ds_read_b64_tr_b16 v[232:233], v100 offset:16384
    ds_read_b64_tr_b16 v[234:235], v101 offset:16384
    ds_read_b64_tr_b16 v[236:237], v102 offset:16384
    ds_read_b64_tr_b16 v[238:239], v103 offset:16384
    s_waitcnt vmcnt(0)
    s_waitcnt lgkmcnt(0)
    s_barrier
    ds_read_b64_tr_b16 v[240:241], v96 offset:20480
    ds_read_b64_tr_b16 v[242:243], v97 offset:20480
    ds_read_b64_tr_b16 v[244:245], v98 offset:20480
    ds_read_b64_tr_b16 v[246:247], v99 offset:20480
    ds_read_b64_tr_b16 v[248:249], v100 offset:20480
    ds_read_b64_tr_b16 v[250:251], v101 offset:20480
    ds_read_b64_tr_b16 v[252:253], v102 offset:20480
    ds_read_b64_tr_b16 v[254:255], v103 offset:20480
    s_waitcnt vmcnt(0) lgkmcnt(0)
    s_barrier
    s_add_u32 s52, s52, s54
    s_add_u32 s53, s50, 40960
    s_add_u32 s34, s52, 0
    s_add_u32 m0, s53, 0
    s_nop 0
    buffer_load_dwordx4 v2, s[16:19], s34 offen lds
    s_add_u32 s34, s52, 20480
    s_add_u32 m0, s53, 1024
    s_nop 0
    buffer_load_dwordx4 v2, s[16:19], s34 offen lds
    s_add_u32 s34, s52, 64
    s_add_u32 m0, s53, 2048
    s_nop 0
    buffer_load_dwordx4 v2, s[16:19], s34 offen lds
    s_add_u32 s34, s52, 20544
    s_add_u32 m0, s53, 3072
    s_nop 0
    buffer_load_dwordx4 v2, s[16:19], s34 offen lds
    s_add_u32 s34, s52, 128
    s_add_u32 m0, s53, 4096
    s_nop 0
    buffer_load_dwordx4 v2, s[16:19], s34 offen lds
    s_add_u32 s34, s52, 20608
    s_add_u32 m0, s53, 5120
    s_nop 0
    buffer_load_dwordx4 v2, s[16:19], s34 offen lds
    s_add_u32 s34, s52, 192
    s_add_u32 m0, s53, 6144
    s_nop 0
    buffer_load_dwordx4 v2, s[16:19], s34 offen lds
    s_add_u32 s34, s52, 20672
    s_add_u32 m0, s53, 7168
    s_nop 0
    buffer_load_dwordx4 v2, s[16:19], s34 offen lds
    s_add_u32 s34, s52, 256
    s_add_u32 m0, s53, 8192
    s_nop 0
    buffer_load_dwordx4 v2, s[16:19], s34 offen lds
    s_add_u32 s34, s52, 20736
    s_add_u32 m0, s53, 9216
    s_nop 0
    buffer_load_dwordx4 v2, s[16:19], s34 offen lds
    s_add_u32 s52, s52, s54
    s_add_u32 s53, s50, 81920
    s_mov_b32 s55, 0
    s_mul_i32 s56, s46, 262144
    s_add_u32 s56, s56, s48
    s_mul_i32 s57, s47, 262144
LK_tile:
    v_add_u32 v13, s55, v3
    ds_read_b128 v[48:51], v13 offset:0
    ds_read_b128 v[52:55], v13 offset:1024
    ds_read_b128 v[56:59], v13 offset:2048
    ds_read_b128 v[60:63], v13 offset:3072
    ds_read_b128 v[64:67], v13 offset:4096
    ds_read_b128 v[68:71], v13 offset:5120
    s_waitcnt lgkmcnt(5)
    v_mfma_f32_16x16x32_bf16 v[16:19], a[0:3], v[48:51], 0
    ds_read_b128 v[72:75], v13 offset:6144
    ds_read_b128 v[76:79], v13 offset:7168
    s_waitcnt lgkmcnt(6)
    v_mfma_f32_16x16x32_bf16 v[32:35], a[0:3], v[52:55], 0
    v_mfma_f32_16x16x32_bf16 v[20:23], a[8:11], v[48:51], 0
    v_mfma_f32_16x16x32_bf16 v[36:39], a[8:11], v[52:55], 0
    v_mfma_f32_16x16x32_bf16 v[24:27], a[16:19], v[48:51], 0
    v_mfma_f32_16x16x32_bf16 v[40:43], a[16:19], v[52:55], 0
    v_mfma_f32_16x16x32_bf16 v[28:31], a[24:27], v[48:51], 0
    v_mfma_f32_16x16x32_bf16 v[44:47], a[24:27], v[52:55], 0
    s_waitcnt lgkmcnt(5)
    v_mfma_f32_16x16x32_bf16 v[16:19], a[4:7], v[56:59], v[16:19]
    ds_read_b128 v[48:51], v13 offset:8192
    ds_read_b128 v[52:55], v13 offset:9216
    s_waitcnt lgkmcnt(6)
    v_mfma_f32_16x16x32_bf16 v[32:35], a[4:7], v[60:63], v[32:35]
    v_mfma_f32_16x16x32_bf16 v[20:23], a[12:15], v[56:59], v[20:23]
    v_mfma_f32_16x16x32_bf16 v[36:39], a[12:15], v[60:63], v[36:39]
    s_add_u32 s34, s52, 0
    s_add_u32 m0, s53, 0
    s_nop 0
    buffer_load_dwordx4 v2, s[16:19], s34 offen lds
    v_mfma_f32_16x16x32_bf16 v[24:27], a[20:23], v[56:59], v[24:27]
    v_mfma_f32_16x16x32_bf16 v[40:43], a[20:23], v[60:63], v[40:43]
    v_mfma_f32_16x16x32_bf16 v[28:31], a[28:31], v[56:59], v[28:31]
    v_mfma_f32_16x16x32_bf16 v[44:47], a[28:31], v[60:63], v[44:47]
    s_waitcnt lgkmcnt(5)
    v_mfma_f32_16x16x32_bf16 v[16:19], a[32:35], v[64:67], v[16:19]
    ds_read_b128 v[56:59], v13 offset:10240
    ds_read_b128 v[60:63], v13 offset:11264
    s_waitcnt lgkmcnt(6)
    v_mfma_f32_16x16x32_bf16 v[32:35], a[32:35], v[68:71], v[32:35]
    v_mfma_f32_16x16x32_bf16 v[20:23], a[40:43], v[64:67], v[20:23]
    v_mfma_f32_16x16x32_bf16 v[36:39], a[40:43], v[68:71], v[36:39]
    s_add_u32 s34, s52, 20480
    s_add_u32 m0, s53, 1024
    s_nop 0
    buffer_load_dwordx4 v2, s[16:19], s34 offen lds
    v_mfma_f32_16x16x32_bf16 v[24:27], a[48:51], v[64:67], v[24:27]
    v_mfma_f32_16x16x32_bf16 v[40:43], a[48:51], v[68:71], v[40:43]
    v_mfma_f32_16x16x32_bf16 v[28:31], a[56:59], v[64:67], v[28:31]
    v_mfma_f32_16x16x32_bf16 v[44:47], a[56:59], v[68:71], v[44:47]
    s_waitcnt lgkmcnt(5)
    v_mfma_f32_16x16x32_bf16 v[16:19], a[36:39], v[72:75], v[16:19]
    ds_read_b128 v[64:67], v13 offset:12288
    ds_read_b128 v[68:71], v13 offset:13312
    s_waitcnt lgkmcnt(6)
    v_mfma_f32_16x16x32_bf16 v[32:35], a[36:39], v[76:79], v[32:35]
    v_mfma_f32_16x16x32_bf16 v[20:23], a[44:47], v[72:75], v[20:23]
    v_mfma_f32_16x16x32_bf16 v[36:39], a[44:47], v[76:79], v[36:39]
    s_add_u32 s34, s52, 64
    s_add_u32 m0, s53, 2048
    s_nop 0
    buffer_load_dwordx4 v2, s[16:19], s34 offen lds
    v_mfma_f32_16x16x32_bf16 v[24:27], a[52:55], v[72:75], v[24:27]
    v_mfma_f32_16x16x32_bf16 v[40:43], a[52:55], v[76:79], v[40:43]
    v_mfma_f32_16x16x32_bf16 v[28:31], a[60:63], v[72:75], v[28:31]
    v_mfma_f32_16x16x32_bf16 v[44:47], a[60:63], v[76:79], v[44:47]
    s_waitcnt lgkmcnt(5)
    v_mfma_f32_16x16x32_bf16 v[16:19], a[64:67], v[48:51], v[16:19]
    ds_read_b128 v[72:75], v13 offset:14336
    ds_read_b128 v[76:79], v13 offset:15360
    s_waitcnt lgkmcnt(6)
    v_mfma_f32_16x16x32_bf16 v[32:35], a[64:67], v[52:55], v[32:35]
    v_mfma_f32_16x16x32_bf16 v[20:23], a[72:75], v[48:51], v[20:23]
    v_mfma_f32_16x16x32_bf16 v[36:39], a[72:75], v[52:55], v[36:39]
    s_add_u32 s34, s52, 20544
    s_add_u32 m0, s53, 3072
    s_nop 0
    buffer_load_dwordx4 v2, s[16:19], s34 offen lds
    v_mfma_f32_16x16x32_bf16 v[24:27], a[80:83], v[48:51], v[24:27]
    v_mfma_f32_16x16x32_bf16 v[40:43], a[80:83], v[52:55], v[40:43]
    v_mfma_f32_16x16x32_bf16 v[28:31], a[88:91], v[48:51], v[28:31]
    v_mfma_f32_16x16x32_bf16 v[44:47], a[88:91], v[52:55], v[44:47]
    s_waitcnt lgkmcnt(5)
    v_mfma_f32_16x16x32_bf16 v[16:19], a[68:71], v[56:59], v[16:19]
    ds_read_b128 v[48:51], v13 offset:16384
    ds_read_b128 v[52:55], v13 offset:17408
    s_waitcnt lgkmcnt(6)
    v_mfma_f32_16x16x32_bf16 v[32:35], a[68:71], v[60:63], v[32:35]
    v_mfma_f32_16x16x32_bf16 v[20:23], a[76:79], v[56:59], v[20:23]
    v_mfma_f32_16x16x32_bf16 v[36:39], a[76:79], v[60:63], v[36:39]
    s_add_u32 s34, s52, 128
    s_add_u32 m0, s53, 4096
    s_nop 0
    buffer_load_dwordx4 v2, s[16:19], s34 offen lds
    v_mfma_f32_16x16x32_bf16 v[24:27], a[84:87], v[56:59], v[24:27]
    v_mfma_f32_16x16x32_bf16 v[40:43], a[84:87], v[60:63], v[40:43]
    v_mfma_f32_16x16x32_bf16 v[28:31], a[92:95], v[56:59], v[28:31]
    v_mfma_f32_16x16x32_bf16 v[44:47], a[92:95], v[60:63], v[44:47]
    s_waitcnt lgkmcnt(5)
    v_mfma_f32_16x16x32_bf16 v[16:19], a[96:99], v[64:67], v[16:19]
    ds_read_b128 v[56:59], v13 offset:18432
    ds_read_b128 v[60:63], v13 offset:19456
    s_waitcnt lgkmcnt(6)
    v_mfma_f32_16x16x32_bf16 v[32:35], a[96:99], v[68:71], v[32:35]
    v_mfma_f32_16x16x32_bf16 v[20:23], a[104:107], v[64:67], v[20:23]
    v_mfma_f32_16x16x32_bf16 v[36:39], a[104:107], v[68:71], v[36:39]
    s_add_u32 s34, s52, 20608
    s_add_u32 m0, s53, 5120
    s_nop 0
    buffer_load_dwordx4 v2, s[16:19], s34 offen lds
    v_mfma_f32_16x16x32_bf16 v[24:27], a[112:115], v[64:67], v[24:27]
    v_mfma_f32_16x16x32_bf16 v[40:43], a[112:115], v[68:71], v[40:43]
    v_mfma_f32_16x16x32_bf16 v[28:31], a[120:123], v[64:67], v[28:31]
    v_mfma_f32_16x16x32_bf16 v[44:47], a[120:123], v[68:71], v[44:47]
    s_waitcnt lgkmcnt(5)
    v_mfma_f32_16x16x32_bf16 v[16:19], a[100:103], v[72:75], v[16:19]
    ds_read_b128 v[64:67], v13 offset:20480
    ds_read_b128 v[68:71], v13 offset:21504
    s_waitcnt lgkmcnt(6)
    v_mfma_f32_16x16x32_bf16 v[32:35], a[100:103], v[76:79], v[32:35]
    v_mfma_f32_16x16x32_bf16 v[20:23], a[108:111], v[72:75], v[20:23]
    v_mfma_f32_16x16x32_bf16 v[36:39], a[108:111], v[76:79], v[36:39]
    s_add_u32 s34, s52, 192
    s_add_u32 m0, s53, 6144
    s_nop 0
    buffer_load_dwordx4 v2, s[16:19], s34 offen lds
    v_mfma_f32_16x16x32_bf16 v[24:27], a[116:119], v[72:75], v[24:27]
    v_mfma_f32_16x16x32_bf16 v[40:43], a[116:119], v[76:79], v[40:43]
    v_mfma_f32_16x16x32_bf16 v[28:31], a[124:127], v[72:75], v[28:31]
    v_mfma_f32_16x16x32_bf16 v[44:47], a[124:127], v[76:79], v[44:47]
    s_waitcnt lgkmcnt(5)
    v_mfma_f32_16x16x32_bf16 v[16:19], a[128:131], v[48:51], v[16:19]
    ds_read_b128 v[72:75], v13 offset:22528
    ds_read_b128 v[76:79], v13 offset:23552
    s_waitcnt lgkmcnt(6)
    v_mfma_f32_16x16x32_bf16 v[32:35], a[128:131], v[52:55], v[32:35]
    v_mfma_f32_16x16x32_bf16 v[20:23], a[136:139], v[48:51], v[20:23]
    v_mfma_f32_16x16x32_bf16 v[36:39], a[136:139], v[52:55], v[36:39]
    s_add_u32 s34, s52, 20672
    s_add_u32 m0, s53, 7168
    s_nop 0
    buffer_load_dwordx4 v2, s[16:19], s34 offen lds
    v_mfma_f32_16x16x32_bf16 v[24:27], a[144:147], v[48:51], v[24:27]
    v_mfma_f32_16x16x32_bf16 v[40:43], a[144:147], v[52:55], v[40:43]
    v_mfma_f32_16x16x32_bf16 v[28:31], a[152:155], v[48:51], v[28:31]
    v_mfma_f32_16x16x32_bf16 v[44:47], a[152:155], v[52:55], v[44:47]
    s_waitcnt lgkmcnt(5)
    v_mfma_f32_16x16x32_bf16 v[16:19], a[132:135], v[56:59], v[16:19]
    ds_read_b128 v[48:51], v13 offset:24576
    ds_read_b128 v[52:55], v13 offset:25600
    s_waitcnt lgkmcnt(6)
    v_mfma_f32_16x16x32_bf16 v[32:35], a[132:135], v[60:63], v[32:35]
    v_mfma_f32_16x16x32_bf16 v[20:23], a[140:143], v[56:59], v[20:23]
    v_mfma_f32_16x16x32_bf16 v[36:39], a[140:143], v[60:63], v[36:39]
    s_add_u32 s34, s52, 256
    s_add_u32 m0, s53, 8192
    s_nop 0
    buffer_load_dwordx4 v2, s[16:19], s34 offen lds
    v_mfma_f32_16x16x32_bf16 v[24:27], a[148:151], v[56:59], v[24:27]
    v_mfma_f32_16x16x32_bf16 v[40:43], a[148:151], v[60:63], v[40:43]
    v_mfma_f32_16x16x32_bf16 v[28:31], a[156:159], v[56:59], v[28:31]
    v_mfma_f32_16x16x32_bf16 v[44:47], a[156:159], v[60:63], v[44:47]
    s_waitcnt lgkmcnt(5)
    v_mfma_f32_16x16x32_bf16 v[16:19], a[160:163], v[64:67], v[16:19]
    ds_read_b128 v[56:59], v13 offset:26624
    ds_read_b128 v[60:63], v13 offset:27648
    s_waitcnt lgkmcnt(6)
    v_mfma_f32_16x16x32_bf16 v[32:35], a[160:163], v[68:71], v[32:35]
    v_mfma_f32_16x16x32_bf16 v[20:23], a[168:171], v[64:67], v[20:23]
    v_mfma_f32_16x16x32_bf16 v[36:39], a[168:171], v[68:71], v[36:39]
    s_add_u32 s34, s52, 20736
    s_add_u32 m0, s53, 9216
    s_nop 0
    buffer_load_dwordx4 v2, s[16:19], s34 offen lds
    v_mfma_f32_16x16x32_bf16 v[24:27], a[176:179], v[64:67], v[24:27]
    v_mfma_f32_16x16x32_bf16 v[40:43], a[176:179], v[68:71], v[40:43]
    v_mfma_f32_16x16x32_bf16 v[28:31], a[184:187], v[64:67], v[28:31]
    v_mfma_f32_16x16x32_bf16 v[44:47], a[184:187], v[68:71], v[44:47]
    s_waitcnt lgkmcnt(5)
    v_mfma_f32_16x16x32_bf16 v[16:19], a[164:167], v[72:75], v[16:19]
    ds_read_b128 v[64:67], v13 offset:28672
    ds_read_b128 v[68:71], v13 offset:29696
    s_waitcnt lgkmcnt(6)
    v_mfma_f32_16x16x32_bf16 v[32:35], a[164:167], v[76:79], v[32:35]
    v_mfma_f32_16x16x32_bf16 v[20:23], a[172:175], v[72:75], v[20:23]
    v_mfma_f32_16x16x32_bf16 v[36:39], a[172:175], v[76:79], v[36:39]
    v_mfma_f32_16x16x32_bf16 v[24:27], a[180:183], v[72:75], v[24:27]
    v_mfma_f32_16x16x32_bf16 v[40:43], a[180:183], v[76:79], v[40:43]
    v_mfma_f32_16x16x32_bf16 v[28:31], a[188:191], v[72:75], v[28:31]
    v_mfma_f32_16x16x32_bf16 v[44:47], a[188:191], v[76:79], v[44:47]
    s_waitcnt lgkmcnt(5)
    v_mfma_f32_16x16x32_bf16 v[16:19], a[192:195], v[48:51], v[16:19]
    ds_read_b128 v[72:75], v13 offset:30720
    ds_read_b128 v[76:79], v13 offset:31744
    s_waitcnt lgkmcnt(6)
    v_mfma_f32_16x16x32_bf16 v[32:35], a[192:195], v[52:55], v[32:35]
    v_mfma_f32_16x16x32_bf16 v[20:23], a[200:203], v[48:51], v[20:23]
    v_mfma_f32_16x16x32_bf16 v[36:39], a[200:203], v[52:55], v[36:39]
    v_mfma_f32_16x16x32_bf16 v[24:27], a[208:211], v[48:51], v[24:27]
    v_mfma_f32_16x16x32_bf16 v[40:43], a[208:211], v[52:55], v[40:43]
    v_mfma_f32_16x16x32_bf16 v[28:31], a[216:219], v[48:51], v[28:31]
    v_mfma_f32_16x16x32_bf16 v[44:47], a[216:219], v[52:55], v[44:47]
    s_waitcnt lgkmcnt(5)
    v_mfma_f32_16x16x32_bf16 v[16:19], a[196:199], v[56:59], v[16:19]
    ds_read_b128 v[48:51], v13 offset:32768
    ds_read_b128 v[52:55], v13 offset:33792
    s_waitcnt lgkmcnt(6)
    v_mfma_f32_16x16x32_bf16 v[32:35], a[196:199], v[60:63], v[32:35]
    v_mfma_f32_16x16x32_bf16 v[20:23], a[204:207], v[56:59], v[20:23]
    v_mfma_f32_16x16x32_bf16 v[36:39], a[204:207], v[60:63], v[36:39]
    v_mfma_f32_16x16x32_bf16 v[24:27], a[212:215], v[56:59], v[24:27]
    v_mfma_f32_16x16x32_bf16 v[40:43], a[212:215], v[60:63], v[40:43]
    v_mfma_f32_16x16x32_bf16 v[28:31], a[220:223], v[56:59], v[28:31]
    v_mfma_f32_16x16x32_bf16 v[44:47], a[220:223], v[60:63], v[44:47]
    s_waitcnt lgkmcnt(5)
    v_mfma_f32_16x16x32_bf16 v[16:19], a[224:227], v[64:67], v[16:19]
    ds_read_b128 v[56:59], v13 offset:34816
    ds_read_b128 v[60:63], v13 offset:35840
    s_waitcnt lgkmcnt(6)
    v_mfma_f32_16x16x32_bf16 v[32:35], a[224:227], v[68:71], v[32:35]
    v_mfma_f32_16x16x32_bf16 v[20:23], a[232:235], v[64:67], v[20:23]
    v_mfma_f32_16x16x32_bf16 v[36:39], a[232:235], v[68:71], v[36:39]
    v_mfma_f32_16x16x32_bf16 v[24:27], a[240:243], v[64:67], v[24:27]
    v_mfma_f32_16x16x32_bf16 v[40:43], a[240:243], v[68:71], v[40:43]
    v_mfma_f32_16x16x32_bf16 v[28:31], a[248:251], v[64:67], v[28:31]
    v_mfma_f32_16x16x32_bf16 v[44:47], a[248:251], v[68:71], v[44:47]
    s_waitcnt lgkmcnt(5)
    v_mfma_f32_16x16x32_bf16 v[16:19], a[228:231], v[72:75], v[16:19]
    ds_read_b128 v[64:67], v13 offset:36864
    ds_read_b128 v[68:71], v13 offset:37888
    s_waitcnt lgkmcnt(6)
    v_mfma_f32_16x16x32_bf16 v[32:35], a[228:231], v[76:79], v[32:35]
    v_mfma_f32_16x16x32_bf16 v[20:23], a[236:239], v[72:75], v[20:23]
    v_mfma_f32_16x16x32_bf16 v[36:39], a[236:239], v[76:79], v[36:39]
    v_mfma_f32_16x16x32_bf16 v[24:27], a[244:247], v[72:75], v[24:27]
    v_mfma_f32_16x16x32_bf16 v[40:43], a[244:247], v[76:79], v[40:43]
    v_mfma_f32_16x16x32_bf16 v[28:31], a[252:255], v[72:75], v[28:31]
    v_mfma_f32_16x16x32_bf16 v[44:47], a[252:255], v[76:79], v[44:47]
    s_waitcnt lgkmcnt(5)
    v_mfma_f32_16x16x32_bf16 v[16:19], v[192:195], v[48:51], v[16:19]
    ds_read_b128 v[72:75], v13 offset:38912
    ds_read_b128 v[76:79], v13 offset:39936
    s_waitcnt lgkmcnt(6)
    v_mfma_f32_16x16x32_bf16 v[32:35], v[192:195], v[52:55], v[32:35]
    v_mfma_f32_16x16x32_bf16 v[20:23], v[200:203], v[48:51], v[20:23]
    v_mfma_f32_16x16x32_bf16 v[36:39], v[200:203], v[52:55], v[36:39]
    v_mfma_f32_16x16x32_bf16 v[24:27], v[208:211], v[48:51], v[24:27]
    v_mfma_f32_16x16x32_bf16 v[40:43], v[208:211], v[52:55], v[40:43]
    v_mfma_f32_16x16x32_bf16 v[28:31], v[216:219], v[48:51], v[28:31]
    v_mfma_f32_16x16x32_bf16 v[44:47], v[216:219], v[52:55], v[44:47]
    s_waitcnt lgkmcnt(5)
    v_mfma_f32_16x16x32_bf16 v[16:19], v[196:199], v[56:59], v[16:19]
    s_waitcnt lgkmcnt(4)
    v_mfma_f32_16x16x32_bf16 v[32:35], v[196:199], v[60:63], v[32:35]
    v_mfma_f32_16x16x32_bf16 v[20:23], v[204:207], v[56:59], v[20:23]
    v_mfma_f32_16x16x32_bf16 v[36:39], v[204:207], v[60:63], v[36:39]
    v_mfma_f32_16x16x32_bf16 v[24:27], v[212:215], v[56:59], v[24:27]
    v_mfma_f32_16x16x32_bf16 v[40:43], v[212:215], v[60:63], v[40:43]
    v_mfma_f32_16x16x32_bf16 v[28:31], v[220:223], v[56:59], v[28:31]
    v_mfma_f32_16x16x32_bf16 v[44:47], v[220:223], v[60:63], v[44:47]
    s_waitcnt lgkmcnt(3)
    v_mfma_f32_16x16x32_bf16 v[16:19], v[224:227], v[64:67], v[16:19]
    s_waitcnt lgkmcnt(2)
    v_mfma_f32_16x16x32_bf16 v[32:35], v[224:227], v[68:71], v[32:35]
    v_mfma_f32_16x16x32_bf16 v[20:23], v[232:235], v[64:67], v[20:23]
    v_mfma_f32_16x16x32_bf16 v[36:39], v[232:235], v[68:71], v[36:39]
    v_mfma_f32_16x16x32_bf16 v[24:27], v[240:243], v[64:67], v[24:27]
    v_mfma_f32_16x16x32_bf16 v[40:43], v[240:243], v[68:71], v[40:43]
    v_mfma_f32_16x16x32_bf16 v[28:31], v[248:251], v[64:67], v[28:31]
    v_mfma_f32_16x16x32_bf16 v[44:47], v[248:251], v[68:71], v[44:47]
    s_waitcnt lgkmcnt(1)
    v_mfma_f32_16x16x32_bf16 v[16:19], v[228:231], v[72:75], v[16:19]
    s_waitcnt lgkmcnt(0)
    v_mfma_f32_16x16x32_bf16 v[32:35], v[228:231], v[76:79], v[32:35]
    v_mfma_f32_16x16x32_bf16 v[20:23], v[236:239], v[72:75], v[20:23]
    v_mfma_f32_16x16x32_bf16 v[36:39], v[236:239], v[76:79], v[36:39]
    v_mfma_f32_16x16x32_bf16 v[24:27], v[244:247], v[72:75], v[24:27]
    v_mfma_f32_16x16x32_bf16 v[40:43], v[244:247], v[76:79], v[40:43]
    v_mfma_f32_16x16x32_bf16 v[28:31], v[252:255], v[72:75], v[28:31]
    v_mfma_f32_16x16x32_bf16 v[44:47], v[252:255], v[76:79], v[44:47]
    v_cvt_pk_bf16_f32 v80, v16, v20
    v_cvt_pk_bf16_f32 v81, v17, v21
    v_cvt_pk_bf16_f32 v82, v18, v22
    v_cvt_pk_bf16_f32 v83, v19, v23
    s_add_u32 s35, s56, 0
    buffer_store_dwordx4 v[80:83], v0, s[12:15], s35 offen sc1
    v_cvt_pk_bf16_f32 v84, v24, v28
    v_cvt_pk_bf16_f32 v85, v25, v29
    v_cvt_pk_bf16_f32 v86, v26, v30
    v_cvt_pk_bf16_f32 v87, v27, v31
    s_add_u32 s35, s56, 8192
    buffer_store_dwordx4 v[84:87], v0, s[12:15], s35 offen sc1
    v_cvt_pk_bf16_f32 v88, v32, v36
    v_cvt_pk_bf16_f32 v89, v33, v37
    v_cvt_pk_bf16_f32 v90, v34, v38
    v_cvt_pk_bf16_f32 v91, v35, v39
    s_add_u32 s35, s56, 4096
    buffer_store_dwordx4 v[88:91], v0, s[12:15], s35 offen sc1
    v_cvt_pk_bf16_f32 v92, v40, v44
    v_cvt_pk_bf16_f32 v93, v41, v45
    v_cvt_pk_bf16_f32 v94, v42, v46
    v_cvt_pk_bf16_f32 v95, v43, v47
    s_add_u32 s35, s56, 12288
    buffer_store_dwordx4 v[92:95], v0, s[12:15], s35 offen sc1
    s_add_u32 s46, s46, s47
    s_add_u32 s52, s52, s54
    s_add_u32 s56, s56, s57
    s_add_u32 s53, s55, s50
    s_add_u32 s55, s55, 40960
    s_cmp_eq_u32 s55, 122880
    s_cselect_b32 s55, 0, s55
    s_waitcnt vmcnt(14)
    s_cmp_lg_u32 s59, 0
    s_cbranch_scc1 LK_nw
    s_waitcnt vmcnt(0)
LK_nw:
    s_barrier
    s_add_u32 s59, s59, 1
    s_cmp_lg_u32 s31, 0
    s_cbranch_scc1 LK_nosig
    s_cmp_eq_u32 s59, 1
    s_cselect_b32 s35, 64, 0
    s_cmp_eq_u32 s59, 4
    s_cselect_b32 s35, 68, s35
    s_cmp_eq_u32 s35, 0
    s_cbranch_scc1 LK_nosig
    v_mov_b32 v4, s35
    v_mov_b32 v5, 1
    s_mov_b64 exec, 1
    buffer_atomic_add v5, v4, s[8:11], 0 offen
    s_mov_b64 exec, -1
LK_nosig:
    s_cmp_lt_u32 s46, 64
    s_cbranch_scc1 LK_tile
    s_waitcnt vmcnt(0)
    s_cmp_eq_u32 s71, 1
    s_cbranch_scc1 LW_p1b_done
    s_branch LW_p1a_done
LW_v:
    s_mov_b32 s36, s26
    s_mov_b32 s37, s27
    s_mov_b32 s38, 0x500000
    s_mov_b32 s39, 0x00020000
    s_mov_b32 s40, s26
    s_mov_b32 s41, s27
    s_mov_b32 s42, 0x500000
    s_mov_b32 s43, 0x00020000
    s_lshl_b32 s48, s70, 11
    s_add_u32 s48, s48, s69
    s_add_u32 s48, s48, 16777216
    s_mul_i32 s33, s31, 28672
    s_add_u32 s33, s33, 40960
    s_lshr_b32 s34, s31, 1
    s_lshl_b32 s34, s34, 5
    s_and_b32 s35, s31, 1
    s_lshl_b32 s35, s35, 2
    s_add_u32 s34, s34, s35
    s_mul_i32 s34, s34, 8192
    s_add_u32 s76, s44, s34
    s_add_u32 s77, s45, s34
    s_mul_i32 s50, s31, 10240
    s_mul_i32 s51, s31, 320
    s_mul_i32 s52, s46, 40960
    s_add_u32 s52, s52, s51
    s_mul_i32 s54, s47, 40960
    s_mov_b32 s53, s50
    s_barrier
    s_add_u32 s34, s52, 0
    s_add_u32 m0, s53, 0
    s_nop 0
    buffer_load_dwordx4 v2, s[16:19], s34 offen lds
    s_add_u32 s34, s52, 20480
    s_add_u32 m0, s53, 1024
    s_nop 0
    buffer_load_dwordx4 v2, s[16:19], s34 offen lds
    s_add_u32 s34, s52, 64
    s_add_u32 m0, s53, 2048
    s_nop 0
    buffer_load_dwordx4 v2, s[16:19], s34 offen lds
    s_add_u32 s34, s52, 20544
    s_add_u32 m0, s53, 3072
    s_nop 0
    buffer_load_dwordx4 v2, s[16:19], s34 offen lds
    s_add_u32 s34, s52, 128
    s_add_u32 m0, s53, 4096
    s_nop 0
    buffer_load_dwordx4 v2, s[16:19], s34 offen lds
    s_add_u32 s34, s52, 20608
    s_add_u32 m0, s53, 5120
    s_nop 0
    buffer_load_dwordx4 v2, s[16:19], s34 offen lds
    s_add_u32 s34, s52, 192
    s_add_u32 m0, s53, 6144
    s_nop 0
    buffer_load_dwordx4 v2, s[16:19], s34 offen lds
    s_add_u32 s34, s52, 20672
    s_add_u32 m0, s53, 7168
    s_nop 0
    buffer_load_dwordx4 v2, s[16:19], s34 offen lds
    s_add_u32 s34, s52, 256
    s_add_u32 m0, s53, 8192
    s_nop 0
    buffer_load_dwordx4 v2, s[16:19], s34 offen lds
    s_add_u32 s34, s52, 20736
    s_add_u32 m0, s53, 9216
    s_nop 0
    buffer_load_dwordx4 v2, s[16:19], s34 offen lds
    v_lshrrev_b32 v4, 8, v0
    v_bfe_u32 v5, v0, 4, 4
    v_lshlrev_b32 v6, 1, v4
    v_xor_b32 v6, v6, v5
    v_xor_b32 v7, 8, v6
    v_mul_u32_u24 v4, 8192, v4
    v_lshl_add_u32 v104, v6, 4, v4
    v_lshl_add_u32 v105, v7, 4, v4
    s_add_u32 s34, s76, 0
    s_add_u32 m0, s33, 0
    s_nop 0
    buffer_load_dwordx4 v104, s[36:39], s34 offen lds
    s_add_u32 s34, s76, 65536
    s_add_u32 m0, s33, 1024
    s_nop 0
    buffer_load_dwordx4 v105, s[36:39], s34 offen lds
    s_add_u32 s34, s76, 131072
    s_add_u32 m0, s33, 2048
    s_nop 0
    buffer_load_dwordx4 v104, s[36:39], s34 offen lds
    s_add_u32 s34, s76, 196608
    s_add_u32 m0, s33, 3072
    s_nop 0
    buffer_load_dwordx4 v105, s[36:39], s34 offen lds
    s_add_u32 s34, s77, 0
    s_add_u32 m0, s33, 4096
    s_nop 0
    buffer_load_dwordx4 v104, s[40:43], s34 offen lds
    s_add_u32 s34, s77, 65536
    s_add_u32 m0, s33, 5120
    s_nop 0
    buffer_load_dwordx4 v105, s[40:43], s34 offen lds
    s_add_u32 s34, s77, 131072
    s_add_u32 m0, s33, 6144
    s_nop 0
    buffer_load_dwordx4 v104, s[40:43], s34 offen lds
    s_add_u32 s34, s77, 196608
    s_add_u32 m0, s33, 7168
    s_nop 0
    buffer_load_dwordx4 v105, s[40:43], s34 offen lds
    s_add_u32 s34, s76, 524288
    s_add_u32 m0, s33, 8192
    s_nop 0
    buffer_load_dwordx4 v104, s[36:39], s34 offen lds
    s_add_u32 s34, s76, 589824
    s_add_u32 m0, s33, 9216
    s_nop 0
    buffer_load_dwordx4 v105, s[36:39], s34 offen lds
    s_add_u32 s34, s76, 655360
    s_add_u32 m0, s33, 10240
    s_nop 0
    buffer_load_dwordx4 v104, s[36:39], s34 offen lds
    s_add_u32 s34, s76, 720896
    s_add_u32 m0, s33, 11264
    s_nop 0
    buffer_load_dwordx4 v105, s[36:39], s34 offen lds
    s_add_u32 s34, s77, 524288
    s_add_u32 m0, s33, 12288
    s_nop 0
    buffer_load_dwordx4 v104, s[40:43], s34 offen lds
    s_add_u32 s34, s77, 589824
    s_add_u32 m0, s33, 13312
    s_nop 0
    buffer_load_dwordx4 v105, s[40:43], s34 offen lds
    s_add_u32 s34, s77, 655360
    s_add_u32 m0, s33, 14336
    s_nop 0
    buffer_load_dwordx4 v104, s[40:43], s34 offen lds
    s_add_u32 s34, s77, 720896
    s_add_u32 m0, s33, 15360
    s_nop 0
    buffer_load_dwordx4 v105, s[40:43], s34 offen lds
    s_add_u32 s34, s76, 1048576
    s_add_u32 m0, s33, 16384
    s_nop 0
    buffer_load_dwordx4 v104, s[36:39], s34 offen lds
    s_add_u32 s34, s76, 1114112
    s_add_u32 m0, s33, 17408
    s_nop 0
    buffer_load_dwordx4 v105, s[36:39], s34 offen lds
    s_add_u32 s34, s76, 1179648
    s_add_u32 m0, s33, 18432
    s_nop 0
    buffer_load_dwordx4 v104, s[36:39], s34 offen lds
    s_add_u32 s34, s76, 1245184
    s_add_u32 m0, s33, 19456
    s_nop 0
    buffer_load_dwordx4 v105, s[36:39], s34 offen lds
    s_add_u32 s34, s77, 1048576
    s_add_u32 m0, s33, 20480
    s_nop 0
    buffer_load_dwordx4 v104, s[40:43], s34 offen lds
    s_add_u32 s34, s77, 1114112
    s_add_u32 m0, s33, 21504
    s_nop 0
    buffer_load_dwordx4 v105, s[40:43], s34 offen lds
    s_add_u32 s34, s77, 1179648
    s_add_u32 m0, s33, 22528
    s_nop 0
    buffer_load_dwordx4 v104, s[40:43], s34 offen lds
    s_add_u32 s34, s77, 1245184
    s_add_u32 m0, s33, 23552
    s_nop 0
    buffer_load_dwordx4 v105, s[40:43], s34 offen lds
    v_lshrrev_b32 v4, 6, v0
    v_and_b32 v5, 7, v4
    v_lshlrev_b32 v5, 1, v5
    v_bfe_u32 v6, v0, 4, 1
    v_lshlrev_b32 v6, 3, v6
    v_lshl_add_u32 v6, v4, 8, v6
    s_lshl_b32 s34, s31, 2
    v_bfe_u32 v7, v0, 5, 1
    v_add_u32 v7, s34, v7
    v_add_u32 v8, 0, v7
    v_xor_b32 v8, v8, v5
    v_lshl_add_u32 v8, v8, 4, v6
    v_add_u32 v96, 40960, v8
    v_add_u32 v97, 69632, v8
    v_add_u32 v98, 98304, v8
    v_add_u32 v99, 126976, v8
    v_add_u32 v8, 2, v7
    v_xor_b32 v8, v8, v5
    v_lshl_add_u32 v8, v8, 4, v6
    v_add_u32 v100, 40960, v8
    v_add_u32 v101, 69632, v8
    v_add_u32 v102, 98304, v8
    v_add_u32 v103, 126976, v8
    s_waitcnt vmcnt(20)
    s_waitcnt lgkmcnt(0)
    s_barrier
    s_add_u32 s34, s76, 1572864
    s_add_u32 m0, s33, 24576
    s_nop 0
    buffer_load_dwordx4 v104, s[36:39], s34 offen lds
    s_add_u32 s34, s76, 1638400
    s_add_u32 m0, s33, 25600
    s_nop 0
    buffer_load_dwordx4 v105, s[36:39], s34 offen lds
    s_add_u32 s34, s76, 1703936
    s_add_u32 m0, s33, 26624
    s_nop 0
    buffer_load_dwordx4 v104, s[36:39], s34 offen lds
    s_add_u32 s34, s76, 1769472
    s_add_u32 m0, s33, 27648
    s_nop 0
    buffer_load_dwordx4 v105, s[36:39], s34 offen lds
    ds_read_b64_tr_b16 a[0:1], v96 offset:0
    ds_read_b64_tr_b16 a[2:3], v97 offset:0
    ds_read_b64_tr_b16 a[4:5], v98 offset:0
    ds_read_b64_tr_b16 a[6:7], v99 offset:0
    ds_read_b64_tr_b16 a[8:9], v100 offset:0
    ds_read_b64_tr_b16 a[10:11], v101 offset:0
    ds_read_b64_tr_b16 a[12:13], v102 offset:0
    ds_read_b64_tr_b16 a[14:15], v103 offset:0
    s_waitcnt vmcnt(20)
    s_waitcnt lgkmcnt(0)
    s_barrier
    s_add_u32 s34, s77, 1572864
    s_add_u32 m0, s33, 0
    s_nop 0
    buffer_load_dwordx4 v104, s[40:43], s34 offen lds
    s_add_u32 s34, s77, 1638400
    s_add_u32 m0, s33, 1024
    s_nop 0
    buffer_load_dwordx4 v105, s[40:43], s34 offen lds
    s_add_u32 s34, s77, 1703936
    s_add_u32 m0, s33, 2048
    s_nop 0
    buffer_load_dwordx4 v104, s[40:43], s34 offen lds
    s_add_u32 s34, s77, 1769472
    s_add_u32 m0, s33, 3072
    s_nop 0
    buffer_load_dwordx4 v105, s[40:43], s34 offen lds
    ds_read_b64_tr_b16 a[16:17], v96 offset:4096
    ds_read_b64_tr_b16 a[18:19], v97 offset:4096
    ds_read_b64_tr_b16 a[20:21], v98 offset:4096
    ds_read_b64_tr_b16 a[22:23], v99 offset:4096
    ds_read_b64_tr_b16 a[24:25], v100 offset:4096
    ds_read_b64_tr_b16 a[26:27], v101 offset:4096
    ds_read_b64_tr_b16 a[28:29], v102 offset:4096
    ds_read_b64_tr_b16 a[30:31], v103 offset:4096
    s_waitcnt vmcnt(20)
    s_waitcnt lgkmcnt(0)
    s_barrier
    s_add_u32 s34, s76, 2097152
    s_add_u32 m0, s33, 4096
    s_nop 0
    buffer_load_dwordx4 v104, s[36:39], s34 offen lds
    s_add_u32 s34, s76, 2162688
    s_add_u32 m0, s33, 5120
    s_nop 0
    buffer_load_dwordx4 v105, s[36:39], s34 offen lds
    s_add_u32 s34, s76, 2228224
    s_add_u32 m0, s33, 6144
    s_nop 0
    buffer_load_dwordx4 v104, s[36:39], s34 offen lds
    s_add_u32 s34, s76, 2293760
    s_add_u32 m0, s33, 7168
    s_nop 0
    buffer_load_dwordx4 v105, s[36:39], s34 offen lds
    ds_read_b64_tr_b16 a[32:33], v96 offset:8192
    ds_read_b64_tr_b16 a[34:35], v97 offset:8192
    ds_read_b64_tr_b16 a[36:37], v98 offset:8192
    ds_read_b64_tr_b16 a[38:39], v99 offset:8192
    ds_read_b64_tr_b16 a[40:41], v100 offset:8192
    ds_read_b64_tr_b16 a[42:43], v101 offset:8192
    ds_read_b64_tr_b16 a[44:45], v102 offset:8192
    ds_read_b64_tr_b16 a[46:47], v103 offset:8192
    s_waitcnt vmcnt(20)
    s_waitcnt lgkmcnt(0)
    s_barrier
    s_add_u32 s34, s77, 2097152
    s_add_u32 m0, s33, 8192
    s_nop 0
    buffer_load_dwordx4 v104, s[40:43], s34 offen lds
    s_add_u32 s34, s77, 2162688
    s_add_u32 m0, s33, 9216
    s_nop 0
    buffer_load_dwordx4 v105, s[40:43], s34 offen lds
    s_add_u32 s34, s77, 2228224
    s_add_u32 m0, s33, 10240
    s_nop 0
    buffer_load_dwordx4 v104, s[40:43], s34 offen lds
    s_add_u32 s34, s77, 2293760
    s_add_u32 m0, s33, 11264
    s_nop 0
    buffer_load_dwordx4 v105, s[40:43], s34 offen lds
    ds_read_b64_tr_b16 a[48:49], v96 offset:12288
    ds_read_b64_tr_b16 a[50:51], v97 offset:12288
    ds_read_b64_tr_b16 a[52:53], v98 offset:12288
    ds_read_b64_tr_b16 a[54:55], v99 offset:12288
    ds_read_b64_tr_b16 a[56:57], v100 offset:12288
    ds_read_b64_tr_b16 a[58:59], v101 offset:12288
    ds_read_b64_tr_b16 a[60:61], v102 offset:12288
    ds_read_b64_tr_b16 a[62:63], v103 offset:12288
    s_waitcnt vmcnt(20)
    s_waitcnt lgkmcnt(0)
    s_barrier
    s_add_u32 s34, s76, 2621440
    s_add_u32 m0, s33, 12288
    s_nop 0
    buffer_load_dwordx4 v104, s[36:39], s34 offen lds
    s_add_u32 s34, s76, 2686976
    s_add_u32 m0, s33, 13312
    s_nop 0
    buffer_load_dwordx4 v105, s[36:39], s34 offen lds
    s_add_u32 s34, s76, 2752512
    s_add_u32 m0, s33, 14336
    s_nop 0
    buffer_load_dwordx4 v104, s[36:39], s34 offen lds
    s_add_u32 s34, s76, 2818048
    s_add_u32 m0, s33, 15360
    s_nop 0
    buffer_load_dwordx4 v105, s[36:39], s34 offen lds
    ds_read_b64_tr_b16 a[64:65], v96 offset:16384
    ds_read_b64_tr_b16 a[66:67], v97 offset:16384
    ds_read_b64_tr_b16 a[68:69], v98 offset:16384
    ds_read_b64_tr_b16 a[70:71], v99 offset:16384
    ds_read_b64_tr_b16 a[72:73], v100 offset:16384
    ds_read_b64_tr_b16 a[74:75], v101 offset:16384
    ds_read_b64_tr_b16 a[76:77], v102 offset:16384
    ds_read_b64_tr_b16 a[78:79], v103 offset:16384
    s_waitcnt vmcnt(20)
    s_waitcnt lgkmcnt(0)
    s_barrier
    s_add_u32 s34, s77, 2621440
    s_add_u32 m0, s33, 16384
    s_nop 0
    buffer_load_dwordx4 v104, s[40:43], s34 offen lds
    s_add_u32 s34, s77, 2686976
    s_add_u32 m0, s33, 17408
    s_nop 0
    buffer_load_dwordx4 v105, s[40:43], s34 offen lds
    s_add_u32 s34, s77, 2752512
    s_add_u32 m0, s33, 18432
    s_nop 0
    buffer_load_dwordx4 v104, s[40:43], s34 offen lds
    s_add_u32 s34, s77, 2818048
    s_add_u32 m0, s33, 19456
    s_nop 0
    buffer_load_dwordx4 v105, s[40:43], s34 offen lds
    ds_read_b64_tr_b16 a[80:81], v96 offset:20480
    ds_read_b64_tr_b16 a[82:83], v97 offset:20480
    ds_read_b64_tr_b16 a[84:85], v98 offset:20480
    ds_read_b64_tr_b16 a[86:87], v99 offset:20480
    ds_read_b64_tr_b16 a[88:89], v100 offset:20480
    ds_read_b64_tr_b16 a[90:91], v101 offset:20480
    ds_read_b64_tr_b16 a[92:93], v102 offset:20480
    ds_read_b64_tr_b16 a[94:95], v103 offset:20480
    s_waitcnt vmcnt(20)
    s_waitcnt lgkmcnt(0)
    s_barrier
    s_add_u32 s34, s76, 3145728
    s_add_u32 m0, s33, 20480
    s_nop 0
    buffer_load_dwordx4 v104, s[36:39], s34 offen lds
    s_add_u32 s34, s76, 3211264
    s_add_u32 m0, s33, 21504
    s_nop 0
    buffer_load_dwordx4 v105, s[36:39], s34 offen lds
    s_add_u32 s34, s76, 3276800
    s_add_u32 m0, s33, 22528
    s_nop 0
    buffer_load_dwordx4 v104, s[36:39], s34 offen lds
    s_add_u32 s34, s76, 3342336
    s_add_u32 m0, s33, 23552
    s_nop 0
    buffer_load_dwordx4 v105, s[36:39], s34 offen lds
    ds_read_b64_tr_b16 a[96:97], v96 offset:24576
    ds_read_b64_tr_b16 a[98:99], v97 offset:24576
    ds_read_b64_tr_b16 a[100:101], v98 offset:24576
    ds_read_b64_tr_b16 a[102:103], v99 offset:24576
    ds_read_b64_tr_b16 a[104:105], v100 offset:24576
    ds_read_b64_tr_b16 a[106:107], v101 offset:24576
    ds_read_b64_tr_b16 a[108:109], v102 offset:24576
    ds_read_b64_tr_b16 a[110:111], v103 offset:24576
    s_waitcnt vmcnt(20)
    s_waitcnt lgkmcnt(0)
    s_barrier
    s_add_u32 s34, s77, 3145728
    s_add_u32 m0, s33, 24576
    s_nop 0
    buffer_load_dwordx4 v104, s[40:43], s34 offen lds
    s_add_u32 s34, s77, 3211264
    s_add_u32 m0, s33, 25600
    s_nop 0
    buffer_load_dwordx4 v105, s[40:43], s34 offen lds
    s_add_u32 s34, s77, 3276800
    s_add_u32 m0, s33, 26624
    s_nop 0
    buffer_load_dwordx4 v104, s[40:43], s34 offen lds
    s_add_u32 s34, s77, 3342336
    s_add_u32 m0, s33, 27648
    s_nop 0
    buffer_load_dwordx4 v105, s[40:43], s34 offen lds
    ds_read_b64_tr_b16 a[112:113], v96 offset:0
    ds_read_b64_tr_b16 a[114:115], v97 offset:0
    ds_read_b64_tr_b16 a[116:117], v98 offset:0
    ds_read_b64_tr_b16 a[118:119], v99 offset:0
    ds_read_b64_tr_b16 a[120:121], v100 offset:0
    ds_read_b64_tr_b16 a[122:123], v101 offset:0
    ds_read_b64_tr_b16 a[124:125], v102 offset:0
    ds_read_b64_tr_b16 a[126:127], v103 offset:0
    s_waitcnt vmcnt(20)
    s_waitcnt lgkmcnt(0)
    s_barrier
    s_add_u32 s34, s76, 3670016
    s_add_u32 m0, s33, 0
    s_nop 0
    buffer_load_dwordx4 v104, s[36:39], s34 offen lds
    s_add_u32 s34, s76, 3735552
    s_add_u32 m0, s33, 1024
    s_nop 0
    buffer_load_dwordx4 v105, s[36:39], s34 offen lds
    s_add_u32 s34, s76, 3801088
    s_add_u32 m0, s33, 2048
    s_nop 0
    buffer_load_dwordx4 v104, s[36:39], s34 offen lds
    s_add_u32 s34, s76, 3866624
    s_add_u32 m0, s33, 3072
    s_nop 0
    buffer_load_dwordx4 v105, s[36:39], s34 offen lds
    ds_read_b64_tr_b16 a[128:129], v96 offset:4096
    ds_read_b64_tr_b16 a[130:131], v97 offset:4096
    ds_read_b64_tr_b16 a[132:133], v98 offset:4096
    ds_read_b64_tr_b16 a[134:135], v99 offset:4096
    ds_read_b64_tr_b16 a[136:137], v100 offset:4096
    ds_read_b64_tr_b16 a[138:139], v101 offset:4096
    ds_read_b64_tr_b16 a[140:141], v102 offset:4096
    ds_read_b64_tr_b16 a[142:143], v103 offset:4096
    s_waitcnt vmcnt(20)
    s_waitcnt lgkmcnt(0)
    s_barrier
    s_add_u32 s34, s77, 3670016
    s_add_u32 m0, s33, 4096
    s_nop 0
    buffer_load_dwordx4 v104, s[40:43], s34 offen lds
    s_add_u32 s34, s77, 3735552
    s_add_u32 m0, s33, 5120
    s_nop 0
    buffer_load_dwordx4 v105, s[40:43], s34 offen lds
    s_add_u32 s34, s77, 3801088
    s_add_u32 m0, s33, 6144
    s_nop 0
    buffer_load_dwordx4 v104, s[40:43], s34 offen lds
    s_add_u32 s34, s77, 3866624
    s_add_u32 m0, s33, 7168
    s_nop 0
    buffer_load_dwordx4 v105, s[40:43], s34 offen lds
    ds_read_b64_tr_b16 a[144:145], v96 offset:8192
    ds_read_b64_tr_b16 a[146:147], v97 offset:8192
    ds_read_b64_tr_b16 a[148:149], v98 offset:8192
    ds_read_b64_tr_b16 a[150:151], v99 offset:8192
    ds_read_b64_tr_b16 a[152:153], v100 offset:8192
    ds_read_b64_tr_b16 a[154:155], v101 offset:8192
    ds_read_b64_tr_b16 a[156:157], v102 offset:8192
    ds_read_b64_tr_b16 a[158:159], v103 offset:8192
    s_waitcnt vmcnt(20)
    s_waitcnt lgkmcnt(0)
    s_barrier
    s_add_u32 s34, s76, 4194304
    s_add_u32 m0, s33, 8192
    s_nop 0
    buffer_load_dwordx4 v104, s[36:39], s34 offen lds
    s_add_u32 s34, s76, 4259840
    s_add_u32 m0, s33, 9216
    s_nop 0
    buffer_load_dwordx4 v105, s[36:39], s34 offen lds
    s_add_u32 s34, s76, 4325376
    s_add_u32 m0, s33, 10240
    s_nop 0
    buffer_load_dwordx4 v104, s[36:39], s34 offen lds
    s_add_u32 s34, s76, 4390912
    s_add_u32 m0, s33, 11264
    s_nop 0
    buffer_load_dwordx4 v105, s[36:39], s34 offen lds
    ds_read_b64_tr_b16 a[160:161], v96 offset:12288
    ds_read_b64_tr_b16 a[162:163], v97 offset:12288
    ds_read_b64_tr_b16 a[164:165], v98 offset:12288
    ds_read_b64_tr_b16 a[166:167], v99 offset:12288
    ds_read_b64_tr_b16 a[168:169], v100 offset:12288
    ds_read_b64_tr_b16 a[170:171], v101 offset:12288
    ds_read_b64_tr_b16 a[172:173], v102 offset:12288
    ds_read_b64_tr_b16 a[174:175], v103 offset:12288
    s_waitcnt vmcnt(20)
    s_waitcnt lgkmcnt(0)
    s_barrier
    s_add_u32 s34, s77, 4194304
    s_add_u32 m0, s33, 12288
    s_nop 0
    buffer_load_dwordx4 v104, s[40:43], s34 offen lds
    s_add_u32 s34, s77, 4259840
    s_add_u32 m0, s33, 13312
    s_nop 0
    buffer_load_dwordx4 v105, s[40:43], s34 offen lds
    s_add_u32 s34, s77, 4325376
    s_add_u32 m0, s33, 14336
    s_nop 0
    buffer_load_dwordx4 v104, s[40:43], s34 offen lds
    s_add_u32 s34, s77, 4390912
    s_add_u32 m0, s33, 15360
    s_nop 0
    buffer_load_dwordx4 v105, s[40:43], s34 offen lds
    ds_read_b64_tr_b16 a[176:177], v96 offset:16384
    ds_read_b64_tr_b16 a[178:179], v97 offset:16384
    ds_read_b64_tr_b16 a[180:181], v98 offset:16384
    ds_read_b64_tr_b16 a[182:183], v99 offset:16384
    ds_read_b64_tr_b16 a[184:185], v100 offset:16384
    ds_read_b64_tr_b16 a[186:187], v101 offset:16384
    ds_read_b64_tr_b16 a[188:189], v102 offset:16384
    ds_read_b64_tr_b16 a[190:191], v103 offset:16384
    s_waitcnt vmcnt(20)
    s_waitcnt lgkmcnt(0)
    s_barrier
    s_add_u32 s34, s76, 4718592
    s_add_u32 m0, s33, 16384
    s_nop 0
    buffer_load_dwordx4 v104, s[36:39], s34 offen lds
    s_add_u32 s34, s76, 4784128
    s_add_u32 m0, s33, 17408
    s_nop 0
    buffer_load_dwordx4 v105, s[36:39], s34 offen lds
    s_add_u32 s34, s76, 4849664
    s_add_u32 m0, s33, 18432
    s_nop 0
    buffer_load_dwordx4 v104, s[36:39], s34 offen lds
    s_add_u32 s34, s76, 4915200
    s_add_u32 m0, s33, 19456
    s_nop 0
    buffer_load_dwordx4 v105, s[36:39], s34 offen lds
    ds_read_b64_tr_b16 a[192:193], v96 offset:20480
    ds_read_b64_tr_b16 a[194:195], v97 offset:20480
    ds_read_b64_tr_b16 a[196:197], v98 offset:20480
    ds_read_b64_tr_b16 a[198:199], v99 offset:20480
    ds_read_b64_tr_b16 a[200:201], v100 offset:20480
    ds_read_b64_tr_b16 a[202:203], v101 offset:20480
    ds_read_b64_tr_b16 a[204:205], v102 offset:20480
    ds_read_b64_tr_b16 a[206:207], v103 offset:20480
    s_waitcnt vmcnt(20)
    s_waitcnt lgkmcnt(0)
    s_barrier
    s_add_u32 s34, s77, 4718592
    s_add_u32 m0, s33, 20480
    s_nop 0
    buffer_load_dwordx4 v104, s[40:43], s34 offen lds
    s_add_u32 s34, s77, 4784128
    s_add_u32 m0, s33, 21504
    s_nop 0
    buffer_load_dwordx4 v105, s[40:43], s34 offen lds
    s_add_u32 s34, s77, 4849664
    s_add_u32 m0, s33, 22528
    s_nop 0
    buffer_load_dwordx4 v104, s[40:43], s34 offen lds
    s_add_u32 s34, s77, 4915200
    s_add_u32 m0, s33, 23552
    s_nop 0
    buffer_load_dwordx4 v105, s[40:43], s34 offen lds
    ds_read_b64_tr_b16 a[208:209], v96 offset:24576
    ds_read_b64_tr_b16 a[210:211], v97 offset:24576
    ds_read_b64_tr_b16 a[212:213], v98 offset:24576
    ds_read_b64_tr_b16 a[214:215], v99 offset:24576
    ds_read_b64_tr_b16 a[216:217], v100 offset:24576
    ds_read_b64_tr_b16 a[218:219], v101 offset:24576
    ds_read_b64_tr_b16 a[220:221], v102 offset:24576
    ds_read_b64_tr_b16 a[222:223], v103 offset:24576
    s_waitcnt vmcnt(20)
    s_waitcnt lgkmcnt(0)
    s_barrier
    ds_read_b64_tr_b16 a[224:225], v96 offset:0
    ds_read_b64_tr_b16 a[226:227], v97 offset:0
    ds_read_b64_tr_b16 a[228:229], v98 offset:0
    ds_read_b64_tr_b16 a[230:231], v99 offset:0
    ds_read_b64_tr_b16 a[232:233], v100 offset:0
    ds_read_b64_tr_b16 a[234:235], v101 offset:0
    ds_read_b64_tr_b16 a[236:237], v102 offset:0
    ds_read_b64_tr_b16 a[238:239], v103 offset:0
    s_waitcnt vmcnt(16)
    s_waitcnt lgkmcnt(0)
    s_barrier
    ds_read_b64_tr_b16 a[240:241], v96 offset:4096
    ds_read_b64_tr_b16 a[242:243], v97 offset:4096
    ds_read_b64_tr_b16 a[244:245], v98 offset:4096
    ds_read_b64_tr_b16 a[246:247], v99 offset:4096
    ds_read_b64_tr_b16 a[248:249], v100 offset:4096
    ds_read_b64_tr_b16 a[250:251], v101 offset:4096
    ds_read_b64_tr_b16 a[252:253], v102 offset:4096
    ds_read_b64_tr_b16 a[254:255], v103 offset:4096
    s_waitcnt vmcnt(12)
    s_waitcnt lgkmcnt(0)
    s_barrier
    ds_read_b64_tr_b16 v[192:193], v96 offset:8192
    ds_read_b64_tr_b16 v[194:195], v97 offset:8192
    ds_read_b64_tr_b16 v[196:197], v98 offset:8192
    ds_read_b64_tr_b16 v[198:199], v99 offset:8192
    ds_read_b64_tr_b16 v[200:201], v100 offset:8192
    ds_read_b64_tr_b16 v[202:203], v101 offset:8192
    ds_read_b64_tr_b16 v[204:205], v102 offset:8192
    ds_read_b64_tr_b16 v[206:207], v103 offset:8192
    s_waitcnt vmcnt(8)
    s_waitcnt lgkmcnt(0)
    s_barrier
    ds_read_b64_tr_b16 v[208:209], v96 offset:12288
    ds_read_b64_tr_b16 v[210:211], v97 offset:12288
    ds_read_b64_tr_b16 v[212:213], v98 offset:12288
    ds_read_b64_tr_b16 v[214:215], v99 offset:12288
    ds_read_b64_tr_b16 v[216:217], v100 offset:12288
    ds_read_b64_tr_b16 v[218:219], v101 offset:12288
    ds_read_b64_tr_b16 v[220:221], v102 offset:12288
    ds_read_b64_tr_b16 v[222:223], v103 offset:12288
    s_waitcnt vmcnt(4)
    s_waitcnt lgkmcnt(0)
    s_barrier
    ds_read_b64_tr_b16 v[224:225], v96 offset:16384
    ds_read_b64_tr_b16 v[226:227], v97 offset:16384
    ds_read_b64_tr_b16 v[228:229], v98 offset:16384
    ds_read_b64_tr_b16 v[230:231], v99 offset:16384
    ds_read_b64_tr_b16 v[232:233], v100 offset:16384
    ds_read_b64_tr_b16 v[234:235], v101 offset:16384
    ds_read_b64_tr_b16 v[236:237], v102 offset:16384
    ds_read_b64_tr_b16 v[238:239], v103 offset:16384
    s_waitcnt vmcnt(0)
    s_waitcnt lgkmcnt(0)
    s_barrier
    ds_read_b64_tr_b16 v[240:241], v96 offset:20480
    ds_read_b64_tr_b16 v[242:243], v97 offset:20480
    ds_read_b64_tr_b16 v[244:245], v98 offset:20480
    ds_read_b64_tr_b16 v[246:247], v99 offset:20480
    ds_read_b64_tr_b16 v[248:249], v100 offset:20480
    ds_read_b64_tr_b16 v[250:251], v101 offset:20480
    ds_read_b64_tr_b16 v[252:253], v102 offset:20480
    ds_read_b64_tr_b16 v[254:255], v103 offset:20480
    s_waitcnt vmcnt(0) lgkmcnt(0)
    s_barrier
    s_add_u32 s52, s52, s54
    s_add_u32 s53, s50, 40960
    s_add_u32 s34, s52, 0
    s_add_u32 m0, s53, 0
    s_nop 0
    buffer_load_dwordx4 v2, s[16:19], s34 offen lds
    s_add_u32 s34, s52, 20480
    s_add_u32 m0, s53, 1024
    s_nop 0
    buffer_load_dwordx4 v2, s[16:19], s34 offen lds
    s_add_u32 s34, s52, 64
    s_add_u32 m0, s53, 2048
    s_nop 0
    buffer_load_dwordx4 v2, s[16:19], s34 offen lds
    s_add_u32 s34, s52, 20544
    s_add_u32 m0, s53, 3072
    s_nop 0
    buffer_load_dwordx4 v2, s[16:19], s34 offen lds
    s_add_u32 s34, s52, 128
    s_add_u32 m0, s53, 4096
    s_nop 0
    buffer_load_dwordx4 v2, s[16:19], s34 offen lds
    s_add_u32 s34, s52, 20608
    s_add_u32 m0, s53, 5120
    s_nop 0
    buffer_load_dwordx4 v2, s[16:19], s34 offen lds
    s_add_u32 s34, s52, 192
    s_add_u32 m0, s53, 6144
    s_nop 0
    buffer_load_dwordx4 v2, s[16:19], s34 offen lds
    s_add_u32 s34, s52, 20672
    s_add_u32 m0, s53, 7168
    s_nop 0
    buffer_load_dwordx4 v2, s[16:19], s34 offen lds
    s_add_u32 s34, s52, 256
    s_add_u32 m0, s53, 8192
    s_nop 0
    buffer_load_dwordx4 v2, s[16:19], s34 offen lds
    s_add_u32 s34, s52, 20736
    s_add_u32 m0, s53, 9216
    s_nop 0
    buffer_load_dwordx4 v2, s[16:19], s34 offen lds
    s_add_u32 s52, s52, s54
    s_add_u32 s53, s50, 81920
    s_mov_b32 s55, 0
    s_mul_i32 s56, s46, 262144
    s_add_u32 s56, s56, s48
    s_mul_i32 s57, s47, 262144
LV_tile:
    v_add_u32 v13, s55, v3
    ds_read_b128 v[48:51], v13 offset:0
    ds_read_b128 v[52:55], v13 offset:1024
    ds_read_b128 v[56:59], v13 offset:2048
    ds_read_b128 v[60:63], v13 offset:3072
    ds_read_b128 v[64:67], v13 offset:4096
    ds_read_b128 v[68:71], v13 offset:5120
    s_waitcnt lgkmcnt(5)
    v_mfma_f32_16x16x32_bf16 v[16:19], v[48:51], a[0:3], 0
    ds_read_b128 v[72:75], v13 offset:6144
    ds_read_b128 v[76:79], v13 offset:7168
    s_waitcnt lgkmcnt(6)
    v_mfma_f32_16x16x32_bf16 v[32:35], v[52:55], a[0:3], 0
    v_mfma_f32_16x16x32_bf16 v[20:23], v[48:51], a[8:11], 0
    v_mfma_f32_16x16x32_bf16 v[36:39], v[52:55], a[8:11], 0
    v_mfma_f32_16x16x32_bf16 v[24:27], v[48:51], a[16:19], 0
    v_mfma_f32_16x16x32_bf16 v[40:43], v[52:55], a[16:19], 0
    v_mfma_f32_16x16x32_bf16 v[28:31], v[48:51], a[24:27], 0
    v_mfma_f32_16x16x32_bf16 v[44:47], v[52:55], a[24:27], 0
    s_waitcnt lgkmcnt(5)
    v_mfma_f32_16x16x32_bf16 v[16:19], v[56:59], a[4:7], v[16:19]
    ds_read_b128 v[48:51], v13 offset:8192
    ds_read_b128 v[52:55], v13 offset:9216
    s_waitcnt lgkmcnt(6)
    v_mfma_f32_16x16x32_bf16 v[32:35], v[60:63], a[4:7], v[32:35]
    v_mfma_f32_16x16x32_bf16 v[20:23], v[56:59], a[12:15], v[20:23]
    v_mfma_f32_16x16x32_bf16 v[36:39], v[60:63], a[12:15], v[36:39]
    s_add_u32 s34, s52, 0
    s_add_u32 m0, s53, 0
    s_nop 0
    buffer_load_dwordx4 v2, s[16:19], s34 offen lds
    v_mfma_f32_16x16x32_bf16 v[24:27], v[56:59], a[20:23], v[24:27]
    v_mfma_f32_16x16x32_bf16 v[40:43], v[60:63], a[20:23], v[40:43]
    v_mfma_f32_16x16x32_bf16 v[28:31], v[56:59], a[28:31], v[28:31]
    v_mfma_f32_16x16x32_bf16 v[44:47], v[60:63], a[28:31], v[44:47]
    s_waitcnt lgkmcnt(5)
    v_mfma_f32_16x16x32_bf16 v[16:19], v[64:67], a[32:35], v[16:19]
    ds_read_b128 v[56:59], v13 offset:10240
    ds_read_b128 v[60:63], v13 offset:11264
    s_waitcnt lgkmcnt(6)
    v_mfma_f32_16x16x32_bf16 v[32:35], v[68:71], a[32:35], v[32:35]
    v_mfma_f32_16x16x32_bf16 v[20:23], v[64:67], a[40:43], v[20:23]
    v_mfma_f32_16x16x32_bf16 v[36:39], v[68:71], a[40:43], v[36:39]
    s_add_u32 s34, s52, 20480
    s_add_u32 m0, s53, 1024
    s_nop 0
    buffer_load_dwordx4 v2, s[16:19], s34 offen lds
    v_mfma_f32_16x16x32_bf16 v[24:27], v[64:67], a[48:51], v[24:27]
    v_mfma_f32_16x16x32_bf16 v[40:43], v[68:71], a[48:51], v[40:43]
    v_mfma_f32_16x16x32_bf16 v[28:31], v[64:67], a[56:59], v[28:31]
    v_mfma_f32_16x16x32_bf16 v[44:47], v[68:71], a[56:59], v[44:47]
    s_waitcnt lgkmcnt(5)
    v_mfma_f32_16x16x32_bf16 v[16:19], v[72:75], a[36:39], v[16:19]
    ds_read_b128 v[64:67], v13 offset:12288
    ds_read_b128 v[68:71], v13 offset:13312
    s_waitcnt lgkmcnt(6)
    v_mfma_f32_16x16x32_bf16 v[32:35], v[76:79], a[36:39], v[32:35]
    v_mfma_f32_16x16x32_bf16 v[20:23], v[72:75], a[44:47], v[20:23]
    v_mfma_f32_16x16x32_bf16 v[36:39], v[76:79], a[44:47], v[36:39]
    s_add_u32 s34, s52, 64
    s_add_u32 m0, s53, 2048
    s_nop 0
    buffer_load_dwordx4 v2, s[16:19], s34 offen lds
    v_mfma_f32_16x16x32_bf16 v[24:27], v[72:75], a[52:55], v[24:27]
    v_mfma_f32_16x16x32_bf16 v[40:43], v[76:79], a[52:55], v[40:43]
    v_mfma_f32_16x16x32_bf16 v[28:31], v[72:75], a[60:63], v[28:31]
    v_mfma_f32_16x16x32_bf16 v[44:47], v[76:79], a[60:63], v[44:47]
    s_waitcnt lgkmcnt(5)
    v_mfma_f32_16x16x32_bf16 v[16:19], v[48:51], a[64:67], v[16:19]
    ds_read_b128 v[72:75], v13 offset:14336
    ds_read_b128 v[76:79], v13 offset:15360
    s_waitcnt lgkmcnt(6)
    v_mfma_f32_16x16x32_bf16 v[32:35], v[52:55], a[64:67], v[32:35]
    v_mfma_f32_16x16x32_bf16 v[20:23], v[48:51], a[72:75], v[20:23]
    v_mfma_f32_16x16x32_bf16 v[36:39], v[52:55], a[72:75], v[36:39]
    s_add_u32 s34, s52, 20544
    s_add_u32 m0, s53, 3072
    s_nop 0
    buffer_load_dwordx4 v2, s[16:19], s34 offen lds
    v_mfma_f32_16x16x32_bf16 v[24:27], v[48:51], a[80:83], v[24:27]
    v_mfma_f32_16x16x32_bf16 v[40:43], v[52:55], a[80:83], v[40:43]
    v_mfma_f32_16x16x32_bf16 v[28:31], v[48:51], a[88:91], v[28:31]
    v_mfma_f32_16x16x32_bf16 v[44:47], v[52:55], a[88:91], v[44:47]
    s_waitcnt lgkmcnt(5)
    v_mfma_f32_16x16x32_bf16 v[16:19], v[56:59], a[68:71], v[16:19]
    ds_read_b128 v[48:51], v13 offset:16384
    ds_read_b128 v[52:55], v13 offset:17408
    s_waitcnt lgkmcnt(6)
    v_mfma_f32_16x16x32_bf16 v[32:35], v[60:63], a[68:71], v[32:35]
    v_mfma_f32_16x16x32_bf16 v[20:23], v[56:59], a[76:79], v[20:23]
    v_mfma_f32_16x16x32_bf16 v[36:39], v[60:63], a[76:79], v[36:39]
    s_add_u32 s34, s52, 128
    s_add_u32 m0, s53, 4096
    s_nop 0
    buffer_load_dwordx4 v2, s[16:19], s34 offen lds
    v_mfma_f32_16x16x32_bf16 v[24:27], v[56:59], a[84:87], v[24:27]
    v_mfma_f32_16x16x32_bf16 v[40:43], v[60:63], a[84:87], v[40:43]
    v_mfma_f32_16x16x32_bf16 v[28:31], v[56:59], a[92:95], v[28:31]
    v_mfma_f32_16x16x32_bf16 v[44:47], v[60:63], a[92:95], v[44:47]
    s_waitcnt lgkmcnt(5)
    v_mfma_f32_16x16x32_bf16 v[16:19], v[64:67], a[96:99], v[16:19]
    ds_read_b128 v[56:59], v13 offset:18432
    ds_read_b128 v[60:63], v13 offset:19456
    s_waitcnt lgkmcnt(6)
    v_mfma_f32_16x16x32_bf16 v[32:35], v[68:71], a[96:99], v[32:35]
    v_mfma_f32_16x16x32_bf16 v[20:23], v[64:67], a[104:107], v[20:23]
    v_mfma_f32_16x16x32_bf16 v[36:39], v[68:71], a[104:107], v[36:39]
    s_add_u32 s34, s52, 20608
    s_add_u32 m0, s53, 5120
    s_nop 0
    buffer_load_dwordx4 v2, s[16:19], s34 offen lds
    v_mfma_f32_16x16x32_bf16 v[24:27], v[64:67], a[112:115], v[24:27]
    v_mfma_f32_16x16x32_bf16 v[40:43], v[68:71], a[112:115], v[40:43]
    v_mfma_f32_16x16x32_bf16 v[28:31], v[64:67], a[120:123], v[28:31]
    v_mfma_f32_16x16x32_bf16 v[44:47], v[68:71], a[120:123], v[44:47]
    s_waitcnt lgkmcnt(5)
    v_mfma_f32_16x16x32_bf16 v[16:19], v[72:75], a[100:103], v[16:19]
    ds_read_b128 v[64:67], v13 offset:20480
    ds_read_b128 v[68:71], v13 offset:21504
    s_waitcnt lgkmcnt(6)
    v_mfma_f32_16x16x32_bf16 v[32:35], v[76:79], a[100:103], v[32:35]
    v_mfma_f32_16x16x32_bf16 v[20:23], v[72:75], a[108:111], v[20:23]
    v_mfma_f32_16x16x32_bf16 v[36:39], v[76:79], a[108:111], v[36:39]
    s_add_u32 s34, s52, 192
    s_add_u32 m0, s53, 6144
    s_nop 0
    buffer_load_dwordx4 v2, s[16:19], s34 offen lds
    v_mfma_f32_16x16x32_bf16 v[24:27], v[72:75], a[116:119], v[24:27]
    v_mfma_f32_16x16x32_bf16 v[40:43], v[76:79], a[116:119], v[40:43]
    v_mfma_f32_16x16x32_bf16 v[28:31], v[72:75], a[124:127], v[28:31]
    v_mfma_f32_16x16x32_bf16 v[44:47], v[76:79], a[124:127], v[44:47]
    s_waitcnt lgkmcnt(5)
    v_mfma_f32_16x16x32_bf16 v[16:19], v[48:51], a[128:131], v[16:19]
    ds_read_b128 v[72:75], v13 offset:22528
    ds_read_b128 v[76:79], v13 offset:23552
    s_waitcnt lgkmcnt(6)
    v_mfma_f32_16x16x32_bf16 v[32:35], v[52:55], a[128:131], v[32:35]
    v_mfma_f32_16x16x32_bf16 v[20:23], v[48:51], a[136:139], v[20:23]
    v_mfma_f32_16x16x32_bf16 v[36:39], v[52:55], a[136:139], v[36:39]
    s_add_u32 s34, s52, 20672
    s_add_u32 m0, s53, 7168
    s_nop 0
    buffer_load_dwordx4 v2, s[16:19], s34 offen lds
    v_mfma_f32_16x16x32_bf16 v[24:27], v[48:51], a[144:147], v[24:27]
    v_mfma_f32_16x16x32_bf16 v[40:43], v[52:55], a[144:147], v[40:43]
    v_mfma_f32_16x16x32_bf16 v[28:31], v[48:51], a[152:155], v[28:31]
    v_mfma_f32_16x16x32_bf16 v[44:47], v[52:55], a[152:155], v[44:47]
    s_waitcnt lgkmcnt(5)
    v_mfma_f32_16x16x32_bf16 v[16:19], v[56:59], a[132:135], v[16:19]
    ds_read_b128 v[48:51], v13 offset:24576
    ds_read_b128 v[52:55], v13 offset:25600
    s_waitcnt lgkmcnt(6)
    v_mfma_f32_16x16x32_bf16 v[32:35], v[60:63], a[132:135], v[32:35]
    v_mfma_f32_16x16x32_bf16 v[20:23], v[56:59], a[140:143], v[20:23]
    v_mfma_f32_16x16x32_bf16 v[36:39], v[60:63], a[140:143], v[36:39]
    s_add_u32 s34, s52, 256
    s_add_u32 m0, s53, 8192
    s_nop 0
    buffer_load_dwordx4 v2, s[16:19], s34 offen lds
    v_mfma_f32_16x16x32_bf16 v[24:27], v[56:59], a[148:151], v[24:27]
    v_mfma_f32_16x16x32_bf16 v[40:43], v[60:63], a[148:151], v[40:43]
    v_mfma_f32_16x16x32_bf16 v[28:31], v[56:59], a[156:159], v[28:31]
    v_mfma_f32_16x16x32_bf16 v[44:47], v[60:63], a[156:159], v[44:47]
    s_waitcnt lgkmcnt(5)
    v_mfma_f32_16x16x32_bf16 v[16:19], v[64:67], a[160:163], v[16:19]
    ds_read_b128 v[56:59], v13 offset:26624
    ds_read_b128 v[60:63], v13 offset:27648
    s_waitcnt lgkmcnt(6)
    v_mfma_f32_16x16x32_bf16 v[32:35], v[68:71], a[160:163], v[32:35]
    v_mfma_f32_16x16x32_bf16 v[20:23], v[64:67], a[168:171], v[20:23]
    v_mfma_f32_16x16x32_bf16 v[36:39], v[68:71], a[168:171], v[36:39]
    s_add_u32 s34, s52, 20736
    s_add_u32 m0, s53, 9216
    s_nop 0
    buffer_load_dwordx4 v2, s[16:19], s34 offen lds
    v_mfma_f32_16x16x32_bf16 v[24:27], v[64:67], a[176:179], v[24:27]
    v_mfma_f32_16x16x32_bf16 v[40:43], v[68:71], a[176:179], v[40:43]
    v_mfma_f32_16x16x32_bf16 v[28:31], v[64:67], a[184:187], v[28:31]
    v_mfma_f32_16x16x32_bf16 v[44:47], v[68:71], a[184:187], v[44:47]
    s_waitcnt lgkmcnt(5)
    v_mfma_f32_16x16x32_bf16 v[16:19], v[72:75], a[164:167], v[16:19]
    ds_read_b128 v[64:67], v13 offset:28672
    ds_read_b128 v[68:71], v13 offset:29696
    s_waitcnt lgkmcnt(6)
    v_mfma_f32_16x16x32_bf16 v[32:35], v[76:79], a[164:167], v[32:35]
    v_mfma_f32_16x16x32_bf16 v[20:23], v[72:75], a[172:175], v[20:23]
    v_mfma_f32_16x16x32_bf16 v[36:39], v[76:79], a[172:175], v[36:39]
    v_mfma_f32_16x16x32_bf16 v[24:27], v[72:75], a[180:183], v[24:27]
    v_mfma_f32_16x16x32_bf16 v[40:43], v[76:79], a[180:183], v[40:43]
    v_mfma_f32_16x16x32_bf16 v[28:31], v[72:75], a[188:191], v[28:31]
    v_mfma_f32_16x16x32_bf16 v[44:47], v[76:79], a[188:191], v[44:47]
    s_waitcnt lgkmcnt(5)
    v_mfma_f32_16x16x32_bf16 v[16:19], v[48:51], a[192:195], v[16:19]
    ds_read_b128 v[72:75], v13 offset:30720
    ds_read_b128 v[76:79], v13 offset:31744
    s_waitcnt lgkmcnt(6)
    v_mfma_f32_16x16x32_bf16 v[32:35], v[52:55], a[192:195], v[32:35]
    v_mfma_f32_16x16x32_bf16 v[20:23], v[48:51], a[200:203], v[20:23]
    v_mfma_f32_16x16x32_bf16 v[36:39], v[52:55], a[200:203], v[36:39]
    v_mfma_f32_16x16x32_bf16 v[24:27], v[48:51], a[208:211], v[24:27]
    v_mfma_f32_16x16x32_bf16 v[40:43], v[52:55], a[208:211], v[40:43]
    v_mfma_f32_16x16x32_bf16 v[28:31], v[48:51], a[216:219], v[28:31]
    v_mfma_f32_16x16x32_bf16 v[44:47], v[52:55], a[216:219], v[44:47]
    s_waitcnt lgkmcnt(5)
    v_mfma_f32_16x16x32_bf16 v[16:19], v[56:59], a[196:199], v[16:19]
    ds_read_b128 v[48:51], v13 offset:32768
    ds_read_b128 v[52:55], v13 offset:33792
    s_waitcnt lgkmcnt(6)
    v_mfma_f32_16x16x32_bf16 v[32:35], v[60:63], a[196:199], v[32:35]
    v_mfma_f32_16x16x32_bf16 v[20:23], v[56:59], a[204:207], v[20:23]
    v_mfma_f32_16x16x32_bf16 v[36:39], v[60:63], a[204:207], v[36:39]
    v_mfma_f32_16x16x32_bf16 v[24:27], v[56:59], a[212:215], v[24:27]
    v_mfma_f32_16x16x32_bf16 v[40:43], v[60:63], a[212:215], v[40:43]
    v_mfma_f32_16x16x32_bf16 v[28:31], v[56:59], a[220:223], v[28:31]
    v_mfma_f32_16x16x32_bf16 v[44:47], v[60:63], a[220:223], v[44:47]
    s_waitcnt lgkmcnt(5)
    v_mfma_f32_16x16x32_bf16 v[16:19], v[64:67], a[224:227], v[16:19]
    ds_read_b128 v[56:59], v13 offset:34816
    ds_read_b128 v[60:63], v13 offset:35840
    s_waitcnt lgkmcnt(6)
    v_mfma_f32_16x16x32_bf16 v[32:35], v[68:71], a[224:227], v[32:35]
    v_mfma_f32_16x16x32_bf16 v[20:23], v[64:67], a[232:235], v[20:23]
    v_mfma_f32_16x16x32_bf16 v[36:39], v[68:71], a[232:235], v[36:39]
    v_mfma_f32_16x16x32_bf16 v[24:27], v[64:67], a[240:243], v[24:27]
    v_mfma_f32_16x16x32_bf16 v[40:43], v[68:71], a[240:243], v[40:43]
    v_mfma_f32_16x16x32_bf16 v[28:31], v[64:67], a[248:251], v[28:31]
    v_mfma_f32_16x16x32_bf16 v[44:47], v[68:71], a[248:251], v[44:47]
    s_waitcnt lgkmcnt(5)
    v_mfma_f32_16x16x32_bf16 v[16:19], v[72:75], a[228:231], v[16:19]
    ds_read_b128 v[64:67], v13 offset:36864
    ds_read_b128 v[68:71], v13 offset:37888
    s_waitcnt lgkmcnt(6)
    v_mfma_f32_16x16x32_bf16 v[32:35], v[76:79], a[228:231], v[32:35]
    v_mfma_f32_16x16x32_bf16 v[20:23], v[72:75], a[236:239], v[20:23]
    v_mfma_f32_16x16x32_bf16 v[36:39], v[76:79], a[236:239], v[36:39]
    v_mfma_f32_16x16x32_bf16 v[24:27], v[72:75], a[244:247], v[24:27]
    v_mfma_f32_16x16x32_bf16 v[40:43], v[76:79], a[244:247], v[40:43]
    v_mfma_f32_16x16x32_bf16 v[28:31], v[72:75], a[252:255], v[28:31]
    v_mfma_f32_16x16x32_bf16 v[44:47], v[76:79], a[252:255], v[44:47]
    s_waitcnt lgkmcnt(5)
    v_mfma_f32_16x16x32_bf16 v[16:19], v[48:51], v[192:195], v[16:19]
    ds_read_b128 v[72:75], v13 offset:38912
    ds_read_b128 v[76:79], v13 offset:39936
    s_waitcnt lgkmcnt(6)
    v_mfma_f32_16x16x32_bf16 v[32:35], v[52:55], v[192:195], v[32:35]
    v_mfma_f32_16x16x32_bf16 v[20:23], v[48:51], v[200:203], v[20:23]
    v_mfma_f32_16x16x32_bf16 v[36:39], v[52:55], v[200:203], v[36:39]
    v_mfma_f32_16x16x32_bf16 v[24:27], v[48:51], v[208:211], v[24:27]
    v_mfma_f32_16x16x32_bf16 v[40:43], v[52:55], v[208:211], v[40:43]
    v_mfma_f32_16x16x32_bf16 v[28:31], v[48:51], v[216:219], v[28:31]
    v_mfma_f32_16x16x32_bf16 v[44:47], v[52:55], v[216:219], v[44:47]
    s_waitcnt lgkmcnt(5)
    v_mfma_f32_16x16x32_bf16 v[16:19], v[56:59], v[196:199], v[16:19]
    s_waitcnt lgkmcnt(4)
    v_mfma_f32_16x16x32_bf16 v[32:35], v[60:63], v[196:199], v[32:35]
    v_mfma_f32_16x16x32_bf16 v[20:23], v[56:59], v[204:207], v[20:23]
    v_mfma_f32_16x16x32_bf16 v[36:39], v[60:63], v[204:207], v[36:39]
    v_mfma_f32_16x16x32_bf16 v[24:27], v[56:59], v[212:215], v[24:27]
    v_mfma_f32_16x16x32_bf16 v[40:43], v[60:63], v[212:215], v[40:43]
    v_mfma_f32_16x16x32_bf16 v[28:31], v[56:59], v[220:223], v[28:31]
    v_mfma_f32_16x16x32_bf16 v[44:47], v[60:63], v[220:223], v[44:47]
    s_waitcnt lgkmcnt(3)
    v_mfma_f32_16x16x32_bf16 v[16:19], v[64:67], v[224:227], v[16:19]
    s_waitcnt lgkmcnt(2)
    v_mfma_f32_16x16x32_bf16 v[32:35], v[68:71], v[224:227], v[32:35]
    v_mfma_f32_16x16x32_bf16 v[20:23], v[64:67], v[232:235], v[20:23]
    v_mfma_f32_16x16x32_bf16 v[36:39], v[68:71], v[232:235], v[36:39]
    v_mfma_f32_16x16x32_bf16 v[24:27], v[64:67], v[240:243], v[24:27]
    v_mfma_f32_16x16x32_bf16 v[40:43], v[68:71], v[240:243], v[40:43]
    v_mfma_f32_16x16x32_bf16 v[28:31], v[64:67], v[248:251], v[28:31]
    v_mfma_f32_16x16x32_bf16 v[44:47], v[68:71], v[248:251], v[44:47]
    s_waitcnt lgkmcnt(1)
    v_mfma_f32_16x16x32_bf16 v[16:19], v[72:75], v[228:231], v[16:19]
    s_waitcnt lgkmcnt(0)
    v_mfma_f32_16x16x32_bf16 v[32:35], v[76:79], v[228:231], v[32:35]
    v_mfma_f32_16x16x32_bf16 v[20:23], v[72:75], v[236:239], v[20:23]
    v_mfma_f32_16x16x32_bf16 v[36:39], v[76:79], v[236:239], v[36:39]
    v_mfma_f32_16x16x32_bf16 v[24:27], v[72:75], v[244:247], v[24:27]
    v_mfma_f32_16x16x32_bf16 v[40:43], v[76:79], v[244:247], v[40:43]
    v_mfma_f32_16x16x32_bf16 v[28:31], v[72:75], v[252:255], v[28:31]
    v_mfma_f32_16x16x32_bf16 v[44:47], v[76:79], v[252:255], v[44:47]
    v_cvt_pk_bf16_f32 v80, v16, v17
    v_cvt_pk_bf16_f32 v81, v18, v19
    v_cvt_pk_bf16_f32 v82, v32, v33
    v_cvt_pk_bf16_f32 v83, v34, v35
    buffer_store_dwordx4 v[80:83], v0, s[12:15], s56 offen offset:0 sc1
    v_cvt_pk_bf16_f32 v84, v20, v21
    v_cvt_pk_bf16_f32 v85, v22, v23
    v_cvt_pk_bf16_f32 v86, v36, v37
    v_cvt_pk_bf16_f32 v87, v38, v39
    buffer_store_dwordx4 v[84:87], v0, s[12:15], s56 offen offset:1024 sc1
    v_cvt_pk_bf16_f32 v88, v24, v25
    v_cvt_pk_bf16_f32 v89, v26, v27
    v_cvt_pk_bf16_f32 v90, v40, v41
    v_cvt_pk_bf16_f32 v91, v42, v43
    s_add_u32 s35, s56, 8192
    buffer_store_dwordx4 v[88:91], v0, s[12:15], s35 offen offset:0 sc1
    v_cvt_pk_bf16_f32 v92, v28, v29
    v_cvt_pk_bf16_f32 v93, v30, v31
    v_cvt_pk_bf16_f32 v94, v44, v45
    v_cvt_pk_bf16_f32 v95, v46, v47
    buffer_store_dwordx4 v[92:95], v0, s[12:15], s35 offen offset:1024 sc1
    s_add_u32 s46, s46, s47
    s_add_u32 s52, s52, s54
    s_add_u32 s56, s56, s57
    s_add_u32 s53, s55, s50
    s_add_u32 s55, s55, 40960
    s_cmp_eq_u32 s55, 122880
    s_cselect_b32 s55, 0, s55
    s_waitcnt vmcnt(14)
    s_cmp_lg_u32 s59, 0
    s_cbranch_scc1 LV_nw
    s_waitcnt vmcnt(0)
LV_nw:
    s_barrier
    s_add_u32 s59, s59, 1
    s_cmp_lg_u32 s31, 0
    s_cbranch_scc1 LV_nosig
    s_cmp_eq_u32 s59, 1
    s_cselect_b32 s35, 64, 0
    s_cmp_eq_u32 s59, 4
    s_cselect_b32 s35, 68, s35
    s_cmp_eq_u32 s35, 0
    s_cbranch_scc1 LV_nosig
    v_mov_b32 v4, s35
    v_mov_b32 v5, 1
    s_mov_b64 exec, 1
    buffer_atomic_add v5, v4, s[8:11], 0 offen
    s_mov_b64 exec, -1
LV_nosig:
    s_cmp_lt_u32 s46, 64
    s_cbranch_scc1 LV_tile
    s_waitcnt vmcnt(0)
LW_p1a_done:
    s_barrier
    s_cmp_lg_u32 s31, 0
    s_cbranch_scc1 LSG_1
    v_mov_b32 v4, 72
    v_mov_b32 v5, 1
    s_mov_b64 exec, 1
    buffer_atomic_add v5, v4, s[8:11], 0 offen
    s_mov_b64 exec, -1
LSG_1:
    s_mov_b32 s46, s67
    s_mov_b32 s47, 6
    s_cmp_ge_u32 s66, 16
    s_cbranch_scc1 LW_h
    s_mov_b32 s36, s22
    s_mov_b32 s37, s23
    s_mov_b32 s38, 0x500000
    s_mov_b32 s39, 0x00020000
    s_mov_b32 s40, s22
    s_mov_b32 s41, s23
    s_mov_b32 s42, 0x500000
    s_mov_b32 s43, 0x00020000
    s_lshl_b32 s48, s70, 10
    s_add_u32 s48, s48, s69
    s_add_u32 s48, s48, 33554432
    s_mov_b32 s71, 1
    s_branch LW_kq
LW_h:
    s_cmp_ge_u32 s66, 30
    s_cbranch_scc1 LW_gate
    s_mov_b32 s36, s60
    s_mov_b32 s37, s61
    s_mov_b32 s38, 0x21c000
    s_mov_b32 s39, 0x00020000
    s_mov_b32 s40, s62
    s_mov_b32 s41, s63
    s_mov_b32 s42, 0x21c000
    s_mov_b32 s43, 0x00020000
    s_lshl_b32 s34, s68, 2
    s_add_u32 s34, s34, s31
    s_lshl_b32 s44, s68, 8
    s_mov_b32 s45, s44
    s_lshl_b32 s48, s34, 10
    s_add_u32 s48, s48, 67108864
    s_mul_i32 s33, s31, 28672
    s_add_u32 s33, s33, 40960
    s_lshr_b32 s34, s31, 1
    s_lshl_b32 s34, s34, 5
    s_and_b32 s35, s31, 1
    s_lshl_b32 s35, s35, 2
    s_add_u32 s34, s34, s35
    s_mul_i32 s34, s34, 3456
    s_add_u32 s76, s44, s34
    s_add_u32 s77, s45, s34
    s_mul_i32 s50, s31, 10240
    s_mul_i32 s51, s31, 320
    s_mul_i32 s52, s46, 40960
    s_add_u32 s52, s52, s51
    s_mul_i32 s54, s47, 40960
    s_mov_b32 s53, s50
    s_barrier
    s_add_u32 s34, s52, 0
    s_add_u32 m0, s53, 0
    s_nop 0
    buffer_load_dwordx4 v2, s[16:19], s34 offen lds
    s_add_u32 s34, s52, 20480
    s_add_u32 m0, s53, 1024
    s_nop 0
    buffer_load_dwordx4 v2, s[16:19], s34 offen lds
    s_add_u32 s34, s52, 64
    s_add_u32 m0, s53, 2048
    s_nop 0
    buffer_load_dwordx4 v2, s[16:19], s34 offen lds
    s_add_u32 s34, s52, 20544
    s_add_u32 m0, s53, 3072
    s_nop 0
    buffer_load_dwordx4 v2, s[16:19], s34 offen lds
    s_add_u32 s34, s52, 128
    s_add_u32 m0, s53, 4096
    s_nop 0
    buffer_load_dwordx4 v2, s[16:19], s34 offen lds
    s_add_u32 s34, s52, 20608
    s_add_u32 m0, s53, 5120
    s_nop 0
    buffer_load_dwordx4 v2, s[16:19], s34 offen lds
    s_add_u32 s34, s52, 192
    s_add_u32 m0, s53, 6144
    s_nop 0
    buffer_load_dwordx4 v2, s[16:19], s34 offen lds
    s_add_u32 s34, s52, 20672
    s_add_u32 m0, s53, 7168
    s_nop 0
    buffer_load_dwordx4 v2, s[16:19], s34 offen lds
    s_add_u32 s34, s52, 256
    s_add_u32 m0, s53, 8192
    s_nop 0
    buffer_load_dwordx4 v2, s[16:19], s34 offen lds
    s_add_u32 s34, s52, 20736
    s_add_u32 m0, s53, 9216
    s_nop 0
    buffer_load_dwordx4 v2, s[16:19], s34 offen lds
    v_lshrrev_b32 v4, 8, v0
    v_bfe_u32 v5, v0, 4, 4
    v_lshlrev_b32 v6, 1, v4
    v_xor_b32 v6, v6, v5
    v_xor_b32 v7, 8, v6
    v_mul_u32_u24 v4, 3456, v4
    v_lshl_add_u32 v104, v6, 4, v4
    v_lshl_add_u32 v105, v7, 4, v4
    s_add_u32 s34, s76, 0
    s_add_u32 m0, s33, 0
    s_nop 0
    buffer_load_dwordx4 v104, s[36:39], s34 offen lds
    s_add_u32 s34, s76, 27648
    s_add_u32 m0, s33, 1024
    s_nop 0
    buffer_load_dwordx4 v105, s[36:39], s34 offen lds
    s_add_u32 s34, s76, 55296
    s_add_u32 m0, s33, 2048
    s_nop 0
    buffer_load_dwordx4 v104, s[36:39], s34 offen lds
    s_add_u32 s34, s76, 82944
    s_add_u32 m0, s33, 3072
    s_nop 0
    buffer_load_dwordx4 v105, s[36:39], s34 offen lds
    s_add_u32 s34, s77, 0
    s_add_u32 m0, s33, 4096
    s_nop 0
    buffer_load_dwordx4 v104, s[40:43], s34 offen lds
    s_add_u32 s34, s77, 27648
    s_add_u32 m0, s33, 5120
    s_nop 0
    buffer_load_dwordx4 v105, s[40:43], s34 offen lds
    s_add_u32 s34, s77, 55296
    s_add_u32 m0, s33, 6144
    s_nop 0
    buffer_load_dwordx4 v104, s[40:43], s34 offen lds
    s_add_u32 s34, s77, 82944
    s_add_u32 m0, s33, 7168
    s_nop 0
    buffer_load_dwordx4 v105, s[40:43], s34 offen lds
    s_add_u32 s34, s76, 221184
    s_add_u32 m0, s33, 8192
    s_nop 0
    buffer_load_dwordx4 v104, s[36:39], s34 offen lds
    s_add_u32 s34, s76, 248832
    s_add_u32 m0, s33, 9216
    s_nop 0
    buffer_load_dwordx4 v105, s[36:39], s34 offen lds
    s_add_u32 s34, s76, 276480
    s_add_u32 m0, s33, 10240
    s_nop 0
    buffer_load_dwordx4 v104, s[36:39], s34 offen lds
    s_add_u32 s34, s76, 304128
    s_add_u32 m0, s33, 11264
    s_nop 0
    buffer_load_dwordx4 v105, s[36:39], s34 offen lds
    s_add_u32 s34, s77, 221184
    s_add_u32 m0, s33, 12288
    s_nop 0
    buffer_load_dwordx4 v104, s[40:43], s34 offen lds
    s_add_u32 s34, s77, 248832
    s_add_u32 m0, s33, 13312
    s_nop 0
    buffer_load_dwordx4 v105, s[40:43], s34 offen lds
    s_add_u32 s34, s77, 276480
    s_add_u32 m0, s33, 14336
    s_nop 0
    buffer_load_dwordx4 v104, s[40:43], s34 offen lds
    s_add_u32 s34, s77, 304128
    s_add_u32 m0, s33, 15360
    s_nop 0
    buffer_load_dwordx4 v105, s[40:43], s34 offen lds
    s_add_u32 s34, s76, 442368
    s_add_u32 m0, s33, 16384
    s_nop 0
    buffer_load_dwordx4 v104, s[36:39], s34 offen lds
    s_add_u32 s34, s76, 470016
    s_add_u32 m0, s33, 17408
    s_nop 0
    buffer_load_dwordx4 v105, s[36:39], s34 offen lds
    s_add_u32 s34, s76, 497664
    s_add_u32 m0, s33, 18432
    s_nop 0
    buffer_load_dwordx4 v104, s[36:39], s34 offen lds
    s_add_u32 s34, s76, 525312
    s_add_u32 m0, s33, 19456
    s_nop 0
    buffer_load_dwordx4 v105, s[36:39], s34 offen lds
    s_add_u32 s34, s77, 442368
    s_add_u32 m0, s33, 20480
    s_nop 0
    buffer_load_dwordx4 v104, s[40:43], s34 offen lds
    s_add_u32 s34, s77, 470016
    s_add_u32 m0, s33, 21504
    s_nop 0
    buffer_load_dwordx4 v105, s[40:43], s34 offen lds
    s_add_u32 s34, s77, 497664
    s_add_u32 m0, s33, 22528
    s_nop 0
    buffer_load_dwordx4 v104, s[40:43], s34 offen lds
    s_add_u32 s34, s77, 525312
    s_add_u32 m0, s33, 23552
    s_nop 0
    buffer_load_dwordx4 v105, s[40:43], s34 offen lds
    v_lshrrev_b32 v4, 6, v0
    v_and_b32 v5, 7, v4
    v_lshlrev_b32 v5, 1, v5
    v_bfe_u32 v6, v0, 4, 1
    v_lshlrev_b32 v6, 3, v6
    v_lshl_add_u32 v6, v4, 8, v6
    s_lshl_b32 s34, s31, 2
    v_bfe_u32 v7, v0, 5, 1
    v_add_u32 v7, s34, v7
    v_add_u32 v8, 0, v7
    v_xor_b32 v8, v8, v5
    v_lshl_add_u32 v8, v8, 4, v6
    v_add_u32 v96, 40960, v8
    v_add_u32 v97, 69632, v8
    v_add_u32 v98, 98304, v8
    v_add_u32 v99, 126976, v8
    v_add_u32 v8, 2, v7
    v_xor_b32 v8, v8, v5
    v_lshl_add_u32 v8, v8, 4, v6
    v_add_u32 v100, 40960, v8
    v_add_u32 v101, 69632, v8
    v_add_u32 v102, 98304, v8
    v_add_u32 v103, 126976, v8
    s_waitcnt vmcnt(20)
    s_waitcnt lgkmcnt(0)
    s_barrier
    s_add_u32 s34, s76, 663552
    s_add_u32 m0, s33, 24576
    s_nop 0
    buffer_load_dwordx4 v104, s[36:39], s34 offen lds
    s_add_u32 s34, s76, 691200
    s_add_u32 m0, s33, 25600
    s_nop 0
    buffer_load_dwordx4 v105, s[36:39], s34 offen lds
    s_add_u32 s34, s76, 718848
    s_add_u32 m0, s33, 26624
    s_nop 0
    buffer_load_dwordx4 v104, s[36:39], s34 offen lds
    s_add_u32 s34, s76, 746496
    s_add_u32 m0, s33, 27648
    s_nop 0
    buffer_load_dwordx4 v105, s[36:39], s34 offen lds
    ds_read_b64_tr_b16 a[0:1], v96 offset:0
    ds_read_b64_tr_b16 a[2:3], v97 offset:0
    ds_read_b64_tr_b16 a[4:5], v98 offset:0
    ds_read_b64_tr_b16 a[6:7], v99 offset:0
    ds_read_b64_tr_b16 a[8:9], v100 offset:0
    ds_read_b64_tr_b16 a[10:11], v101 offset:0
    ds_read_b64_tr_b16 a[12:13], v102 offset:0
    ds_read_b64_tr_b16 a[14:15], v103 offset:0
    s_waitcnt vmcnt(20)
    s_waitcnt lgkmcnt(0)
    s_barrier
    s_add_u32 s34, s77, 663552
    s_add_u32 m0, s33, 0
    s_nop 0
    buffer_load_dwordx4 v104, s[40:43], s34 offen lds
    s_add_u32 s34, s77, 691200
    s_add_u32 m0, s33, 1024
    s_nop 0
    buffer_load_dwordx4 v105, s[40:43], s34 offen lds
    s_add_u32 s34, s77, 718848
    s_add_u32 m0, s33, 2048
    s_nop 0
    buffer_load_dwordx4 v104, s[40:43], s34 offen lds
    s_add_u32 s34, s77, 746496
    s_add_u32 m0, s33, 3072
    s_nop 0
    buffer_load_dwordx4 v105, s[40:43], s34 offen lds
    ds_read_b64_tr_b16 a[16:17], v96 offset:4096
    ds_read_b64_tr_b16 a[18:19], v97 offset:4096
    ds_read_b64_tr_b16 a[20:21], v98 offset:4096
    ds_read_b64_tr_b16 a[22:23], v99 offset:4096
    ds_read_b64_tr_b16 a[24:25], v100 offset:4096
    ds_read_b64_tr_b16 a[26:27], v101 offset:4096
    ds_read_b64_tr_b16 a[28:29], v102 offset:4096
    ds_read_b64_tr_b16 a[30:31], v103 offset:4096
    s_waitcnt vmcnt(20)
    s_waitcnt lgkmcnt(0)
    s_barrier
    s_add_u32 s34, s76, 884736
    s_add_u32 m0, s33, 4096
    s_nop 0
    buffer_load_dwordx4 v104, s[36:39], s34 offen lds
    s_add_u32 s34, s76, 912384
    s_add_u32 m0, s33, 5120
    s_nop 0
    buffer_load_dwordx4 v105, s[36:39], s34 offen lds
    s_add_u32 s34, s76, 940032
    s_add_u32 m0, s33, 6144
    s_nop 0
    buffer_load_dwordx4 v104, s[36:39], s34 offen lds
    s_add_u32 s34, s76, 967680
    s_add_u32 m0, s33, 7168
    s_nop 0
    buffer_load_dwordx4 v105, s[36:39], s34 offen lds
    ds_read_b64_tr_b16 a[32:33], v96 offset:8192
    ds_read_b64_tr_b16 a[34:35], v97 offset:8192
    ds_read_b64_tr_b16 a[36:37], v98 offset:8192
    ds_read_b64_tr_b16 a[38:39], v99 offset:8192
    ds_read_b64_tr_b16 a[40:41], v100 offset:8192
    ds_read_b64_tr_b16 a[42:43], v101 offset:8192
    ds_read_b64_tr_b16 a[44:45], v102 offset:8192
    ds_read_b64_tr_b16 a[46:47], v103 offset:8192
    s_waitcnt vmcnt(20)
    s_waitcnt lgkmcnt(0)
    s_barrier
    s_add_u32 s34, s77, 884736
    s_add_u32 m0, s33, 8192
    s_nop 0
    buffer_load_dwordx4 v104, s[40:43], s34 offen lds
    s_add_u32 s34, s77, 912384
    s_add_u32 m0, s33, 9216
    s_nop 0
    buffer_load_dwordx4 v105, s[40:43], s34 offen lds
    s_add_u32 s34, s77, 940032
    s_add_u32 m0, s33, 10240
    s_nop 0
    buffer_load_dwordx4 v104, s[40:43], s34 offen lds
    s_add_u32 s34, s77, 967680
    s_add_u32 m0, s33, 11264
    s_nop 0
    buffer_load_dwordx4 v105, s[40:43], s34 offen lds
    ds_read_b64_tr_b16 a[48:49], v96 offset:12288
    ds_read_b64_tr_b16 a[50:51], v97 offset:12288
    ds_read_b64_tr_b16 a[52:53], v98 offset:12288
    ds_read_b64_tr_b16 a[54:55], v99 offset:12288
    ds_read_b64_tr_b16 a[56:57], v100 offset:12288
    ds_read_b64_tr_b16 a[58:59], v101 offset:12288
    ds_read_b64_tr_b16 a[60:61], v102 offset:12288
    ds_read_b64_tr_b16 a[62:63], v103 offset:12288
    s_waitcnt vmcnt(20)
    s_waitcnt lgkmcnt(0)
    s_barrier
    s_add_u32 s34, s76, 1105920
    s_add_u32 m0, s33, 12288
    s_nop 0
    buffer_load_dwordx4 v104, s[36:39], s34 offen lds
    s_add_u32 s34, s76, 1133568
    s_add_u32 m0, s33, 13312
    s_nop 0
    buffer_load_dwordx4 v105, s[36:39], s34 offen lds
    s_add_u32 s34, s76, 1161216
    s_add_u32 m0, s33, 14336
    s_nop 0
    buffer_load_dwordx4 v104, s[36:39], s34 offen lds
    s_add_u32 s34, s76, 1188864
    s_add_u32 m0, s33, 15360
    s_nop 0
    buffer_load_dwordx4 v105, s[36:39], s34 offen lds
    ds_read_b64_tr_b16 a[64:65], v96 offset:16384
    ds_read_b64_tr_b16 a[66:67], v97 offset:16384
    ds_read_b64_tr_b16 a[68:69], v98 offset:16384
    ds_read_b64_tr_b16 a[70:71], v99 offset:16384
    ds_read_b64_tr_b16 a[72:73], v100 offset:16384
    ds_read_b64_tr_b16 a[74:75], v101 offset:16384
    ds_read_b64_tr_b16 a[76:77], v102 offset:16384
    ds_read_b64_tr_b16 a[78:79], v103 offset:16384
    s_waitcnt vmcnt(20)
    s_waitcnt lgkmcnt(0)
    s_barrier
    s_add_u32 s34, s77, 1105920
    s_add_u32 m0, s33, 16384
    s_nop 0
    buffer_load_dwordx4 v104, s[40:43], s34 offen lds
    s_add_u32 s34, s77, 1133568
    s_add_u32 m0, s33, 17408
    s_nop 0
    buffer_load_dwordx4 v105, s[40:43], s34 offen lds
    s_add_u32 s34, s77, 1161216
    s_add_u32 m0, s33, 18432
    s_nop 0
    buffer_load_dwordx4 v104, s[40:43], s34 offen lds
    s_add_u32 s34, s77, 1188864
    s_add_u32 m0, s33, 19456
    s_nop 0
    buffer_load_dwordx4 v105, s[40:43], s34 offen lds
    ds_read_b64_tr_b16 a[80:81], v96 offset:20480
    ds_read_b64_tr_b16 a[82:83], v97 offset:20480
    ds_read_b64_tr_b16 a[84:85], v98 offset:20480
    ds_read_b64_tr_b16 a[86:87], v99 offset:20480
    ds_read_b64_tr_b16 a[88:89], v100 offset:20480
    ds_read_b64_tr_b16 a[90:91], v101 offset:20480
    ds_read_b64_tr_b16 a[92:93], v102 offset:20480
    ds_read_b64_tr_b16 a[94:95], v103 offset:20480
    s_waitcnt vmcnt(20)
    s_waitcnt lgkmcnt(0)
    s_barrier
    s_add_u32 s34, s76, 1327104
    s_add_u32 m0, s33, 20480
    s_nop 0
    buffer_load_dwordx4 v104, s[36:39], s34 offen lds
    s_add_u32 s34, s76, 1354752
    s_add_u32 m0, s33, 21504
    s_nop 0
    buffer_load_dwordx4 v105, s[36:39], s34 offen lds
    s_add_u32 s34, s76, 1382400
    s_add_u32 m0, s33, 22528
    s_nop 0
    buffer_load_dwordx4 v104, s[36:39], s34 offen lds
    s_add_u32 s34, s76, 1410048
    s_add_u32 m0, s33, 23552
    s_nop 0
    buffer_load_dwordx4 v105, s[36:39], s34 offen lds
    ds_read_b64_tr_b16 a[96:97], v96 offset:24576
    ds_read_b64_tr_b16 a[98:99], v97 offset:24576
    ds_read_b64_tr_b16 a[100:101], v98 offset:24576
    ds_read_b64_tr_b16 a[102:103], v99 offset:24576
    ds_read_b64_tr_b16 a[104:105], v100 offset:24576
    ds_read_b64_tr_b16 a[106:107], v101 offset:24576
    ds_read_b64_tr_b16 a[108:109], v102 offset:24576
    ds_read_b64_tr_b16 a[110:111], v103 offset:24576
    s_waitcnt vmcnt(20)
    s_waitcnt lgkmcnt(0)
    s_barrier
    s_add_u32 s34, s77, 1327104
    s_add_u32 m0, s33, 24576
    s_nop 0
    buffer_load_dwordx4 v104, s[40:43], s34 offen lds
    s_add_u32 s34, s77, 1354752
    s_add_u32 m0, s33, 25600
    s_nop 0
    buffer_load_dwordx4 v105, s[40:43], s34 offen lds
    s_add_u32 s34, s77, 1382400
    s_add_u32 m0, s33, 26624
    s_nop 0
    buffer_load_dwordx4 v104, s[40:43], s34 offen lds
    s_add_u32 s34, s77, 1410048
    s_add_u32 m0, s33, 27648
    s_nop 0
    buffer_load_dwordx4 v105, s[40:43], s34 offen lds
    ds_read_b64_tr_b16 a[112:113], v96 offset:0
    ds_read_b64_tr_b16 a[114:115], v97 offset:0
    ds_read_b64_tr_b16 a[116:117], v98 offset:0
    ds_read_b64_tr_b16 a[118:119], v99 offset:0
    ds_read_b64_tr_b16 a[120:121], v100 offset:0
    ds_read_b64_tr_b16 a[122:123], v101 offset:0
    ds_read_b64_tr_b16 a[124:125], v102 offset:0
    ds_read_b64_tr_b16 a[126:127], v103 offset:0
    s_waitcnt vmcnt(20)
    s_waitcnt lgkmcnt(0)
    s_barrier
    s_add_u32 s34, s76, 1548288
    s_add_u32 m0, s33, 0
    s_nop 0
    buffer_load_dwordx4 v104, s[36:39], s34 offen lds
    s_add_u32 s34, s76, 1575936
    s_add_u32 m0, s33, 1024
    s_nop 0
    buffer_load_dwordx4 v105, s[36:39], s34 offen lds
    s_add_u32 s34, s76, 1603584
    s_add_u32 m0, s33, 2048
    s_nop 0
    buffer_load_dwordx4 v104, s[36:39], s34 offen lds
    s_add_u32 s34, s76, 1631232
    s_add_u32 m0, s33, 3072
    s_nop 0
    buffer_load_dwordx4 v105, s[36:39], s34 offen lds
    ds_read_b64_tr_b16 a[128:129], v96 offset:4096
    ds_read_b64_tr_b16 a[130:131], v97 offset:4096
    ds_read_b64_tr_b16 a[132:133], v98 offset:4096
    ds_read_b64_tr_b16 a[134:135], v99 offset:4096
    ds_read_b64_tr_b16 a[136:137], v100 offset:4096
    ds_read_b64_tr_b16 a[138:139], v101 offset:4096
    ds_read_b64_tr_b16 a[140:141], v102 offset:4096
    ds_read_b64_tr_b16 a[142:143], v103 offset:4096
    s_waitcnt vmcnt(20)
    s_waitcnt lgkmcnt(0)
    s_barrier
    s_add_u32 s34, s77, 1548288
    s_add_u32 m0, s33, 4096
    s_nop 0
    buffer_load_dwordx4 v104, s[40:43], s34 offen lds
    s_add_u32 s34, s77, 1575936
    s_add_u32 m0, s33, 5120
    s_nop 0
    buffer_load_dwordx4 v105, s[40:43], s34 offen lds
    s_add_u32 s34, s77, 1603584
    s_add_u32 m0, s33, 6144
    s_nop 0
    buffer_load_dwordx4 v104, s[40:43], s34 offen lds
    s_add_u32 s34, s77, 1631232
    s_add_u32 m0, s33, 7168
    s_nop 0
    buffer_load_dwordx4 v105, s[40:43], s34 offen lds
    ds_read_b64_tr_b16 a[144:145], v96 offset:8192
    ds_read_b64_tr_b16 a[146:147], v97 offset:8192
    ds_read_b64_tr_b16 a[148:149], v98 offset:8192
    ds_read_b64_tr_b16 a[150:151], v99 offset:8192
    ds_read_b64_tr_b16 a[152:153], v100 offset:8192
    ds_read_b64_tr_b16 a[154:155], v101 offset:8192
    ds_read_b64_tr_b16 a[156:157], v102 offset:8192
    ds_read_b64_tr_b16 a[158:159], v103 offset:8192
    s_waitcnt vmcnt(20)
    s_waitcnt lgkmcnt(0)
    s_barrier
    s_add_u32 s34, s76, 1769472
    s_add_u32 m0, s33, 8192
    s_nop 0
    buffer_load_dwordx4 v104, s[36:39], s34 offen lds
    s_add_u32 s34, s76, 1797120
    s_add_u32 m0, s33, 9216
    s_nop 0
    buffer_load_dwordx4 v105, s[36:39], s34 offen lds
    s_add_u32 s34, s76, 1824768
    s_add_u32 m0, s33, 10240
    s_nop 0
    buffer_load_dwordx4 v104, s[36:39], s34 offen lds
    s_add_u32 s34, s76, 1852416
    s_add_u32 m0, s33, 11264
    s_nop 0
    buffer_load_dwordx4 v105, s[36:39], s34 offen lds
    ds_read_b64_tr_b16 a[160:161], v96 offset:12288
    ds_read_b64_tr_b16 a[162:163], v97 offset:12288
    ds_read_b64_tr_b16 a[164:165], v98 offset:12288
    ds_read_b64_tr_b16 a[166:167], v99 offset:12288
    ds_read_b64_tr_b16 a[168:169], v100 offset:12288
    ds_read_b64_tr_b16 a[170:171], v101 offset:12288
    ds_read_b64_tr_b16 a[172:173], v102 offset:12288
    ds_read_b64_tr_b16 a[174:175], v103 offset:12288
    s_waitcnt vmcnt(20)
    s_waitcnt lgkmcnt(0)
    s_barrier
    s_add_u32 s34, s77, 1769472
    s_add_u32 m0, s33, 12288
    s_nop 0
    buffer_load_dwordx4 v104, s[40:43], s34 offen lds
    s_add_u32 s34, s77, 1797120
    s_add_u32 m0, s33, 13312
    s_nop 0
    buffer_load_dwordx4 v105, s[40:43], s34 offen lds
    s_add_u32 s34, s77, 1824768
    s_add_u32 m0, s33, 14336
    s_nop 0
    buffer_load_dwordx4 v104, s[40:43], s34 offen lds
    s_add_u32 s34, s77, 1852416
    s_add_u32 m0, s33, 15360
    s_nop 0
    buffer_load_dwordx4 v105, s[40:43], s34 offen lds
    ds_read_b64_tr_b16 a[176:177], v96 offset:16384
    ds_read_b64_tr_b16 a[178:179], v97 offset:16384
    ds_read_b64_tr_b16 a[180:181], v98 offset:16384
    ds_read_b64_tr_b16 a[182:183], v99 offset:16384
    ds_read_b64_tr_b16 a[184:185], v100 offset:16384
    ds_read_b64_tr_b16 a[186:187], v101 offset:16384
    ds_read_b64_tr_b16 a[188:189], v102 offset:16384
    ds_read_b64_tr_b16 a[190:191], v103 offset:16384
    s_waitcnt vmcnt(20)
    s_waitcnt lgkmcnt(0)
    s_barrier
    s_add_u32 s34, s76, 1990656
    s_add_u32 m0, s33, 16384
    s_nop 0
    buffer_load_dwordx4 v104, s[36:39], s34 offen lds
    s_add_u32 s34, s76, 2018304
    s_add_u32 m0, s33, 17408
    s_nop 0
    buffer_load_dwordx4 v105, s[36:39], s34 offen lds
    s_add_u32 s34, s76, 2045952
    s_add_u32 m0, s33, 18432
    s_nop 0
    buffer_load_dwordx4 v104, s[36:39], s34 offen lds
    s_add_u32 s34, s76, 2073600
    s_add_u32 m0, s33, 19456
    s_nop 0
    buffer_load_dwordx4 v105, s[36:39], s34 offen lds
    ds_read_b64_tr_b16 a[192:193], v96 offset:20480
    ds_read_b64_tr_b16 a[194:195], v97 offset:20480
    ds_read_b64_tr_b16 a[196:197], v98 offset:20480
    ds_read_b64_tr_b16 a[198:199], v99 offset:20480
    ds_read_b64_tr_b16 a[200:201], v100 offset:20480
    ds_read_b64_tr_b16 a[202:203], v101 offset:20480
    ds_read_b64_tr_b16 a[204:205], v102 offset:20480
    ds_read_b64_tr_b16 a[206:207], v103 offset:20480
    s_waitcnt vmcnt(20)
    s_waitcnt lgkmcnt(0)
    s_barrier
    s_add_u32 s34, s77, 1990656
    s_add_u32 m0, s33, 20480
    s_nop 0
    buffer_load_dwordx4 v104, s[40:43], s34 offen lds
    s_add_u32 s34, s77, 2018304
    s_add_u32 m0, s33, 21504
    s_nop 0
    buffer_load_dwordx4 v105, s[40:43], s34 offen lds
    s_add_u32 s34, s77, 2045952
    s_add_u32 m0, s33, 22528
    s_nop 0
    buffer_load_dwordx4 v104, s[40:43], s34 offen lds
    s_add_u32 s34, s77, 2073600
    s_add_u32 m0, s33, 23552
    s_nop 0
    buffer_load_dwordx4 v105, s[40:43], s34 offen lds
    ds_read_b64_tr_b16 a[208:209], v96 offset:24576
    ds_read_b64_tr_b16 a[210:211], v97 offset:24576
    ds_read_b64_tr_b16 a[212:213], v98 offset:24576
    ds_read_b64_tr_b16 a[214:215], v99 offset:24576
    ds_read_b64_tr_b16 a[216:217], v100 offset:24576
    ds_read_b64_tr_b16 a[218:219], v101 offset:24576
    ds_read_b64_tr_b16 a[220:221], v102 offset:24576
    ds_read_b64_tr_b16 a[222:223], v103 offset:24576
    s_waitcnt vmcnt(20)
    s_waitcnt lgkmcnt(0)
    s_barrier
    ds_read_b64_tr_b16 a[224:225], v96 offset:0
    ds_read_b64_tr_b16 a[226:227], v97 offset:0
    ds_read_b64_tr_b16 a[228:229], v98 offset:0
    ds_read_b64_tr_b16 a[230:231], v99 offset:0
    ds_read_b64_tr_b16 a[232:233], v100 offset:0
    ds_read_b64_tr_b16 a[234:235], v101 offset:0
    ds_read_b64_tr_b16 a[236:237], v102 offset:0
    ds_read_b64_tr_b16 a[238:239], v103 offset:0
    s_waitcnt vmcnt(16)
    s_waitcnt lgkmcnt(0)
    s_barrier
    ds_read_b64_tr_b16 a[240:241], v96 offset:4096
    ds_read_b64_tr_b16 a[242:243], v97 offset:4096
    ds_read_b64_tr_b16 a[244:245], v98 offset:4096
    ds_read_b64_tr_b16 a[246:247], v99 offset:4096
    ds_read_b64_tr_b16 a[248:249], v100 offset:4096
    ds_read_b64_tr_b16 a[250:251], v101 offset:4096
    ds_read_b64_tr_b16 a[252:253], v102 offset:4096
    ds_read_b64_tr_b16 a[254:255], v103 offset:4096
    s_waitcnt vmcnt(12)
    s_waitcnt lgkmcnt(0)
    s_barrier
    ds_read_b64_tr_b16 v[192:193], v96 offset:8192
    ds_read_b64_tr_b16 v[194:195], v97 offset:8192
    ds_read_b64_tr_b16 v[196:197], v98 offset:8192
    ds_read_b64_tr_b16 v[198:199], v99 offset:8192
    ds_read_b64_tr_b16 v[200:201], v100 offset:8192
    ds_read_b64_tr_b16 v[202:203], v101 offset:8192
    ds_read_b64_tr_b16 v[204:205], v102 offset:8192
    ds_read_b64_tr_b16 v[206:207], v103 offset:8192
    s_waitcnt vmcnt(8)
    s_waitcnt lgkmcnt(0)
    s_barrier
    ds_read_b64_tr_b16 v[208:209], v96 offset:12288
    ds_read_b64_tr_b16 v[210:211], v97 offset:12288
    ds_read_b64_tr_b16 v[212:213], v98 offset:12288
    ds_read_b64_tr_b16 v[214:215], v99 offset:12288
    ds_read_b64_tr_b16 v[216:217], v100 offset:12288
    ds_read_b64_tr_b16 v[218:219], v101 offset:12288
    ds_read_b64_tr_b16 v[220:221], v102 offset:12288
    ds_read_b64_tr_b16 v[222:223], v103 offset:12288
    s_waitcnt vmcnt(4)
    s_waitcnt lgkmcnt(0)
    s_barrier
    ds_read_b64_tr_b16 v[224:225], v96 offset:16384
    ds_read_b64_tr_b16 v[226:227], v97 offset:16384
    ds_read_b64_tr_b16 v[228:229], v98 offset:16384
    ds_read_b64_tr_b16 v[230:231], v99 offset:16384
    ds_read_b64_tr_b16 v[232:233], v100 offset:16384
    ds_read_b64_tr_b16 v[234:235], v101 offset:16384
    ds_read_b64_tr_b16 v[236:237], v102 offset:16384
    ds_read_b64_tr_b16 v[238:239], v103 offset:16384
    s_waitcnt vmcnt(0)
    s_waitcnt lgkmcnt(0)
    s_barrier
    ds_read_b64_tr_b16 v[240:241], v96 offset:20480
    ds_read_b64_tr_b16 v[242:243], v97 offset:20480
    ds_read_b64_tr_b16 v[244:245], v98 offset:20480
    ds_read_b64_tr_b16 v[246:247], v99 offset:20480
    ds_read_b64_tr_b16 v[248:249], v100 offset:20480
    ds_read_b64_tr_b16 v[250:251], v101 offset:20480
    ds_read_b64_tr_b16 v[252:253], v102 offset:20480
    ds_read_b64_tr_b16 v[254:255], v103 offset:20480
    s_waitcnt vmcnt(0) lgkmcnt(0)
    s_barrier
    s_add_u32 s52, s52, s54
    s_add_u32 s53, s50, 40960
    s_add_u32 s34, s52, 0
    s_add_u32 m0, s53, 0
    s_nop 0
    buffer_load_dwordx4 v2, s[16:19], s34 offen lds
    s_add_u32 s34, s52, 20480
    s_add_u32 m0, s53, 1024
    s_nop 0
    buffer_load_dwordx4 v2, s[16:19], s34 offen lds
    s_add_u32 s34, s52, 64
    s_add_u32 m0, s53, 2048
    s_nop 0
    buffer_load_dwordx4 v2, s[16:19], s34 offen lds
    s_add_u32 s34, s52, 20544
    s_add_u32 m0, s53, 3072
    s_nop 0
    buffer_load_dwordx4 v2, s[16:19], s34 offen lds
    s_add_u32 s34, s52, 128
    s_add_u32 m0, s53, 4096
    s_nop 0
    buffer_load_dwordx4 v2, s[16:19], s34 offen lds
    s_add_u32 s34, s52, 20608
    s_add_u32 m0, s53, 5120
    s_nop 0
    buffer_load_dwordx4 v2, s[16:19], s34 offen lds
    s_add_u32 s34, s52, 192
    s_add_u32 m0, s53, 6144
    s_nop 0
    buffer_load_dwordx4 v2, s[16:19], s34 offen lds
    s_add_u32 s34, s52, 20672
    s_add_u32 m0, s53, 7168
    s_nop 0
    buffer_load_dwordx4 v2, s[16:19], s34 offen lds
    s_add_u32 s34, s52, 256
    s_add_u32 m0, s53, 8192
    s_nop 0
    buffer_load_dwordx4 v2, s[16:19], s34 offen lds
    s_add_u32 s34, s52, 20736
    s_add_u32 m0, s53, 9216
    s_nop 0
    buffer_load_dwordx4 v2, s[16:19], s34 offen lds
    s_add_u32 s52, s52, s54
    s_add_u32 s53, s50, 81920
    s_mov_b32 s55, 0
    s_mul_i32 s56, s46, 131072
    s_add_u32 s56, s56, s48
    s_mul_i32 s57, s47, 131072
LH_tile:
    v_add_u32 v13, s55, v3
    ds_read_b128 v[48:51], v13 offset:0
    ds_read_b128 v[52:55], v13 offset:1024
    ds_read_b128 v[56:59], v13 offset:2048
    ds_read_b128 v[60:63], v13 offset:3072
    ds_read_b128 v[64:67], v13 offset:4096
    ds_read_b128 v[68:71], v13 offset:5120
    s_waitcnt lgkmcnt(5)
    v_mfma_f32_16x16x32_bf16 v[16:19], a[0:3], v[48:51], 0
    ds_read_b128 v[72:75], v13 offset:6144
    ds_read_b128 v[76:79], v13 offset:7168
    s_waitcnt lgkmcnt(6)
    v_mfma_f32_16x16x32_bf16 v[32:35], a[0:3], v[52:55], 0
    v_mfma_f32_16x16x32_bf16 v[20:23], a[8:11], v[48:51], 0
    v_mfma_f32_16x16x32_bf16 v[36:39], a[8:11], v[52:55], 0
    v_mfma_f32_16x16x32_bf16 v[24:27], a[16:19], v[48:51], 0
    v_mfma_f32_16x16x32_bf16 v[40:43], a[16:19], v[52:55], 0
    v_mfma_f32_16x16x32_bf16 v[28:31], a[24:27], v[48:51], 0
    v_mfma_f32_16x16x32_bf16 v[44:47], a[24:27], v[52:55], 0
    s_waitcnt lgkmcnt(5)
    v_mfma_f32_16x16x32_bf16 v[16:19], a[4:7], v[56:59], v[16:19]
    ds_read_b128 v[48:51], v13 offset:8192
    ds_read_b128 v[52:55], v13 offset:9216
    s_waitcnt lgkmcnt(6)
    v_mfma_f32_16x16x32_bf16 v[32:35], a[4:7], v[60:63], v[32:35]
    v_mfma_f32_16x16x32_bf16 v[20:23], a[12:15], v[56:59], v[20:23]
    v_mfma_f32_16x16x32_bf16 v[36:39], a[12:15], v[60:63], v[36:39]
    s_add_u32 s34, s52, 0
    s_add_u32 m0, s53, 0
    s_nop 0
    buffer_load_dwordx4 v2, s[16:19], s34 offen lds
    v_mfma_f32_16x16x32_bf16 v[24:27], a[20:23], v[56:59], v[24:27]
    v_mfma_f32_16x16x32_bf16 v[40:43], a[20:23], v[60:63], v[40:43]
    v_mfma_f32_16x16x32_bf16 v[28:31], a[28:31], v[56:59], v[28:31]
    v_mfma_f32_16x16x32_bf16 v[44:47], a[28:31], v[60:63], v[44:47]
    s_waitcnt lgkmcnt(5)
    v_mfma_f32_16x16x32_bf16 v[16:19], a[32:35], v[64:67], v[16:19]
    ds_read_b128 v[56:59], v13 offset:10240
    ds_read_b128 v[60:63], v13 offset:11264
    s_waitcnt lgkmcnt(6)
    v_mfma_f32_16x16x32_bf16 v[32:35], a[32:35], v[68:71], v[32:35]
    v_mfma_f32_16x16x32_bf16 v[20:23], a[40:43], v[64:67], v[20:23]
    v_mfma_f32_16x16x32_bf16 v[36:39], a[40:43], v[68:71], v[36:39]
    s_add_u32 s34, s52, 20480
    s_add_u32 m0, s53, 1024
    s_nop 0
    buffer_load_dwordx4 v2, s[16:19], s34 offen lds
    v_mfma_f32_16x16x32_bf16 v[24:27], a[48:51], v[64:67], v[24:27]
    v_mfma_f32_16x16x32_bf16 v[40:43], a[48:51], v[68:71], v[40:43]
    v_mfma_f32_16x16x32_bf16 v[28:31], a[56:59], v[64:67], v[28:31]
    v_mfma_f32_16x16x32_bf16 v[44:47], a[56:59], v[68:71], v[44:47]
    s_waitcnt lgkmcnt(5)
    v_mfma_f32_16x16x32_bf16 v[16:19], a[36:39], v[72:75], v[16:19]
    ds_read_b128 v[64:67], v13 offset:12288
    ds_read_b128 v[68:71], v13 offset:13312
    s_waitcnt lgkmcnt(6)
    v_mfma_f32_16x16x32_bf16 v[32:35], a[36:39], v[76:79], v[32:35]
    v_mfma_f32_16x16x32_bf16 v[20:23], a[44:47], v[72:75], v[20:23]
    v_mfma_f32_16x16x32_bf16 v[36:39], a[44:47], v[76:79], v[36:39]
    s_add_u32 s34, s52, 64
    s_add_u32 m0, s53, 2048
    s_nop 0
    buffer_load_dwordx4 v2, s[16:19], s34 offen lds
    v_mfma_f32_16x16x32_bf16 v[24:27], a[52:55], v[72:75], v[24:27]
    v_mfma_f32_16x16x32_bf16 v[40:43], a[52:55], v[76:79], v[40:43]
    v_mfma_f32_16x16x32_bf16 v[28:31], a[60:63], v[72:75], v[28:31]
    v_mfma_f32_16x16x32_bf16 v[44:47], a[60:63], v[76:79], v[44:47]
    s_waitcnt lgkmcnt(5)
    v_mfma_f32_16x16x32_bf16 v[16:19], a[64:67], v[48:51], v[16:19]
    ds_read_b128 v[72:75], v13 offset:14336
    ds_read_b128 v[76:79], v13 offset:15360
    s_waitcnt lgkmcnt(6)
    v_mfma_f32_16x16x32_bf16 v[32:35], a[64:67], v[52:55], v[32:35]
    v_mfma_f32_16x16x32_bf16 v[20:23], a[72:75], v[48:51], v[20:23]
    v_mfma_f32_16x16x32_bf16 v[36:39], a[72:75], v[52:55], v[36:39]
    s_add_u32 s34, s52, 20544
    s_add_u32 m0, s53, 3072
    s_nop 0
    buffer_load_dwordx4 v2, s[16:19], s34 offen lds
    v_mfma_f32_16x16x32_bf16 v[24:27], a[80:83], v[48:51], v[24:27]
    v_mfma_f32_16x16x32_bf16 v[40:43], a[80:83], v[52:55], v[40:43]
    v_mfma_f32_16x16x32_bf16 v[28:31], a[88:91], v[48:51], v[28:31]
    v_mfma_f32_16x16x32_bf16 v[44:47], a[88:91], v[52:55], v[44:47]
    s_waitcnt lgkmcnt(5)
    v_mfma_f32_16x16x32_bf16 v[16:19], a[68:71], v[56:59], v[16:19]
    ds_read_b128 v[48:51], v13 offset:16384
    ds_read_b128 v[52:55], v13 offset:17408
    s_waitcnt lgkmcnt(6)
    v_mfma_f32_16x16x32_bf16 v[32:35], a[68:71], v[60:63], v[32:35]
    v_mfma_f32_16x16x32_bf16 v[20:23], a[76:79], v[56:59], v[20:23]
    v_mfma_f32_16x16x32_bf16 v[36:39], a[76:79], v[60:63], v[36:39]
    s_add_u32 s34, s52, 128
    s_add_u32 m0, s53, 4096
    s_nop 0
    buffer_load_dwordx4 v2, s[16:19], s34 offen lds
    v_mfma_f32_16x16x32_bf16 v[24:27], a[84:87], v[56:59], v[24:27]
    v_mfma_f32_16x16x32_bf16 v[40:43], a[84:87], v[60:63], v[40:43]
    v_mfma_f32_16x16x32_bf16 v[28:31], a[92:95], v[56:59], v[28:31]
    v_mfma_f32_16x16x32_bf16 v[44:47], a[92:95], v[60:63], v[44:47]
    s_waitcnt lgkmcnt(5)
    v_mfma_f32_16x16x32_bf16 v[16:19], a[96:99], v[64:67], v[16:19]
    ds_read_b128 v[56:59], v13 offset:18432
    ds_read_b128 v[60:63], v13 offset:19456
    s_waitcnt lgkmcnt(6)
    v_mfma_f32_16x16x32_bf16 v[32:35], a[96:99], v[68:71], v[32:35]
    v_mfma_f32_16x16x32_bf16 v[20:23], a[104:107], v[64:67], v[20:23]
    v_mfma_f32_16x16x32_bf16 v[36:39], a[104:107], v[68:71], v[36:39]
    s_add_u32 s34, s52, 20608
    s_add_u32 m0, s53, 5120
    s_nop 0
    buffer_load_dwordx4 v2, s[16:19], s34 offen lds
    v_mfma_f32_16x16x32_bf16 v[24:27], a[112:115], v[64:67], v[24:27]
    v_mfma_f32_16x16x32_bf16 v[40:43], a[112:115], v[68:71], v[40:43]
    v_mfma_f32_16x16x32_bf16 v[28:31], a[120:123], v[64:67], v[28:31]
    v_mfma_f32_16x16x32_bf16 v[44:47], a[120:123], v[68:71], v[44:47]
    s_waitcnt lgkmcnt(5)
    v_mfma_f32_16x16x32_bf16 v[16:19], a[100:103], v[72:75], v[16:19]
    ds_read_b128 v[64:67], v13 offset:20480
    ds_read_b128 v[68:71], v13 offset:21504
    s_waitcnt lgkmcnt(6)
    v_mfma_f32_16x16x32_bf16 v[32:35], a[100:103], v[76:79], v[32:35]
    v_mfma_f32_16x16x32_bf16 v[20:23], a[108:111], v[72:75], v[20:23]
    v_mfma_f32_16x16x32_bf16 v[36:39], a[108:111], v[76:79], v[36:39]
    s_add_u32 s34, s52, 192
    s_add_u32 m0, s53, 6144
    s_nop 0
    buffer_load_dwordx4 v2, s[16:19], s34 offen lds
    v_mfma_f32_16x16x32_bf16 v[24:27], a[116:119], v[72:75], v[24:27]
    v_mfma_f32_16x16x32_bf16 v[40:43], a[116:119], v[76:79], v[40:43]
    v_mfma_f32_16x16x32_bf16 v[28:31], a[124:127], v[72:75], v[28:31]
    v_mfma_f32_16x16x32_bf16 v[44:47], a[124:127], v[76:79], v[44:47]
    s_waitcnt lgkmcnt(5)
    v_mfma_f32_16x16x32_bf16 v[16:19], a[128:131], v[48:51], v[16:19]
    ds_read_b128 v[72:75], v13 offset:22528
    ds_read_b128 v[76:79], v13 offset:23552
    s_waitcnt lgkmcnt(6)
    v_mfma_f32_16x16x32_bf16 v[32:35], a[128:131], v[52:55], v[32:35]
    v_mfma_f32_16x16x32_bf16 v[20:23], a[136:139], v[48:51], v[20:23]
    v_mfma_f32_16x16x32_bf16 v[36:39], a[136:139], v[52:55], v[36:39]
    s_add_u32 s34, s52, 20672
    s_add_u32 m0, s53, 7168
    s_nop 0
    buffer_load_dwordx4 v2, s[16:19], s34 offen lds
    v_mfma_f32_16x16x32_bf16 v[24:27], a[144:147], v[48:51], v[24:27]
    v_mfma_f32_16x16x32_bf16 v[40:43], a[144:147], v[52:55], v[40:43]
    v_mfma_f32_16x16x32_bf16 v[28:31], a[152:155], v[48:51], v[28:31]
    v_mfma_f32_16x16x32_bf16 v[44:47], a[152:155], v[52:55], v[44:47]
    s_waitcnt lgkmcnt(5)
    v_mfma_f32_16x16x32_bf16 v[16:19], a[132:135], v[56:59], v[16:19]
    ds_read_b128 v[48:51], v13 offset:24576
    ds_read_b128 v[52:55], v13 offset:25600
    s_waitcnt lgkmcnt(6)
    v_mfma_f32_16x16x32_bf16 v[32:35], a[132:135], v[60:63], v[32:35]
    v_mfma_f32_16x16x32_bf16 v[20:23], a[140:143], v[56:59], v[20:23]
    v_mfma_f32_16x16x32_bf16 v[36:39], a[140:143], v[60:63], v[36:39]
    s_add_u32 s34, s52, 256
    s_add_u32 m0, s53, 8192
    s_nop 0
    buffer_load_dwordx4 v2, s[16:19], s34 offen lds
    v_mfma_f32_16x16x32_bf16 v[24:27], a[148:151], v[56:59], v[24:27]
    v_mfma_f32_16x16x32_bf16 v[40:43], a[148:151], v[60:63], v[40:43]
    v_mfma_f32_16x16x32_bf16 v[28:31], a[156:159], v[56:59], v[28:31]
    v_mfma_f32_16x16x32_bf16 v[44:47], a[156:159], v[60:63], v[44:47]
    s_waitcnt lgkmcnt(5)
    v_mfma_f32_16x16x32_bf16 v[16:19], a[160:163], v[64:67], v[16:19]
    ds_read_b128 v[56:59], v13 offset:26624
    ds_read_b128 v[60:63], v13 offset:27648
    s_waitcnt lgkmcnt(6)
    v_mfma_f32_16x16x32_bf16 v[32:35], a[160:163], v[68:71], v[32:35]
    v_mfma_f32_16x16x32_bf16 v[20:23], a[168:171], v[64:67], v[20:23]
    v_mfma_f32_16x16x32_bf16 v[36:39], a[168:171], v[68:71], v[36:39]
    s_add_u32 s34, s52, 20736
    s_add_u32 m0, s53, 9216
    s_nop 0
    buffer_load_dwordx4 v2, s[16:19], s34 offen lds
    v_mfma_f32_16x16x32_bf16 v[24:27], a[176:179], v[64:67], v[24:27]
    v_mfma_f32_16x16x32_bf16 v[40:43], a[176:179], v[68:71], v[40:43]
    v_mfma_f32_16x16x32_bf16 v[28:31], a[184:187], v[64:67], v[28:31]
    v_mfma_f32_16x16x32_bf16 v[44:47], a[184:187], v[68:71], v[44:47]
    s_waitcnt lgkmcnt(5)
    v_mfma_f32_16x16x32_bf16 v[16:19], a[164:167], v[72:75], v[16:19]
    ds_read_b128 v[64:67], v13 offset:28672
    ds_read_b128 v[68:71], v13 offset:29696
    s_waitcnt lgkmcnt(6)
    v_mfma_f32_16x16x32_bf16 v[32:35], a[164:167], v[76:79], v[32:35]
    v_mfma_f32_16x16x32_bf16 v[20:23], a[172:175], v[72:75], v[20:23]
    v_mfma_f32_16x16x32_bf16 v[36:39], a[172:175], v[76:79], v[36:39]
    v_mfma_f32_16x16x32_bf16 v[24:27], a[180:183], v[72:75], v[24:27]
    v_mfma_f32_16x16x32_bf16 v[40:43], a[180:183], v[76:79], v[40:43]
    v_mfma_f32_16x16x32_bf16 v[28:31], a[188:191], v[72:75], v[28:31]
    v_mfma_f32_16x16x32_bf16 v[44:47], a[188:191], v[76:79], v[44:47]
    s_waitcnt lgkmcnt(5)
    v_mfma_f32_16x16x32_bf16 v[16:19], a[192:195], v[48:51], v[16:19]
    ds_read_b128 v[72:75], v13 offset:30720
    ds_read_b128 v[76:79], v13 offset:31744
    s_waitcnt lgkmcnt(6)
    v_mfma_f32_16x16x32_bf16 v[32:35], a[192:195], v[52:55], v[32:35]
    v_mfma_f32_16x16x32_bf16 v[20:23], a[200:203], v[48:51], v[20:23]
    v_mfma_f32_16x16x32_bf16 v[36:39], a[200:203], v[52:55], v[36:39]
    v_mfma_f32_16x16x32_bf16 v[24:27], a[208:211], v[48:51], v[24:27]
    v_mfma_f32_16x16x32_bf16 v[40:43], a[208:211], v[52:55], v[40:43]
    v_mfma_f32_16x16x32_bf16 v[28:31], a[216:219], v[48:51], v[28:31]
    v_mfma_f32_16x16x32_bf16 v[44:47], a[216:219], v[52:55], v[44:47]
    s_waitcnt lgkmcnt(5)
    v_mfma_f32_16x16x32_bf16 v[16:19], a[196:199], v[56:59], v[16:19]
    ds_read_b128 v[48:51], v13 offset:32768
    ds_read_b128 v[52:55], v13 offset:33792
    s_waitcnt lgkmcnt(6)
    v_mfma_f32_16x16x32_bf16 v[32:35], a[196:199], v[60:63], v[32:35]
    v_mfma_f32_16x16x32_bf16 v[20:23], a[204:207], v[56:59], v[20:23]
    v_mfma_f32_16x16x32_bf16 v[36:39], a[204:207], v[60:63], v[36:39]
    v_mfma_f32_16x16x32_bf16 v[24:27], a[212:215], v[56:59], v[24:27]
    v_mfma_f32_16x16x32_bf16 v[40:43], a[212:215], v[60:63], v[40:43]
    v_mfma_f32_16x16x32_bf16 v[28:31], a[220:223], v[56:59], v[28:31]
    v_mfma_f32_16x16x32_bf16 v[44:47], a[220:223], v[60:63], v[44:47]
    s_waitcnt lgkmcnt(5)
    v_mfma_f32_16x16x32_bf16 v[16:19], a[224:227], v[64:67], v[16:19]
    ds_read_b128 v[56:59], v13 offset:34816
    ds_read_b128 v[60:63], v13 offset:35840
    s_waitcnt lgkmcnt(6)
    v_mfma_f32_16x16x32_bf16 v[32:35], a[224:227], v[68:71], v[32:35]
    v_mfma_f32_16x16x32_bf16 v[20:23], a[232:235], v[64:67], v[20:23]
    v_mfma_f32_16x16x32_bf16 v[36:39], a[232:235], v[68:71], v[36:39]
    v_mfma_f32_16x16x32_bf16 v[24:27], a[240:243], v[64:67], v[24:27]
    v_mfma_f32_16x16x32_bf16 v[40:43], a[240:243], v[68:71], v[40:43]
    v_mfma_f32_16x16x32_bf16 v[28:31], a[248:251], v[64:67], v[28:31]
    v_mfma_f32_16x16x32_bf16 v[44:47], a[248:251], v[68:71], v[44:47]
    s_waitcnt lgkmcnt(5)
    v_mfma_f32_16x16x32_bf16 v[16:19], a[228:231], v[72:75], v[16:19]
    ds_read_b128 v[64:67], v13 offset:36864
    ds_read_b128 v[68:71], v13 offset:37888
    s_waitcnt lgkmcnt(6)
    v_mfma_f32_16x16x32_bf16 v[32:35], a[228:231], v[76:79], v[32:35]
    v_mfma_f32_16x16x32_bf16 v[20:23], a[236:239], v[72:75], v[20:23]
    v_mfma_f32_16x16x32_bf16 v[36:39], a[236:239], v[76:79], v[36:39]
    v_mfma_f32_16x16x32_bf16 v[24:27], a[244:247], v[72:75], v[24:27]
    v_mfma_f32_16x16x32_bf16 v[40:43], a[244:247], v[76:79], v[40:43]
    v_mfma_f32_16x16x32_bf16 v[28:31], a[252:255], v[72:75], v[28:31]
    v_mfma_f32_16x16x32_bf16 v[44:47], a[252:255], v[76:79], v[44:47]
    s_waitcnt lgkmcnt(5)
    v_mfma_f32_16x16x32_bf16 v[16:19], v[192:195], v[48:51], v[16:19]
    ds_read_b128 v[72:75], v13 offset:38912
    ds_read_b128 v[76:79], v13 offset:39936
    s_waitcnt lgkmcnt(6)
    v_mfma_f32_16x16x32_bf16 v[32:35], v[192:195], v[52:55], v[32:35]
    v_mfma_f32_16x16x32_bf16 v[20:23], v[200:203], v[48:51], v[20:23]
    v_mfma_f32_16x16x32_bf16 v[36:39], v[200:203], v[52:55], v[36:39]
    v_mfma_f32_16x16x32_bf16 v[24:27], v[208:211], v[48:51], v[24:27]
    v_mfma_f32_16x16x32_bf16 v[40:43], v[208:211], v[52:55], v[40:43]
    v_mfma_f32_16x16x32_bf16 v[28:31], v[216:219], v[48:51], v[28:31]
    v_mfma_f32_16x16x32_bf16 v[44:47], v[216:219], v[52:55], v[44:47]
    s_waitcnt lgkmcnt(5)
    v_mfma_f32_16x16x32_bf16 v[16:19], v[196:199], v[56:59], v[16:19]
    s_waitcnt lgkmcnt(4)
    v_mfma_f32_16x16x32_bf16 v[32:35], v[196:199], v[60:63], v[32:35]
    v_mfma_f32_16x16x32_bf16 v[20:23], v[204:207], v[56:59], v[20:23]
    v_mfma_f32_16x16x32_bf16 v[36:39], v[204:207], v[60:63], v[36:39]
    v_mfma_f32_16x16x32_bf16 v[24:27], v[212:215], v[56:59], v[24:27]
    v_mfma_f32_16x16x32_bf16 v[40:43], v[212:215], v[60:63], v[40:43]
    v_mfma_f32_16x16x32_bf16 v[28:31], v[220:223], v[56:59], v[28:31]
    v_mfma_f32_16x16x32_bf16 v[44:47], v[220:223], v[60:63], v[44:47]
    s_waitcnt lgkmcnt(3)
    v_mfma_f32_16x16x32_bf16 v[16:19], v[224:227], v[64:67], v[16:19]
    s_waitcnt lgkmcnt(2)
    v_mfma_f32_16x16x32_bf16 v[32:35], v[224:227], v[68:71], v[32:35]
    v_mfma_f32_16x16x32_bf16 v[20:23], v[232:235], v[64:67], v[20:23]
    v_mfma_f32_16x16x32_bf16 v[36:39], v[232:235], v[68:71], v[36:39]
    v_mfma_f32_16x16x32_bf16 v[24:27], v[240:243], v[64:67], v[24:27]
    v_mfma_f32_16x16x32_bf16 v[40:43], v[240:243], v[68:71], v[40:43]
    v_mfma_f32_16x16x32_bf16 v[28:31], v[248:251], v[64:67], v[28:31]
    v_mfma_f32_16x16x32_bf16 v[44:47], v[248:251], v[68:71], v[44:47]
    s_waitcnt lgkmcnt(1)
    v_mfma_f32_16x16x32_bf16 v[16:19], v[228:231], v[72:75], v[16:19]
    s_waitcnt lgkmcnt(0)
    v_mfma_f32_16x16x32_bf16 v[32:35], v[228:231], v[76:79], v[32:35]
    v_mfma_f32_16x16x32_bf16 v[20:23], v[236:239], v[72:75], v[20:23]
    v_mfma_f32_16x16x32_bf16 v[36:39], v[236:239], v[76:79], v[36:39]
    v_mfma_f32_16x16x32_bf16 v[24:27], v[244:247], v[72:75], v[24:27]
    v_mfma_f32_16x16x32_bf16 v[40:43], v[244:247], v[76:79], v[40:43]
    v_mfma_f32_16x16x32_bf16 v[28:31], v[252:255], v[72:75], v[28:31]
    v_mfma_f32_16x16x32_bf16 v[44:47], v[252:255], v[76:79], v[44:47]
    s_mov_b32 s35, 0xbfb8aa3b
    v_mul_f32 v88, s35, v16
    v_mul_f32 v89, s35, v17
    v_mul_f32 v90, s35, v18
    v_mul_f32 v91, s35, v19
    v_mul_f32 v92, s35, v20
    v_mul_f32 v93, s35, v21
    v_mul_f32 v94, s35, v22
    v_mul_f32 v95, s35, v23
    v_exp_f32 v88, v88
    v_exp_f32 v89, v89
    v_exp_f32 v90, v90
    v_exp_f32 v91, v91
    v_exp_f32 v92, v92
    v_exp_f32 v93, v93
    v_exp_f32 v94, v94
    v_exp_f32 v95, v95
    v_mul_f32 v16, v16, v24
    v_mul_f32 v17, v17, v25
    v_mul_f32 v18, v18, v26
    v_mul_f32 v19, v19, v27
    v_mul_f32 v20, v20, v28
    v_mul_f32 v21, v21, v29
    v_mul_f32 v22, v22, v30
    v_mul_f32 v23, v23, v31
    v_add_f32 v88, 1.0, v88
    v_add_f32 v89, 1.0, v89
    v_add_f32 v90, 1.0, v90
    v_add_f32 v91, 1.0, v91
    v_add_f32 v92, 1.0, v92
    v_add_f32 v93, 1.0, v93
    v_add_f32 v94, 1.0, v94
    v_add_f32 v95, 1.0, v95
    v_rcp_f32 v88, v88
    v_rcp_f32 v89, v89
    v_rcp_f32 v90, v90
    v_rcp_f32 v91, v91
    v_rcp_f32 v92, v92
    v_rcp_f32 v93, v93
    v_rcp_f32 v94, v94
    v_rcp_f32 v95, v95
    v_mul_f32 v16, v16, v88
    v_mul_f32 v17, v17, v89
    v_mul_f32 v18, v18, v90
    v_mul_f32 v19, v19, v91
    v_mul_f32 v20, v20, v92
    v_mul_f32 v21, v21, v93
    v_mul_f32 v22, v22, v94
    v_mul_f32 v23, v23, v95
    v_cvt_pk_bf16_f32 v80, v16, v20
    v_cvt_pk_bf16_f32 v81, v17, v21
    v_cvt_pk_bf16_f32 v82, v18, v22
    v_cvt_pk_bf16_f32 v83, v19, v23
    buffer_store_dwordx4 v[80:83], v0, s[12:15], s56 offen sc1
    v_mul_f32 v88, s35, v32
    v_mul_f32 v89, s35, v33
    v_mul_f32 v90, s35, v34
    v_mul_f32 v91, s35, v35
    v_mul_f32 v92, s35, v36
    v_mul_f32 v93, s35, v37
    v_mul_f32 v94, s35, v38
    v_mul_f32 v95, s35, v39
    v_exp_f32 v88, v88
    v_exp_f32 v89, v89
    v_exp_f32 v90, v90
    v_exp_f32 v91, v91
    v_exp_f32 v92, v92
    v_exp_f32 v93, v93
    v_exp_f32 v94, v94
    v_exp_f32 v95, v95
    v_mul_f32 v32, v32, v40
    v_mul_f32 v33, v33, v41
    v_mul_f32 v34, v34, v42
    v_mul_f32 v35, v35, v43
    v_mul_f32 v36, v36, v44
    v_mul_f32 v37, v37, v45
    v_mul_f32 v38, v38, v46
    v_mul_f32 v39, v39, v47
    v_add_f32 v88, 1.0, v88
    v_add_f32 v89, 1.0, v89
    v_add_f32 v90, 1.0, v90
    v_add_f32 v91, 1.0, v91
    v_add_f32 v92, 1.0, v92
    v_add_f32 v93, 1.0, v93
    v_add_f32 v94, 1.0, v94
    v_add_f32 v95, 1.0, v95
    v_rcp_f32 v88, v88
    v_rcp_f32 v89, v89
    v_rcp_f32 v90, v90
    v_rcp_f32 v91, v91
    v_rcp_f32 v92, v92
    v_rcp_f32 v93, v93
    v_rcp_f32 v94, v94
    v_rcp_f32 v95, v95
    v_mul_f32 v32, v32, v88
    v_mul_f32 v33, v33, v89
    v_mul_f32 v34, v34, v90
    v_mul_f32 v35, v35, v91
    v_mul_f32 v36, v36, v92
    v_mul_f32 v37, v37, v93
    v_mul_f32 v38, v38, v94
    v_mul_f32 v39, v39, v95
    v_cvt_pk_bf16_f32 v84, v32, v36
    v_cvt_pk_bf16_f32 v85, v33, v37
    v_cvt_pk_bf16_f32 v86, v34, v38
    v_cvt_pk_bf16_f32 v87, v35, v39
    s_add_u32 s58, s56, 65536
    buffer_store_dwordx4 v[84:87], v0, s[12:15], s58 offen sc1
    s_add_u32 s46, s46, s47
    s_add_u32 s52, s52, s54
    s_add_u32 s56, s56, s57
    s_add_u32 s53, s55, s50
    s_add_u32 s55, s55, 40960
    s_cmp_eq_u32 s55, 122880
    s_cselect_b32 s55, 0, s55
    s_waitcnt vmcnt(12)
    s_barrier
    s_cmp_lt_u32 s46, 64
    s_cbranch_scc1 LH_tile
    s_waitcnt vmcnt(0)
    s_branch LW_p1b_done
LW_gate:
    s_mov_b32 s36, s64
    s_mov_b32 s37, s65
    s_mov_b32 s38, 0x500
    s_mov_b32 s39, 0x00020000
    s_sub_u32 s46, s30, 180
    s_lshl_b32 s46, s46, 2
    s_add_u32 s46, s46, s31
    v_lshrrev_b32 v4, 8, v0
    v_lshlrev_b32 v4, 4, v4
    buffer_load_dwordx4 v[16:19], v4, s[36:39], 0 offen offset:0
    buffer_load_dwordx4 v[20:23], v4, s[36:39], 0 offen offset:64
    buffer_load_dwordx4 v[24:27], v4, s[36:39], 0 offen offset:128
    buffer_load_dwordx4 v[28:31], v4, s[36:39], 0 offen offset:192
    buffer_load_dwordx4 v[32:35], v4, s[36:39], 0 offen offset:256
    buffer_load_dwordx4 v[36:39], v4, s[36:39], 0 offen offset:320
    buffer_load_dwordx4 v[40:43], v4, s[36:39], 0 offen offset:384
    buffer_load_dwordx4 v[44:47], v4, s[36:39], 0 offen offset:448
    buffer_load_dwordx4 v[48:51], v4, s[36:39], 0 offen offset:512
    buffer_load_dwordx4 v[52:55], v4, s[36:39], 0 offen offset:576
    buffer_load_dwordx4 v[56:59], v4, s[36:39], 0 offen offset:640
    buffer_load_dwordx4 v[60:63], v4, s[36:39], 0 offen offset:704
    buffer_load_dwordx4 v[64:67], v4, s[36:39], 0 offen offset:768
    buffer_load_dwordx4 v[68:71], v4, s[36:39], 0 offen offset:832
    buffer_load_dwordx4 v[72:75], v4, s[36:39], 0 offen offset:896
    buffer_load_dwordx4 v[76:79], v4, s[36:39], 0 offen offset:960
    buffer_load_dwordx4 v[80:83], v4, s[36:39], 0 offen offset:1024
    buffer_load_dwordx4 v[84:87], v4, s[36:39], 0 offen offset:1088
    buffer_load_dwordx4 v[88:91], v4, s[36:39], 0 offen offset:1152
    buffer_load_dwordx4 v[92:95], v4, s[36:39], 0 offen offset:1216
    v_bfe_u32 v5, v0, 4, 4
    v_mul_u32_u24 v6, 1280, v5
    v_add_u32 v6, v6, v4
    v_lshlrev_b32 v7, 2, v5
    s_mov_b32 s35, 0xbfb8aa3b
LG_loop:
    s_mul_i32 s50, s46, 20480
    s_lshl_b32 s51, s46, 6
    s_add_u32 s51, s51, 79691776
    buffer_load_dwordx4 v[96:99], v6, s[16:19], s50 offen offset:0
    buffer_load_dwordx4 v[100:103], v6, s[16:19], s50 offen offset:64
    buffer_load_dwordx4 v[104:107], v6, s[16:19], s50 offen offset:128
    buffer_load_dwordx4 v[108:111], v6, s[16:19], s50 offen offset:192
    buffer_load_dwordx4 v[112:115], v6, s[16:19], s50 offen offset:256
    buffer_load_dwordx4 v[116:119], v6, s[16:19], s50 offen offset:320
    buffer_load_dwordx4 v[120:123], v6, s[16:19], s50 offen offset:384
    buffer_load_dwordx4 v[124:127], v6, s[16:19], s50 offen offset:448
    buffer_load_dwordx4 v[128:131], v6, s[16:19], s50 offen offset:512
    buffer_load_dwordx4 v[132:135], v6, s[16:19], s50 offen offset:576
    buffer_load_dwordx4 v[136:139], v6, s[16:19], s50 offen offset:640
    buffer_load_dwordx4 v[140:143], v6, s[16:19], s50 offen offset:704
    buffer_load_dwordx4 v[144:147], v6, s[16:19], s50 offen offset:768
    buffer_load_dwordx4 v[148:151], v6, s[16:19], s50 offen offset:832
    buffer_load_dwordx4 v[152:155], v6, s[16:19], s50 offen offset:896
    buffer_load_dwordx4 v[156:159], v6, s[16:19], s50 offen offset:960
    buffer_load_dwordx4 v[160:163], v6, s[16:19], s50 offen offset:1024
    buffer_load_dwordx4 v[164:167], v6, s[16:19], s50 offen offset:1088
    buffer_load_dwordx4 v[168:171], v6, s[16:19], s50 offen offset:1152
    buffer_load_dwordx4 v[172:175], v6, s[16:19], s50 offen offset:1216
    s_waitcnt vmcnt(19)
    v_mfma_f32_16x16x32_bf16 v[176:179], v[16:19], v[96:99], 0
    s_waitcnt vmcnt(18)
    v_mfma_f32_16x16x32_bf16 v[176:179], v[20:23], v[100:103], v[176:179]
    s_waitcnt vmcnt(17)
    v_mfma_f32_16x16x32_bf16 v[176:179], v[24:27], v[104:107], v[176:179]
    s_waitcnt vmcnt(16)
    v_mfma_f32_16x16x32_bf16 v[176:179], v[28:31], v[108:111], v[176:179]
    s_waitcnt vmcnt(15)
    v_mfma_f32_16x16x32_bf16 v[176:179], v[32:35], v[112:115], v[176:179]
    s_waitcnt vmcnt(14)
    v_mfma_f32_16x16x32_bf16 v[176:179], v[36:39], v[116:119], v[176:179]
    s_waitcnt vmcnt(13)
    v_mfma_f32_16x16x32_bf16 v[176:179], v[40:43], v[120:123], v[176:179]
    s_waitcnt vmcnt(12)
    v_mfma_f32_16x16x32_bf16 v[176:179], v[44:47], v[124:127], v[176:179]
    s_waitcnt vmcnt(11)
    v_mfma_f32_16x16x32_bf16 v[176:179], v[48:51], v[128:131], v[176:179]
    s_waitcnt vmcnt(10)
    v_mfma_f32_16x16x32_bf16 v[176:179], v[52:55], v[132:135], v[176:179]
    s_waitcnt vmcnt(9)
    v_mfma_f32_16x16x32_bf16 v[176:179], v[56:59], v[136:139], v[176:179]
    s_waitcnt vmcnt(8)
    v_mfma_f32_16x16x32_bf16 v[176:179], v[60:63], v[140:143], v[176:179]
    s_waitcnt vmcnt(7)
    v_mfma_f32_16x16x32_bf16 v[176:179], v[64:67], v[144:147], v[176:179]
    s_waitcnt vmcnt(6)
    v_mfma_f32_16x16x32_bf16 v[176:179], v[68:71], v[148:151], v[176:179]
    s_waitcnt vmcnt(5)
    v_mfma_f32_16x16x32_bf16 v[176:179], v[72:75], v[152:155], v[176:179]
    s_waitcnt vmcnt(4)
    v_mfma_f32_16x16x32_bf16 v[176:179], v[76:79], v[156:159], v[176:179]
    s_waitcnt vmcnt(3)
    v_mfma_f32_16x16x32_bf16 v[176:179], v[80:83], v[160:163], v[176:179]
    s_waitcnt vmcnt(2)
    v_mfma_f32_16x16x32_bf16 v[176:179], v[84:87], v[164:167], v[176:179]
    s_waitcnt vmcnt(1)
    v_mfma_f32_16x16x32_bf16 v[176:179], v[88:91], v[168:171], v[176:179]
    s_waitcnt vmcnt(0)
    v_mfma_f32_16x16x32_bf16 v[176:179], v[92:95], v[172:175], v[176:179]
    s_nop 7
    v_mul_f32 v176, s35, v176
    v_exp_f32 v176, v176
    s_nop 0
    v_add_f32 v176, 1.0, v176
    v_rcp_f32 v176, v176
    s_mov_b64 exec, 0xffff
    buffer_store_dword v176, v7, s[12:15], s51 offen sc1
    s_mov_b64 exec, -1
    s_add_u32 s46, s46, 48
    s_cmp_lt_u32 s46, 128
    s_cbranch_scc1 LG_loop
    s_waitcnt vmcnt(0)
LW_p1b_done:
    s_barrier
    s_cmp_lg_u32 s31, 0
    s_cbranch_scc1 LSG_2
    v_mov_b32 v4, 192
    v_mov_b32 v5, 1
    s_mov_b64 exec, 1
    buffer_atomic_add v5, v4, s[8:11], 0 offen
    s_mov_b64 exec, -1
LSG_2:
    s_lshr_b32 s46, s30, 5
    s_and_b32 s47, s30, 31
    s_cmp_ge_u32 s47, 28
    s_cbranch_scc1 L_wend
    s_cmp_ge_u32 s47, 20
    s_cbranch_scc1 LW_attn
    s_load_dwordx2 s[20:21], s[0:1], 40
    s_load_dwordx2 s[22:23], s[0:1], 80
    s_load_dwordx2 s[24:25], s[0:1], 96
    s_mul_i32 s33, s31, 36864
    v_lshrrev_b32 v4, 6, v0
    v_lshlrev_b32 v4, 6, v4
    v_bfe_u32 v5, v0, 4, 2
    v_lshl_add_u32 v1, v5, 4, v4
    v_add_u32 v1, s33, v1
    v_lshrrev_b32 v4, 8, v0
    v_mul_u32_u24 v4, 4, v4
    v_bfe_u32 v5, v0, 6, 2
    v_lshrrev_b32 v6, 1, v5
    v_add_u32 v4, v4, v6
    v_and_b32 v5, 1, v5
    v_lshl_add_u32 v4, v5, 4, v4
    s_mov_b32 s34, 1280
    v_mul_lo_u32 v4, v4, s34
    v_bfe_u32 v5, v0, 4, 2
    v_lshl_add_u32 v12, v5, 4, v4
    s_waitcnt lgkmcnt(0)
    s_mov_b32 s36, s20
    s_mov_b32 s37, s21
    s_mov_b32 s38, 0x500000
    s_mov_b32 s39, 0x00020000
    s_mov_b32 s40, s22
    s_mov_b32 s41, s23
    s_mov_b32 s42, 0x21c000
    s_mov_b32 s43, 0x00020000
    s_mov_b32 s16, s24
    s_mov_b32 s17, s25
    s_mov_b32 s18, 0x280000
    s_mov_b32 s19, 0x00020000
    s_lshl_b32 s34, s47, 6
    s_mul_i32 s44, s31, 1310720
    s_add_u32 s44, s44, s34
    s_mul_i32 s45, s31, 573440
    s_add_u32 s45, s45, s34
    s_barrier
    s_add_u32 s34, s45, 0
    s_add_u32 m0, s33, 0
    s_nop 0
    buffer_load_dwordx4 v12, s[40:43], s34 offen lds
    s_add_u32 s34, s45, 2560
    s_add_u32 m0, s33, 1024
    s_nop 0
    buffer_load_dwordx4 v12, s[40:43], s34 offen lds
    s_add_u32 s34, s45, 40960
    s_add_u32 m0, s33, 2048
    s_nop 0
    buffer_load_dwordx4 v12, s[40:43], s34 offen lds
    s_add_u32 s34, s45, 43520
    s_add_u32 m0, s33, 3072
    s_nop 0
    buffer_load_dwordx4 v12, s[40:43], s34 offen lds
    s_add_u32 s34, s45, 81920
    s_add_u32 m0, s33, 4096
    s_nop 0
    buffer_load_dwordx4 v12, s[40:43], s34 offen lds
    s_add_u32 s34, s45, 84480
    s_add_u32 m0, s33, 5120
    s_nop 0
    buffer_load_dwordx4 v12, s[40:43], s34 offen lds
    s_add_u32 s34, s45, 122880
    s_add_u32 m0, s33, 6144
    s_nop 0
    buffer_load_dwordx4 v12, s[40:43], s34 offen lds
    s_add_u32 s34, s45, 125440
    s_add_u32 m0, s33, 7168
    s_nop 0
    buffer_load_dwordx4 v12, s[40:43], s34 offen lds
    s_add_u32 s34, s45, 163840
    s_add_u32 m0, s33, 8192
    s_nop 0
    buffer_load_dwordx4 v12, s[40:43], s34 offen lds
    s_add_u32 s34, s45, 166400
    s_add_u32 m0, s33, 9216
    s_nop 0
    buffer_load_dwordx4 v12, s[40:43], s34 offen lds
    s_add_u32 s34, s45, 204800
    s_add_u32 m0, s33, 10240
    s_nop 0
    buffer_load_dwordx4 v12, s[40:43], s34 offen lds
    s_add_u32 s34, s45, 207360
    s_add_u32 m0, s33, 11264
    s_nop 0
    buffer_load_dwordx4 v12, s[40:43], s34 offen lds
    s_add_u32 s34, s45, 245760
    s_add_u32 m0, s33, 12288
    s_nop 0
    buffer_load_dwordx4 v12, s[40:43], s34 offen lds
    s_add_u32 s34, s45, 248320
    s_add_u32 m0, s33, 13312
    s_nop 0
    buffer_load_dwordx4 v12, s[40:43], s34 offen lds
    s_add_u32 s34, s45, 286720
    s_add_u32 m0, s33, 14336
    s_nop 0
    buffer_load_dwordx4 v12, s[40:43], s34 offen lds
    s_add_u32 s34, s45, 289280
    s_add_u32 m0, s33, 15360
    s_nop 0
    buffer_load_dwordx4 v12, s[40:43], s34 offen lds
    s_add_u32 s34, s45, 327680
    s_add_u32 m0, s33, 16384
    s_nop 0
    buffer_load_dwordx4 v12, s[40:43], s34 offen lds
    s_add_u32 s34, s45, 330240
    s_add_u32 m0, s33, 17408
    s_nop 0
    buffer_load_dwordx4 v12, s[40:43], s34 offen lds
    s_add_u32 s34, s45, 368640
    s_add_u32 m0, s33, 18432
    s_nop 0
    buffer_load_dwordx4 v12, s[40:43], s34 offen lds
    s_add_u32 s34, s45, 371200
    s_add_u32 m0, s33, 19456
    s_nop 0
    buffer_load_dwordx4 v12, s[40:43], s34 offen lds
    s_add_u32 s34, s45, 409600
    s_add_u32 m0, s33, 20480
    s_nop 0
    buffer_load_dwordx4 v12, s[40:43], s34 offen lds
    s_add_u32 s34, s45, 412160
    s_add_u32 m0, s33, 21504
    s_nop 0
    buffer_load_dwordx4 v12, s[40:43], s34 offen lds
    s_add_u32 s34, s45, 450560
    s_add_u32 m0, s33, 22528
    s_nop 0
    buffer_load_dwordx4 v12, s[40:43], s34 offen lds
    s_add_u32 s34, s45, 453120
    s_add_u32 m0, s33, 23552
    s_nop 0
    buffer_load_dwordx4 v12, s[40:43], s34 offen lds
    s_add_u32 s34, s45, 491520
    s_add_u32 m0, s33, 24576
    s_nop 0
    buffer_load_dwordx4 v12, s[40:43], s34 offen lds
    s_add_u32 s34, s45, 494080
    s_add_u32 m0, s33, 25600
    s_nop 0
    buffer_load_dwordx4 v12, s[40:43], s34 offen lds
    s_add_u32 s34, s45, 532480
    s_add_u32 m0, s33, 26624
    s_nop 0
    buffer_load_dwordx4 v12, s[40:43], s34 offen lds
    s_add_u32 s34, s45, 535040
    s_add_u32 m0, s33, 27648
    s_nop 0
    buffer_load_dwordx4 v12, s[40:43], s34 offen lds
    s_add_u32 s34, s44, 0
    s_add_u32 m0, s33, 28672
    s_nop 0
    buffer_load_dwordx4 v12, s[36:39], s34 offen lds
    s_add_u32 s34, s44, 2560
    s_add_u32 m0, s33, 29696
    s_nop 0
    buffer_load_dwordx4 v12, s[36:39], s34 offen lds
    s_add_u32 s34, s44, 40960
    s_add_u32 m0, s33, 30720
    s_nop 0
    buffer_load_dwordx4 v12, s[36:39], s34 offen lds
    s_add_u32 s34, s44, 43520
    s_add_u32 m0, s33, 31744
    s_nop 0
    buffer_load_dwordx4 v12, s[36:39], s34 offen lds
    s_add_u32 s34, s44, 81920
    s_add_u32 m0, s33, 32768
    s_nop 0
    buffer_load_dwordx4 v12, s[36:39], s34 offen lds
    s_add_u32 s34, s44, 84480
    s_add_u32 m0, s33, 33792
    s_nop 0
    buffer_load_dwordx4 v12, s[36:39], s34 offen lds
    s_add_u32 s34, s44, 122880
    s_add_u32 m0, s33, 34816
    s_nop 0
    buffer_load_dwordx4 v12, s[36:39], s34 offen lds
    s_add_u32 s34, s44, 125440
    s_add_u32 m0, s33, 35840
    s_nop 0
    buffer_load_dwordx4 v12, s[36:39], s34 offen lds
    s_waitcnt vmcnt(32)
    ds_read_b64_tr_b16 v[144:145], v1 offset:0
    ds_read_b64_tr_b16 v[146:147], v1 offset:1024
    ds_read_b64_tr_b16 v[148:149], v1 offset:2048
    ds_read_b64_tr_b16 v[150:151], v1 offset:3072
    ds_read_b64_tr_b16 v[152:153], v1 offset:8
    ds_read_b64_tr_b16 v[154:155], v1 offset:1032
    ds_read_b64_tr_b16 v[156:157], v1 offset:2056
    ds_read_b64_tr_b16 v[158:159], v1 offset:3080
    s_waitcnt lgkmcnt(0)
    s_add_u32 s34, s44, 163840
    s_add_u32 m0, s33, 0
    s_nop 0
    buffer_load_dwordx4 v12, s[36:39], s34 offen lds
    s_add_u32 s34, s44, 166400
    s_add_u32 m0, s33, 1024
    s_nop 0
    buffer_load_dwordx4 v12, s[36:39], s34 offen lds
    s_add_u32 s34, s44, 204800
    s_add_u32 m0, s33, 2048
    s_nop 0
    buffer_load_dwordx4 v12, s[36:39], s34 offen lds
    s_add_u32 s34, s44, 207360
    s_add_u32 m0, s33, 3072
    s_nop 0
    buffer_load_dwordx4 v12, s[36:39], s34 offen lds
    s_waitcnt vmcnt(32)
    ds_read_b64_tr_b16 v[160:161], v1 offset:4096
    ds_read_b64_tr_b16 v[162:163], v1 offset:5120
    ds_read_b64_tr_b16 v[164:165], v1 offset:6144
    ds_read_b64_tr_b16 v[166:167], v1 offset:7168
    ds_read_b64_tr_b16 v[168:169], v1 offset:4104
    ds_read_b64_tr_b16 v[170:171], v1 offset:5128
    ds_read_b64_tr_b16 v[172:173], v1 offset:6152
    ds_read_b64_tr_b16 v[174:175], v1 offset:7176
    s_waitcnt lgkmcnt(0)
    s_add_u32 s34, s44, 245760
    s_add_u32 m0, s33, 4096
    s_nop 0
    buffer_load_dwordx4 v12, s[36:39], s34 offen lds
    s_add_u32 s34, s44, 248320
    s_add_u32 m0, s33, 5120
    s_nop 0
    buffer_load_dwordx4 v12, s[36:39], s34 offen lds
    s_add_u32 s34, s44, 286720
    s_add_u32 m0, s33, 6144
    s_nop 0
    buffer_load_dwordx4 v12, s[36:39], s34 offen lds
    s_add_u32 s34, s44, 289280
    s_add_u32 m0, s33, 7168
    s_nop 0
    buffer_load_dwordx4 v12, s[36:39], s34 offen lds
    s_waitcnt vmcnt(32)
    ds_read_b64_tr_b16 v[176:177], v1 offset:8192
    ds_read_b64_tr_b16 v[178:179], v1 offset:9216
    ds_read_b64_tr_b16 v[180:181], v1 offset:10240
    ds_read_b64_tr_b16 v[182:183], v1 offset:11264
    ds_read_b64_tr_b16 v[184:185], v1 offset:8200
    ds_read_b64_tr_b16 v[186:187], v1 offset:9224
    ds_read_b64_tr_b16 v[188:189], v1 offset:10248
    ds_read_b64_tr_b16 v[190:191], v1 offset:11272
    s_waitcnt lgkmcnt(0)
    s_add_u32 s34, s44, 327680
    s_add_u32 m0, s33, 8192
    s_nop 0
    buffer_load_dwordx4 v12, s[36:39], s34 offen lds
    s_add_u32 s34, s44, 330240
    s_add_u32 m0, s33, 9216
    s_nop 0
    buffer_load_dwordx4 v12, s[36:39], s34 offen lds
    s_add_u32 s34, s44, 368640
    s_add_u32 m0, s33, 10240
    s_nop 0
    buffer_load_dwordx4 v12, s[36:39], s34 offen lds
    s_add_u32 s34, s44, 371200
    s_add_u32 m0, s33, 11264
    s_nop 0
    buffer_load_dwordx4 v12, s[36:39], s34 offen lds
    s_waitcnt vmcnt(32)
    ds_read_b64_tr_b16 v[192:193], v1 offset:12288
    ds_read_b64_tr_b16 v[194:195], v1 offset:13312
    ds_read_b64_tr_b16 v[196:197], v1 offset:14336
    ds_read_b64_tr_b16 v[198:199], v1 offset:15360
    ds_read_b64_tr_b16 v[200:201], v1 offset:12296
    ds_read_b64_tr_b16 v[202:203], v1 offset:13320
    ds_read_b64_tr_b16 v[204:205], v1 offset:14344
    ds_read_b64_tr_b16 v[206:207], v1 offset:15368
    s_waitcnt lgkmcnt(0)
    s_add_u32 s34, s44, 409600
    s_add_u32 m0, s33, 12288
    s_nop 0
    buffer_load_dwordx4 v12, s[36:39], s34 offen lds
    s_add_u32 s34, s44, 412160
    s_add_u32 m0, s33, 13312
    s_nop 0
    buffer_load_dwordx4 v12, s[36:39], s34 offen lds
    s_add_u32 s34, s44, 450560
    s_add_u32 m0, s33, 14336
    s_nop 0
    buffer_load_dwordx4 v12, s[36:39], s34 offen lds
    s_add_u32 s34, s44, 453120
    s_add_u32 m0, s33, 15360
    s_nop 0
    buffer_load_dwordx4 v12, s[36:39], s34 offen lds
    s_waitcnt vmcnt(32)
    ds_read_b64_tr_b16 v[208:209], v1 offset:16384
    ds_read_b64_tr_b16 v[210:211], v1 offset:17408
    ds_read_b64_tr_b16 v[212:213], v1 offset:18432
    ds_read_b64_tr_b16 v[214:215], v1 offset:19456
    ds_read_b64_tr_b16 v[216:217], v1 offset:16392
    ds_read_b64_tr_b16 v[218:219], v1 offset:17416
    ds_read_b64_tr_b16 v[220:221], v1 offset:18440
    ds_read_b64_tr_b16 v[222:223], v1 offset:19464
    s_waitcnt lgkmcnt(0)
    s_add_u32 s34, s44, 491520
    s_add_u32 m0, s33, 16384
    s_nop 0
    buffer_load_dwordx4 v12, s[36:39], s34 offen lds
    s_add_u32 s34, s44, 494080
    s_add_u32 m0, s33, 17408
    s_nop 0
    buffer_load_dwordx4 v12, s[36:39], s34 offen lds
    s_add_u32 s34, s44, 532480
    s_add_u32 m0, s33, 18432
    s_nop 0
    buffer_load_dwordx4 v12, s[36:39], s34 offen lds
    s_add_u32 s34, s44, 535040
    s_add_u32 m0, s33, 19456
    s_nop 0
    buffer_load_dwordx4 v12, s[36:39], s34 offen lds
    s_waitcnt vmcnt(32)
    ds_read_b64_tr_b16 v[224:225], v1 offset:20480
    ds_read_b64_tr_b16 v[226:227], v1 offset:21504
    ds_read_b64_tr_b16 v[228:229], v1 offset:22528
    ds_read_b64_tr_b16 v[230:231], v1 offset:23552
    ds_read_b64_tr_b16 v[232:233], v1 offset:20488
    ds_read_b64_tr_b16 v[234:235], v1 offset:21512
    ds_read_b64_tr_b16 v[236:237], v1 offset:22536
    ds_read_b64_tr_b16 v[238:239], v1 offset:23560
    s_waitcnt lgkmcnt(0)
    s_add_u32 s34, s44, 573440
    s_add_u32 m0, s33, 20480
    s_nop 0
    buffer_load_dwordx4 v12, s[36:39], s34 offen lds
    s_add_u32 s34, s44, 576000
    s_add_u32 m0, s33, 21504
    s_nop 0
    buffer_load_dwordx4 v12, s[36:39], s34 offen lds
    s_add_u32 s34, s44, 614400
    s_add_u32 m0, s33, 22528
    s_nop 0
    buffer_load_dwordx4 v12, s[36:39], s34 offen lds
    s_add_u32 s34, s44, 616960
    s_add_u32 m0, s33, 23552
    s_nop 0
    buffer_load_dwordx4 v12, s[36:39], s34 offen lds
    s_waitcnt vmcnt(32)
    ds_read_b64_tr_b16 v[240:241], v1 offset:24576
    ds_read_b64_tr_b16 v[242:243], v1 offset:25600
    ds_read_b64_tr_b16 v[244:245], v1 offset:26624
    ds_read_b64_tr_b16 v[246:247], v1 offset:27648
    ds_read_b64_tr_b16 v[248:249], v1 offset:24584
    ds_read_b64_tr_b16 v[250:251], v1 offset:25608
    ds_read_b64_tr_b16 v[252:253], v1 offset:26632
    ds_read_b64_tr_b16 v[254:255], v1 offset:27656
    s_waitcnt lgkmcnt(0)
    s_add_u32 s34, s44, 655360
    s_add_u32 m0, s33, 24576
    s_nop 0
    buffer_load_dwordx4 v12, s[36:39], s34 offen lds
    s_add_u32 s34, s44, 657920
    s_add_u32 m0, s33, 25600
    s_nop 0
    buffer_load_dwordx4 v12, s[36:39], s34 offen lds
    s_add_u32 s34, s44, 696320
    s_add_u32 m0, s33, 26624
    s_nop 0
    buffer_load_dwordx4 v12, s[36:39], s34 offen lds
    s_add_u32 s34, s44, 698880
    s_add_u32 m0, s33, 27648
    s_nop 0
    buffer_load_dwordx4 v12, s[36:39], s34 offen lds
    s_waitcnt vmcnt(32)
    ds_read_b64_tr_b16 a[0:1], v1 offset:28672
    ds_read_b64_tr_b16 a[2:3], v1 offset:29696
    ds_read_b64_tr_b16 a[4:5], v1 offset:30720
    ds_read_b64_tr_b16 a[6:7], v1 offset:31744
    ds_read_b64_tr_b16 a[8:9], v1 offset:28680
    ds_read_b64_tr_b16 a[10:11], v1 offset:29704
    ds_read_b64_tr_b16 a[12:13], v1 offset:30728
    ds_read_b64_tr_b16 a[14:15], v1 offset:31752
    s_waitcnt lgkmcnt(0)
    s_add_u32 s34, s44, 737280
    s_add_u32 m0, s33, 28672
    s_nop 0
    buffer_load_dwordx4 v12, s[36:39], s34 offen lds
    s_add_u32 s34, s44, 739840
    s_add_u32 m0, s33, 29696
    s_nop 0
    buffer_load_dwordx4 v12, s[36:39], s34 offen lds
    s_add_u32 s34, s44, 778240
    s_add_u32 m0, s33, 30720
    s_nop 0
    buffer_load_dwordx4 v12, s[36:39], s34 offen lds
    s_add_u32 s34, s44, 780800
    s_add_u32 m0, s33, 31744
    s_nop 0
    buffer_load_dwordx4 v12, s[36:39], s34 offen lds
    s_waitcnt vmcnt(32)
    ds_read_b64_tr_b16 a[16:17], v1 offset:32768
    ds_read_b64_tr_b16 a[18:19], v1 offset:33792
    ds_read_b64_tr_b16 a[20:21], v1 offset:34816
    ds_read_b64_tr_b16 a[22:23], v1 offset:35840
    ds_read_b64_tr_b16 a[24:25], v1 offset:32776
    ds_read_b64_tr_b16 a[26:27], v1 offset:33800
    ds_read_b64_tr_b16 a[28:29], v1 offset:34824
    ds_read_b64_tr_b16 a[30:31], v1 offset:35848
    s_waitcnt lgkmcnt(0)
    s_add_u32 s34, s44, 819200
    s_add_u32 m0, s33, 32768
    s_nop 0
    buffer_load_dwordx4 v12, s[36:39], s34 offen lds
    s_add_u32 s34, s44, 821760
    s_add_u32 m0, s33, 33792
    s_nop 0
    buffer_load_dwordx4 v12, s[36:39], s34 offen lds
    s_add_u32 s34, s44, 860160
    s_add_u32 m0, s33, 34816
    s_nop 0
    buffer_load_dwordx4 v12, s[36:39], s34 offen lds
    s_add_u32 s34, s44, 862720
    s_add_u32 m0, s33, 35840
    s_nop 0
    buffer_load_dwordx4 v12, s[36:39], s34 offen lds
    s_waitcnt vmcnt(32)
    ds_read_b64_tr_b16 a[32:33], v1 offset:0
    ds_read_b64_tr_b16 a[34:35], v1 offset:1024
    ds_read_b64_tr_b16 a[36:37], v1 offset:2048
    ds_read_b64_tr_b16 a[38:39], v1 offset:3072
    ds_read_b64_tr_b16 a[40:41], v1 offset:8
    ds_read_b64_tr_b16 a[42:43], v1 offset:1032
    ds_read_b64_tr_b16 a[44:45], v1 offset:2056
    ds_read_b64_tr_b16 a[46:47], v1 offset:3080
    s_waitcnt lgkmcnt(0)
    s_add_u32 s34, s44, 901120
    s_add_u32 m0, s33, 0
    s_nop 0
    buffer_load_dwordx4 v12, s[36:39], s34 offen lds
    s_add_u32 s34, s44, 903680
    s_add_u32 m0, s33, 1024
    s_nop 0
    buffer_load_dwordx4 v12, s[36:39], s34 offen lds
    s_add_u32 s34, s44, 942080
    s_add_u32 m0, s33, 2048
    s_nop 0
    buffer_load_dwordx4 v12, s[36:39], s34 offen lds
    s_add_u32 s34, s44, 944640
    s_add_u32 m0, s33, 3072
    s_nop 0
    buffer_load_dwordx4 v12, s[36:39], s34 offen lds
    s_waitcnt vmcnt(32)
    ds_read_b64_tr_b16 a[48:49], v1 offset:4096
    ds_read_b64_tr_b16 a[50:51], v1 offset:5120
    ds_read_b64_tr_b16 a[52:53], v1 offset:6144
    ds_read_b64_tr_b16 a[54:55], v1 offset:7168
    ds_read_b64_tr_b16 a[56:57], v1 offset:4104
    ds_read_b64_tr_b16 a[58:59], v1 offset:5128
    ds_read_b64_tr_b16 a[60:61], v1 offset:6152
    ds_read_b64_tr_b16 a[62:63], v1 offset:7176
    s_waitcnt lgkmcnt(0)
    s_add_u32 s34, s44, 983040
    s_add_u32 m0, s33, 4096
    s_nop 0
    buffer_load_dwordx4 v12, s[36:39], s34 offen lds
    s_add_u32 s34, s44, 985600
    s_add_u32 m0, s33, 5120
    s_nop 0
    buffer_load_dwordx4 v12, s[36:39], s34 offen lds
    s_add_u32 s34, s44, 1024000
    s_add_u32 m0, s33, 6144
    s_nop 0
    buffer_load_dwordx4 v12, s[36:39], s34 offen lds
    s_add_u32 s34, s44, 1026560
    s_add_u32 m0, s33, 7168
    s_nop 0
    buffer_load_dwordx4 v12, s[36:39], s34 offen lds
    s_waitcnt vmcnt(32)
    ds_read_b64_tr_b16 a[64:65], v1 offset:8192
    ds_read_b64_tr_b16 a[66:67], v1 offset:9216
    ds_read_b64_tr_b16 a[68:69], v1 offset:10240
    ds_read_b64_tr_b16 a[70:71], v1 offset:11264
    ds_read_b64_tr_b16 a[72:73], v1 offset:8200
    ds_read_b64_tr_b16 a[74:75], v1 offset:9224
    ds_read_b64_tr_b16 a[76:77], v1 offset:10248
    ds_read_b64_tr_b16 a[78:79], v1 offset:11272
    s_waitcnt lgkmcnt(0)
    s_add_u32 s34, s44, 1064960
    s_add_u32 m0, s33, 8192
    s_nop 0
    buffer_load_dwordx4 v12, s[36:39], s34 offen lds
    s_add_u32 s34, s44, 1067520
    s_add_u32 m0, s33, 9216
    s_nop 0
    buffer_load_dwordx4 v12, s[36:39], s34 offen lds
    s_add_u32 s34, s44, 1105920
    s_add_u32 m0, s33, 10240
    s_nop 0
    buffer_load_dwordx4 v12, s[36:39], s34 offen lds
    s_add_u32 s34, s44, 1108480
    s_add_u32 m0, s33, 11264
    s_nop 0
    buffer_load_dwordx4 v12, s[36:39], s34 offen lds
    s_waitcnt vmcnt(32)
    ds_read_b64_tr_b16 a[80:81], v1 offset:12288
    ds_read_b64_tr_b16 a[82:83], v1 offset:13312
    ds_read_b64_tr_b16 a[84:85], v1 offset:14336
    ds_read_b64_tr_b16 a[86:87], v1 offset:15360
    ds_read_b64_tr_b16 a[88:89], v1 offset:12296
    ds_read_b64_tr_b16 a[90:91], v1 offset:13320
    ds_read_b64_tr_b16 a[92:93], v1 offset:14344
    ds_read_b64_tr_b16 a[94:95], v1 offset:15368
    s_waitcnt lgkmcnt(0)
    s_add_u32 s34, s44, 1146880
    s_add_u32 m0, s33, 12288
    s_nop 0
    buffer_load_dwordx4 v12, s[36:39], s34 offen lds
    s_add_u32 s34, s44, 1149440
    s_add_u32 m0, s33, 13312
    s_nop 0
    buffer_load_dwordx4 v12, s[36:39], s34 offen lds
    s_add_u32 s34, s44, 1187840
    s_add_u32 m0, s33, 14336
    s_nop 0
    buffer_load_dwordx4 v12, s[36:39], s34 offen lds
    s_add_u32 s34, s44, 1190400
    s_add_u32 m0, s33, 15360
    s_nop 0
    buffer_load_dwordx4 v12, s[36:39], s34 offen lds
    s_waitcnt vmcnt(32)
    ds_read_b64_tr_b16 a[96:97], v1 offset:16384
    ds_read_b64_tr_b16 a[98:99], v1 offset:17408
    ds_read_b64_tr_b16 a[100:101], v1 offset:18432
    ds_read_b64_tr_b16 a[102:103], v1 offset:19456
    ds_read_b64_tr_b16 a[104:105], v1 offset:16392
    ds_read_b64_tr_b16 a[106:107], v1 offset:17416
    ds_read_b64_tr_b16 a[108:109], v1 offset:18440
    ds_read_b64_tr_b16 a[110:111], v1 offset:19464
    s_waitcnt lgkmcnt(0)
    s_add_u32 s34, s44, 1228800
    s_add_u32 m0, s33, 16384
    s_nop 0
    buffer_load_dwordx4 v12, s[36:39], s34 offen lds
    s_add_u32 s34, s44, 1231360
    s_add_u32 m0, s33, 17408
    s_nop 0
    buffer_load_dwordx4 v12, s[36:39], s34 offen lds
    s_add_u32 s34, s44, 1269760
    s_add_u32 m0, s33, 18432
    s_nop 0
    buffer_load_dwordx4 v12, s[36:39], s34 offen lds
    s_add_u32 s34, s44, 1272320
    s_add_u32 m0, s33, 19456
    s_nop 0
    buffer_load_dwordx4 v12, s[36:39], s34 offen lds
    s_waitcnt vmcnt(32)
    ds_read_b64_tr_b16 a[112:113], v1 offset:20480
    ds_read_b64_tr_b16 a[114:115], v1 offset:21504
    ds_read_b64_tr_b16 a[116:117], v1 offset:22528
    ds_read_b64_tr_b16 a[118:119], v1 offset:23552
    ds_read_b64_tr_b16 a[120:121], v1 offset:20488
    ds_read_b64_tr_b16 a[122:123], v1 offset:21512
    ds_read_b64_tr_b16 a[124:125], v1 offset:22536
    ds_read_b64_tr_b16 a[126:127], v1 offset:23560
    s_waitcnt vmcnt(28)
    ds_read_b64_tr_b16 a[128:129], v1 offset:24576
    ds_read_b64_tr_b16 a[130:131], v1 offset:25600
    ds_read_b64_tr_b16 a[132:133], v1 offset:26624
    ds_read_b64_tr_b16 a[134:135], v1 offset:27648
    ds_read_b64_tr_b16 a[136:137], v1 offset:24584
    ds_read_b64_tr_b16 a[138:139], v1 offset:25608
    ds_read_b64_tr_b16 a[140:141], v1 offset:26632
    ds_read_b64_tr_b16 a[142:143], v1 offset:27656
    s_waitcnt vmcnt(24)
    ds_read_b64_tr_b16 a[144:145], v1 offset:28672
    ds_read_b64_tr_b16 a[146:147], v1 offset:29696
    ds_read_b64_tr_b16 a[148:149], v1 offset:30720
    ds_read_b64_tr_b16 a[150:151], v1 offset:31744
    ds_read_b64_tr_b16 a[152:153], v1 offset:28680
    ds_read_b64_tr_b16 a[154:155], v1 offset:29704
    ds_read_b64_tr_b16 a[156:157], v1 offset:30728
    ds_read_b64_tr_b16 a[158:159], v1 offset:31752
    s_waitcnt vmcnt(20)
    ds_read_b64_tr_b16 a[160:161], v1 offset:32768
    ds_read_b64_tr_b16 a[162:163], v1 offset:33792
    ds_read_b64_tr_b16 a[164:165], v1 offset:34816
    ds_read_b64_tr_b16 a[166:167], v1 offset:35840
    ds_read_b64_tr_b16 a[168:169], v1 offset:32776
    ds_read_b64_tr_b16 a[170:171], v1 offset:33800
    ds_read_b64_tr_b16 a[172:173], v1 offset:34824
    ds_read_b64_tr_b16 a[174:175], v1 offset:35848
    s_waitcnt vmcnt(16)
    ds_read_b64_tr_b16 a[176:177], v1 offset:0
    ds_read_b64_tr_b16 a[178:179], v1 offset:1024
    ds_read_b64_tr_b16 a[180:181], v1 offset:2048
    ds_read_b64_tr_b16 a[182:183], v1 offset:3072
    ds_read_b64_tr_b16 a[184:185], v1 offset:8
    ds_read_b64_tr_b16 a[186:187], v1 offset:1032
    ds_read_b64_tr_b16 a[188:189], v1 offset:2056
    ds_read_b64_tr_b16 a[190:191], v1 offset:3080
    s_waitcnt vmcnt(12)
    ds_read_b64_tr_b16 a[192:193], v1 offset:4096
    ds_read_b64_tr_b16 a[194:195], v1 offset:5120
    ds_read_b64_tr_b16 a[196:197], v1 offset:6144
    ds_read_b64_tr_b16 a[198:199], v1 offset:7168
    ds_read_b64_tr_b16 a[200:201], v1 offset:4104
    ds_read_b64_tr_b16 a[202:203], v1 offset:5128
    ds_read_b64_tr_b16 a[204:205], v1 offset:6152
    ds_read_b64_tr_b16 a[206:207], v1 offset:7176
    s_waitcnt vmcnt(8)
    ds_read_b64_tr_b16 a[208:209], v1 offset:8192
    ds_read_b64_tr_b16 a[210:211], v1 offset:9216
    ds_read_b64_tr_b16 a[212:213], v1 offset:10240
    ds_read_b64_tr_b16 a[214:215], v1 offset:11264
    ds_read_b64_tr_b16 a[216:217], v1 offset:8200
    ds_read_b64_tr_b16 a[218:219], v1 offset:9224
    ds_read_b64_tr_b16 a[220:221], v1 offset:10248
    ds_read_b64_tr_b16 a[222:223], v1 offset:11272
    s_waitcnt vmcnt(4)
    ds_read_b64_tr_b16 a[224:225], v1 offset:12288
    ds_read_b64_tr_b16 a[226:227], v1 offset:13312
    ds_read_b64_tr_b16 a[228:229], v1 offset:14336
    ds_read_b64_tr_b16 a[230:231], v1 offset:15360
    ds_read_b64_tr_b16 a[232:233], v1 offset:12296
    ds_read_b64_tr_b16 a[234:235], v1 offset:13320
    ds_read_b64_tr_b16 a[236:237], v1 offset:14344
    ds_read_b64_tr_b16 a[238:239], v1 offset:15368
    s_waitcnt vmcnt(0)
    ds_read_b64_tr_b16 a[240:241], v1 offset:16384
    ds_read_b64_tr_b16 a[242:243], v1 offset:17408
    ds_read_b64_tr_b16 a[244:245], v1 offset:18432
    ds_read_b64_tr_b16 a[246:247], v1 offset:19456
    ds_read_b64_tr_b16 a[248:249], v1 offset:16392
    ds_read_b64_tr_b16 a[250:251], v1 offset:17416
    ds_read_b64_tr_b16 a[252:253], v1 offset:18440
    ds_read_b64_tr_b16 a[254:255], v1 offset:19464
    s_waitcnt vmcnt(0) lgkmcnt(0)
    s_barrier
    s_cmp_lg_u32 s31, 0
    s_cbranch_scc1 LW_w1_ok
    v_mov_b32 v4, 192
    s_mov_b32 s34, 0
LW_w1:
    buffer_load_dword v5, v4, s[8:11], 0 offen sc1
    s_add_u32 s34, s34, 1
    s_cmp_gt_u32 s34, 2000000
    s_cbranch_scc1 L_wend
    s_waitcnt vmcnt(0)
    v_readfirstlane_b32 s35, v5
    s_nop 0
    s_cmp_ge_u32 s35, 192
    s_cbranch_scc1 LW_w1_ok
    s_sleep 16
    s_branch LW_w1
LW_w1_ok:
    s_barrier
    s_and_b32 s58, s46, 1
    s_lshr_b32 s46, s46, 1
    v_bfe_u32 v10, v0, 4, 4
    v_mul_u32_u24 v14, 1280, v10
    v_lshrrev_b32 v11, 8, v0
    v_lshl_add_u32 v14, v11, 4, v14
    v_lshlrev_b32 v2, 2, v10
    s_lshl_b32 s34, s31, 11
    v_add_u32 v15, s34, v0
    s_mul_i32 s48, s31, 14336
    s_lshl_b32 s34, s58, 16
    s_add_u32 s48, s48, s34
    s_add_u32 s48, s48, 67108864
    s_lshl_b32 s49, s31, 15
    s_lshl_b32 s34, s58, 17
    s_add_u32 s49, s49, s34
    s_add_u32 s49, s49, 50331648
    s_mul_i32 s50, s58, 20480
    s_lshl_b32 s34, s47, 6
    s_add_u32 s50, s50, s34
    s_lshl_b32 s60, s58, 6
    s_add_u32 s60, s60, 79691776
LP_loop:
    s_lshl_b32 s51, s46, 17
    s_add_u32 s51, s51, s48
    s_lshl_b32 s52, s46, 18
    s_add_u32 s52, s52, s49
    s_lshl_b32 s53, s46, 7
    s_add_u32 s54, s53, s60
    s_add_u32 s53, s54, 35655680
    buffer_load_dword v12, v2, s[12:15], s54 offen sc1
    s_add_u32 s56, s51, 0
    buffer_load_dwordx4 v[32:35], v0, s[12:15], s56 offen offset:0 sc1
    buffer_load_dwordx4 v[36:39], v0, s[12:15], s56 offen offset:1024 sc1
    buffer_load_dwordx4 v[40:43], v0, s[12:15], s56 offen offset:2048 sc1
    buffer_load_dwordx4 v[44:47], v0, s[12:15], s56 offen offset:3072 sc1
    s_add_u32 s56, s51, 4096
    buffer_load_dwordx4 v[48:51], v0, s[12:15], s56 offen offset:0 sc1
    buffer_load_dwordx4 v[52:55], v0, s[12:15], s56 offen offset:1024 sc1
    buffer_load_dwordx4 v[56:59], v0, s[12:15], s56 offen offset:2048 sc1
    buffer_load_dwordx4 v[60:63], v0, s[12:15], s56 offen offset:3072 sc1
    s_add_u32 s56, s51, 8192
    buffer_load_dwordx4 v[64:67], v0, s[12:15], s56 offen offset:0 sc1
    buffer_load_dwordx4 v[68:71], v0, s[12:15], s56 offen offset:1024 sc1
    buffer_load_dwordx4 v[72:75], v0, s[12:15], s56 offen offset:2048 sc1
    buffer_load_dwordx4 v[76:79], v0, s[12:15], s56 offen offset:3072 sc1
    s_add_u32 s56, s51, 12288
    buffer_load_dwordx4 v[80:83], v0, s[12:15], s56 offen offset:0 sc1
    buffer_load_dwordx4 v[84:87], v0, s[12:15], s56 offen offset:1024 sc1
    s_waitcnt vmcnt(13)
    v_mfma_f32_16x16x32_bf16 v[24:27], v[144:147], v[32:35], 0
    v_mfma_f32_16x16x32_bf16 v[28:31], v[152:155], v[32:35], 0
    s_waitcnt vmcnt(12)
    v_mfma_f32_16x16x32_bf16 v[24:27], v[148:151], v[36:39], v[24:27]
    v_mfma_f32_16x16x32_bf16 v[28:31], v[156:159], v[36:39], v[28:31]
    s_waitcnt vmcnt(11)
    v_mfma_f32_16x16x32_bf16 v[24:27], v[160:163], v[40:43], v[24:27]
    v_mfma_f32_16x16x32_bf16 v[28:31], v[168:171], v[40:43], v[28:31]
    s_waitcnt vmcnt(10)
    v_mfma_f32_16x16x32_bf16 v[24:27], v[164:167], v[44:47], v[24:27]
    v_mfma_f32_16x16x32_bf16 v[28:31], v[172:175], v[44:47], v[28:31]
    s_waitcnt vmcnt(9)
    v_mfma_f32_16x16x32_bf16 v[24:27], v[176:179], v[48:51], v[24:27]
    v_mfma_f32_16x16x32_bf16 v[28:31], v[184:187], v[48:51], v[28:31]
    s_waitcnt vmcnt(8)
    v_mfma_f32_16x16x32_bf16 v[24:27], v[180:183], v[52:55], v[24:27]
    v_mfma_f32_16x16x32_bf16 v[28:31], v[188:191], v[52:55], v[28:31]
    s_waitcnt vmcnt(7)
    v_mfma_f32_16x16x32_bf16 v[24:27], v[192:195], v[56:59], v[24:27]
    v_mfma_f32_16x16x32_bf16 v[28:31], v[200:203], v[56:59], v[28:31]
    s_waitcnt vmcnt(6)
    v_mfma_f32_16x16x32_bf16 v[24:27], v[196:199], v[60:63], v[24:27]
    v_mfma_f32_16x16x32_bf16 v[28:31], v[204:207], v[60:63], v[28:31]
    s_waitcnt vmcnt(5)
    v_mfma_f32_16x16x32_bf16 v[24:27], v[208:211], v[64:67], v[24:27]
    v_mfma_f32_16x16x32_bf16 v[28:31], v[216:219], v[64:67], v[28:31]
    s_waitcnt vmcnt(4)
    v_mfma_f32_16x16x32_bf16 v[24:27], v[212:215], v[68:71], v[24:27]
    v_mfma_f32_16x16x32_bf16 v[28:31], v[220:223], v[68:71], v[28:31]
    s_waitcnt vmcnt(3)
    v_mfma_f32_16x16x32_bf16 v[24:27], v[224:227], v[72:75], v[24:27]
    v_mfma_f32_16x16x32_bf16 v[28:31], v[232:235], v[72:75], v[28:31]
    s_waitcnt vmcnt(2)
    v_mfma_f32_16x16x32_bf16 v[24:27], v[228:231], v[76:79], v[24:27]
    v_mfma_f32_16x16x32_bf16 v[28:31], v[236:239], v[76:79], v[28:31]
    s_waitcnt vmcnt(1)
    v_mfma_f32_16x16x32_bf16 v[24:27], v[240:243], v[80:83], v[24:27]
    v_mfma_f32_16x16x32_bf16 v[28:31], v[248:251], v[80:83], v[28:31]
    s_waitcnt vmcnt(0)
    v_mfma_f32_16x16x32_bf16 v[24:27], v[244:247], v[84:87], v[24:27]
    v_mfma_f32_16x16x32_bf16 v[28:31], v[252:255], v[84:87], v[28:31]
    v_sub_f32 v10, 1.0, v12
    s_nop 2
    v_mul_f32 v24, v24, v10
    v_mul_f32 v25, v25, v10
    v_mul_f32 v26, v26, v10
    v_mul_f32 v27, v27, v10
    v_mul_f32 v28, v28, v10
    v_mul_f32 v29, v29, v10
    v_mul_f32 v30, v30, v10
    v_mul_f32 v31, v31, v10
    s_cmp_lg_u32 s31, 0
    s_cbranch_scc1 LP_p_ok
    v_and_b32 v4, 0, v0
    s_mov_b32 s34, 0
LP_p:
    buffer_load_dword v6, v4, s[12:15], s53 offen sc1
    s_add_u32 s34, s34, 1
    s_cmp_gt_u32 s34, 4000000
    s_cbranch_scc1 L_wend
    s_waitcnt vmcnt(0)
    v_readfirstlane_b32 s35, v6
    s_nop 0
    s_cmp_ge_u32 s35, 8
    s_cbranch_scc1 LP_p_ok
    s_sleep 2
    s_cmp_ge_u32 s46, 61
    s_cbranch_scc1 LP_p
    s_sleep 24
    s_branch LP_p
LP_p_ok:
    s_barrier
    s_add_u32 s56, s52, 0
    buffer_load_dwordx4 v[32:35], v0, s[12:15], s56 offen offset:0 sc1
    buffer_load_dwordx4 v[36:39], v0, s[12:15], s56 offen offset:1024 sc1
    buffer_load_dwordx4 v[40:43], v0, s[12:15], s56 offen offset:2048 sc1
    buffer_load_dwordx4 v[44:47], v0, s[12:15], s56 offen offset:3072 sc1
    s_add_u32 s56, s52, 4096
    buffer_load_dwordx4 v[48:51], v0, s[12:15], s56 offen offset:0 sc1
    buffer_load_dwordx4 v[52:55], v0, s[12:15], s56 offen offset:1024 sc1
    buffer_load_dwordx4 v[56:59], v0, s[12:15], s56 offen offset:2048 sc1
    buffer_load_dwordx4 v[60:63], v0, s[12:15], s56 offen offset:3072 sc1
    s_add_u32 s56, s52, 8192
    buffer_load_dwordx4 v[64:67], v0, s[12:15], s56 offen offset:0 sc1
    buffer_load_dwordx4 v[68:71], v0, s[12:15], s56 offen offset:1024 sc1
    buffer_load_dwordx4 v[72:75], v0, s[12:15], s56 offen offset:2048 sc1
    buffer_load_dwordx4 v[76:79], v0, s[12:15], s56 offen offset:3072 sc1
    s_add_u32 s56, s52, 12288
    buffer_load_dwordx4 v[80:83], v0, s[12:15], s56 offen offset:0 sc1
    buffer_load_dwordx4 v[84:87], v0, s[12:15], s56 offen offset:1024 sc1
    buffer_load_dwordx4 v[88:91], v0, s[12:15], s56 offen offset:2048 sc1
    buffer_load_dwordx4 v[92:95], v0, s[12:15], s56 offen offset:3072 sc1
    s_add_u32 s56, s52, 16384
    buffer_load_dwordx4 v[96:99], v0, s[12:15], s56 offen offset:0 sc1
    buffer_load_dwordx4 v[100:103], v0, s[12:15], s56 offen offset:1024 sc1
    buffer_load_dwordx4 v[104:107], v0, s[12:15], s56 offen offset:2048 sc1
    buffer_load_dwordx4 v[108:111], v0, s[12:15], s56 offen offset:3072 sc1
    s_add_u32 s56, s52, 20480
    buffer_load_dwordx4 v[112:115], v0, s[12:15], s56 offen offset:0 sc1
    buffer_load_dwordx4 v[116:119], v0, s[12:15], s56 offen offset:1024 sc1
    buffer_load_dwordx4 v[120:123], v0, s[12:15], s56 offen offset:2048 sc1
    buffer_load_dwordx4 v[124:127], v0, s[12:15], s56 offen offset:3072 sc1
    s_add_u32 s56, s52, 24576
    buffer_load_dwordx4 v[128:131], v0, s[12:15], s56 offen offset:0 sc1
    buffer_load_dwordx4 v[132:135], v0, s[12:15], s56 offen offset:1024 sc1
    buffer_load_dwordx4 v[136:139], v0, s[12:15], s56 offen offset:2048 sc1
    buffer_load_dwordx4 v[140:143], v0, s[12:15], s56 offen offset:3072 sc1
    s_waitcnt vmcnt(27)
    v_mfma_f32_16x16x32_bf16 v[16:19], a[0:3], v[32:35], 0
    v_mfma_f32_16x16x32_bf16 v[20:23], a[8:11], v[32:35], 0
    s_add_u32 s56, s52, 28672
    buffer_load_dwordx4 v[32:35], v0, s[12:15], s56 offen offset:0 sc1
    s_waitcnt vmcnt(27)
    v_mfma_f32_16x16x32_bf16 v[16:19], a[4:7], v[36:39], v[16:19]
    v_mfma_f32_16x16x32_bf16 v[20:23], a[12:15], v[36:39], v[20:23]
    buffer_load_dwordx4 v[36:39], v0, s[12:15], s56 offen offset:1024 sc1
    s_waitcnt vmcnt(27)
    v_mfma_f32_16x16x32_bf16 v[16:19], a[16:19], v[40:43], v[16:19]
    v_mfma_f32_16x16x32_bf16 v[20:23], a[24:27], v[40:43], v[20:23]
    buffer_load_dwordx4 v[40:43], v0, s[12:15], s56 offen offset:2048 sc1
    s_waitcnt vmcnt(27)
    v_mfma_f32_16x16x32_bf16 v[16:19], a[20:23], v[44:47], v[16:19]
    v_mfma_f32_16x16x32_bf16 v[20:23], a[28:31], v[44:47], v[20:23]
    buffer_load_dwordx4 v[44:47], v0, s[12:15], s56 offen offset:3072 sc1
    s_waitcnt vmcnt(27)
    v_mfma_f32_16x16x32_bf16 v[16:19], a[32:35], v[48:51], v[16:19]
    v_mfma_f32_16x16x32_bf16 v[20:23], a[40:43], v[48:51], v[20:23]
    s_waitcnt vmcnt(26)
    v_mfma_f32_16x16x32_bf16 v[16:19], a[36:39], v[52:55], v[16:19]
    v_mfma_f32_16x16x32_bf16 v[20:23], a[44:47], v[52:55], v[20:23]
    s_waitcnt vmcnt(25)
    v_mfma_f32_16x16x32_bf16 v[16:19], a[48:51], v[56:59], v[16:19]
    v_mfma_f32_16x16x32_bf16 v[20:23], a[56:59], v[56:59], v[20:23]
    s_waitcnt vmcnt(24)
    v_mfma_f32_16x16x32_bf16 v[16:19], a[52:55], v[60:63], v[16:19]
    v_mfma_f32_16x16x32_bf16 v[20:23], a[60:63], v[60:63], v[20:23]
    s_waitcnt vmcnt(23)
    v_mfma_f32_16x16x32_bf16 v[16:19], a[64:67], v[64:67], v[16:19]
    v_mfma_f32_16x16x32_bf16 v[20:23], a[72:75], v[64:67], v[20:23]
    s_waitcnt vmcnt(22)
    v_mfma_f32_16x16x32_bf16 v[16:19], a[68:71], v[68:71], v[16:19]
    v_mfma_f32_16x16x32_bf16 v[20:23], a[76:79], v[68:71], v[20:23]
    s_waitcnt vmcnt(21)
    v_mfma_f32_16x16x32_bf16 v[16:19], a[80:83], v[72:75], v[16:19]
    v_mfma_f32_16x16x32_bf16 v[20:23], a[88:91], v[72:75], v[20:23]
    s_waitcnt vmcnt(20)
    v_mfma_f32_16x16x32_bf16 v[16:19], a[84:87], v[76:79], v[16:19]
    v_mfma_f32_16x16x32_bf16 v[20:23], a[92:95], v[76:79], v[20:23]
    s_waitcnt vmcnt(19)
    v_mfma_f32_16x16x32_bf16 v[16:19], a[96:99], v[80:83], v[16:19]
    v_mfma_f32_16x16x32_bf16 v[20:23], a[104:107], v[80:83], v[20:23]
    s_waitcnt vmcnt(18)
    v_mfma_f32_16x16x32_bf16 v[16:19], a[100:103], v[84:87], v[16:19]
    v_mfma_f32_16x16x32_bf16 v[20:23], a[108:111], v[84:87], v[20:23]
    s_waitcnt vmcnt(17)
    v_mfma_f32_16x16x32_bf16 v[16:19], a[112:115], v[88:91], v[16:19]
    v_mfma_f32_16x16x32_bf16 v[20:23], a[120:123], v[88:91], v[20:23]
    s_waitcnt vmcnt(16)
    v_mfma_f32_16x16x32_bf16 v[16:19], a[116:119], v[92:95], v[16:19]
    v_mfma_f32_16x16x32_bf16 v[20:23], a[124:127], v[92:95], v[20:23]
    s_waitcnt vmcnt(15)
    v_mfma_f32_16x16x32_bf16 v[16:19], a[128:131], v[96:99], v[16:19]
    v_mfma_f32_16x16x32_bf16 v[20:23], a[136:139], v[96:99], v[20:23]
    s_waitcnt vmcnt(14)
    v_mfma_f32_16x16x32_bf16 v[16:19], a[132:135], v[100:103], v[16:19]
    v_mfma_f32_16x16x32_bf16 v[20:23], a[140:143], v[100:103], v[20:23]
    s_waitcnt vmcnt(13)
    v_mfma_f32_16x16x32_bf16 v[16:19], a[144:147], v[104:107], v[16:19]
    v_mfma_f32_16x16x32_bf16 v[20:23], a[152:155], v[104:107], v[20:23]
    s_waitcnt vmcnt(12)
    v_mfma_f32_16x16x32_bf16 v[16:19], a[148:151], v[108:111], v[16:19]
    v_mfma_f32_16x16x32_bf16 v[20:23], a[156:159], v[108:111], v[20:23]
    s_waitcnt vmcnt(11)
    v_mfma_f32_16x16x32_bf16 v[16:19], a[160:163], v[112:115], v[16:19]
    v_mfma_f32_16x16x32_bf16 v[20:23], a[168:171], v[112:115], v[20:23]
    s_waitcnt vmcnt(10)
    v_mfma_f32_16x16x32_bf16 v[16:19], a[164:167], v[116:119], v[16:19]
    v_mfma_f32_16x16x32_bf16 v[20:23], a[172:175], v[116:119], v[20:23]
    s_waitcnt vmcnt(9)
    v_mfma_f32_16x16x32_bf16 v[16:19], a[176:179], v[120:123], v[16:19]
    v_mfma_f32_16x16x32_bf16 v[20:23], a[184:187], v[120:123], v[20:23]
    s_waitcnt vmcnt(8)
    v_mfma_f32_16x16x32_bf16 v[16:19], a[180:183], v[124:127], v[16:19]
    v_mfma_f32_16x16x32_bf16 v[20:23], a[188:191], v[124:127], v[20:23]
    s_waitcnt vmcnt(7)
    v_mfma_f32_16x16x32_bf16 v[16:19], a[192:195], v[128:131], v[16:19]
    v_mfma_f32_16x16x32_bf16 v[20:23], a[200:203], v[128:131], v[20:23]
    s_waitcnt vmcnt(6)
    v_mfma_f32_16x16x32_bf16 v[16:19], a[196:199], v[132:135], v[16:19]
    v_mfma_f32_16x16x32_bf16 v[20:23], a[204:207], v[132:135], v[20:23]
    s_waitcnt vmcnt(5)
    v_mfma_f32_16x16x32_bf16 v[16:19], a[208:211], v[136:139], v[16:19]
    v_mfma_f32_16x16x32_bf16 v[20:23], a[216:219], v[136:139], v[20:23]
    s_waitcnt vmcnt(4)
    v_mfma_f32_16x16x32_bf16 v[16:19], a[212:215], v[140:143], v[16:19]
    v_mfma_f32_16x16x32_bf16 v[20:23], a[220:223], v[140:143], v[20:23]
    s_waitcnt vmcnt(3)
    v_mfma_f32_16x16x32_bf16 v[16:19], a[224:227], v[32:35], v[16:19]
    v_mfma_f32_16x16x32_bf16 v[20:23], a[232:235], v[32:35], v[20:23]
    s_waitcnt vmcnt(2)
    v_mfma_f32_16x16x32_bf16 v[16:19], a[228:231], v[36:39], v[16:19]
    v_mfma_f32_16x16x32_bf16 v[20:23], a[236:239], v[36:39], v[20:23]
    s_waitcnt vmcnt(1)
    v_mfma_f32_16x16x32_bf16 v[16:19], a[240:243], v[40:43], v[16:19]
    v_mfma_f32_16x16x32_bf16 v[20:23], a[248:251], v[40:43], v[20:23]
    s_waitcnt vmcnt(0)
    v_mfma_f32_16x16x32_bf16 v[16:19], a[244:247], v[44:47], v[16:19]
    v_mfma_f32_16x16x32_bf16 v[20:23], a[252:255], v[44:47], v[20:23]
    s_nop 3
    v_fma_f32 v24, v16, v12, v24
    v_fma_f32 v25, v17, v12, v25
    v_fma_f32 v26, v18, v12, v26
    v_fma_f32 v27, v19, v12, v27
    v_fma_f32 v28, v20, v12, v28
    v_fma_f32 v29, v21, v12, v29
    v_fma_f32 v30, v22, v12, v30
    v_fma_f32 v31, v23, v12, v31
    ds_write_b128 v15, v[24:27] offset:0
    ds_write_b128 v15, v[28:31] offset:1024
    s_waitcnt lgkmcnt(0)
    s_barrier
    s_cmp_ge_u32 s31, 1
    s_cbranch_scc1 LP_skip
    ds_read_b128 v[32:35], v0 offset:0
    ds_read_b128 v[36:39], v0 offset:1024
    ds_read_b128 v[40:43], v0 offset:2048
    ds_read_b128 v[44:47], v0 offset:3072
    ds_read_b128 v[48:51], v0 offset:4096
    ds_read_b128 v[52:55], v0 offset:5120
    ds_read_b128 v[56:59], v0 offset:6144
    ds_read_b128 v[60:63], v0 offset:7168
    s_waitcnt lgkmcnt(5)
    v_add_f32 v32, v32, v40
    s_waitcnt lgkmcnt(1)
    v_add_f32 v48, v48, v56
    v_add_f32 v33, v33, v41
    v_add_f32 v49, v49, v57
    v_add_f32 v34, v34, v42
    v_add_f32 v50, v50, v58
    v_add_f32 v35, v35, v43
    v_add_f32 v51, v51, v59
    v_add_f32 v36, v36, v44
    s_waitcnt lgkmcnt(0)
    v_add_f32 v52, v52, v60
    v_add_f32 v37, v37, v45
    v_add_f32 v53, v53, v61
    v_add_f32 v38, v38, v46
    v_add_f32 v54, v54, v62
    v_add_f32 v39, v39, v47
    v_add_f32 v55, v55, v63
    v_add_f32 v32, v32, v48
    v_add_f32 v33, v33, v49
    v_add_f32 v34, v34, v50
    v_add_f32 v35, v35, v51
    v_add_f32 v36, v36, v52
    v_add_f32 v37, v37, v53
    v_add_f32 v38, v38, v54
    v_add_f32 v39, v39, v55
    v_cvt_pk_bf16_f32 v64, v32, v33
    v_cvt_pk_bf16_f32 v65, v34, v35
    v_cvt_pk_bf16_f32 v66, v36, v37
    v_cvt_pk_bf16_f32 v67, v38, v39
    s_mul_i32 s34, s46, 40960
    s_add_u32 s34, s34, s50
    buffer_store_dwordx4 v[64:67], v14, s[16:19], s34 offen sc1
LP_skip:
    s_barrier
    s_add_u32 s46, s46, 3
    s_cmp_lt_u32 s46, 64
    s_cbranch_scc1 LP_loop
    s_branch L_wend
LW_attn:
    s_sub_u32 s47, s47, 20
    s_lshl_b32 s47, s47, 2
    s_add_u32 s47, s47, s31
    s_cmp_lg_u32 s31, 0
    s_cbranch_scc1 LW_w2_ok
    v_mov_b32 v4, 192
    s_mov_b32 s34, 0
LW_w2:
    buffer_load_dword v5, v4, s[8:11], 0 offen sc1
    s_add_u32 s34, s34, 1
    s_cmp_gt_u32 s34, 2000000
    s_cbranch_scc1 L_wend
    s_waitcnt vmcnt(0)
    v_readfirstlane_b32 s35, v5
    s_nop 0
    s_cmp_ge_u32 s35, 192
    s_cbranch_scc1 LW_w2_ok
    s_sleep 16
    s_branch LW_w2
LW_w2_ok:
    s_barrier
    s_and_b32 s58, s46, 1
    s_lshr_b32 s46, s46, 1
    s_mov_b32 s54, 0x3e0293ee
    v_bfe_u32 v168, v0, 4, 4
    s_lshl_b32 s34, s58, 4
    v_add_u32 v168, s34, v168
    v_lshrrev_b32 v169, 8, v0
    v_lshlrev_b32 v169, 2, v169
    v_add_u32 v170, 0, v169
    v_cmp_le_u32 s[76:77], v170, v168
    v_add_u32 v170, 1, v169
    v_cmp_le_u32 s[78:79], v170, v168
    v_add_u32 v170, 2, v169
    v_cmp_le_u32 s[80:81], v170, v168
    v_add_u32 v170, 3, v169
    v_cmp_le_u32 s[82:83], v170, v168
    v_add_u32 v170, 16, v169
    v_cmp_le_u32 s[84:85], v170, v168
    v_add_u32 v170, 17, v169
    v_cmp_le_u32 s[86:87], v170, v168
    v_add_u32 v170, 18, v169
    v_cmp_le_u32 s[88:89], v170, v168
    v_add_u32 v170, 19, v169
    v_cmp_le_u32 s[90:91], v170, v168
    v_mov_b32 v12, 0xff800000
    v_lshrrev_b32 v13, 1, v0
    s_lshl_b32 s48, s47, 13
    s_lshl_b32 s49, s47, 8
    s_add_u32 s49, s49, 115359744
    s_lshl_b32 s50, s47, 12
    s_lshl_b32 s34, s58, 17
    s_add_u32 s50, s50, s34
    s_add_u32 s50, s50, 50331648
    s_lshl_b32 s57, s58, 12
    s_add_u32 s57, s57, 33554432
    s_lshl_b32 s60, s58, 6
    s_add_u32 s60, s60, 115347456
    s_cmp_eq_u32 s31, 0
    s_cselect_b32 s60, s60, 0x40000000
    v_mov_b32 v181, 0
    v_mov_b32 v182, 0
LA_loop:
    s_lshl_b32 s51, s46, 18
    s_add_u32 s52, s51, s48
    s_add_u32 s53, s52, s57
    buffer_load_dwordx4 v[16:19], v0, s[12:15], s53 offen offset:0 sc1
    buffer_load_dwordx4 v[20:23], v0, s[12:15], s53 offen offset:1024 sc1
    buffer_load_dwordx4 v[24:27], v0, s[12:15], s53 offen offset:2048 sc1
    buffer_load_dwordx4 v[28:31], v0, s[12:15], s53 offen offset:3072 sc1
    s_add_u32 s53, s52, 0
    s_add_u32 s55, s53, 4096
    buffer_load_dwordx4 v[32:35], v0, s[12:15], s53 offen offset:0 sc1
    buffer_load_dwordx4 v[36:39], v0, s[12:15], s53 offen offset:1024 sc1
    buffer_load_dwordx4 v[40:43], v0, s[12:15], s53 offen offset:2048 sc1
    buffer_load_dwordx4 v[44:47], v0, s[12:15], s53 offen offset:3072 sc1
    buffer_load_dwordx4 v[48:51], v0, s[12:15], s55 offen offset:0 sc1
    buffer_load_dwordx4 v[52:55], v0, s[12:15], s55 offen offset:1024 sc1
    buffer_load_dwordx4 v[56:59], v0, s[12:15], s55 offen offset:2048 sc1
    buffer_load_dwordx4 v[60:63], v0, s[12:15], s55 offen offset:3072 sc1
    s_add_u32 s53, s52, 16777216
    s_add_u32 s55, s53, 4096
    buffer_load_dwordx4 v[64:67], v0, s[12:15], s53 offen offset:0 sc1
    buffer_load_dwordx4 v[68:71], v0, s[12:15], s53 offen offset:1024 sc1
    buffer_load_dwordx4 v[72:75], v0, s[12:15], s53 offen offset:2048 sc1
    buffer_load_dwordx4 v[76:79], v0, s[12:15], s53 offen offset:3072 sc1
    buffer_load_dwordx4 v[80:83], v0, s[12:15], s55 offen offset:0 sc1
    buffer_load_dwordx4 v[84:87], v0, s[12:15], s55 offen offset:1024 sc1
    buffer_load_dwordx4 v[88:91], v0, s[12:15], s55 offen offset:2048 sc1
    buffer_load_dwordx4 v[92:95], v0, s[12:15], s55 offen offset:3072 sc1
    s_waitcnt vmcnt(15)
    v_mfma_f32_16x16x32_bf16 v[120:123], v[32:35], v[16:19], 0
    s_waitcnt vmcnt(14)
    v_mfma_f32_16x16x32_bf16 v[120:123], v[36:39], v[20:23], v[120:123]
    s_waitcnt vmcnt(13)
    v_mfma_f32_16x16x32_bf16 v[120:123], v[40:43], v[24:27], v[120:123]
    s_waitcnt vmcnt(12)
    v_mfma_f32_16x16x32_bf16 v[120:123], v[44:47], v[28:31], v[120:123]
    s_waitcnt vmcnt(11)
    v_mfma_f32_16x16x32_bf16 v[124:127], v[48:51], v[16:19], 0
    s_waitcnt vmcnt(10)
    v_mfma_f32_16x16x32_bf16 v[124:127], v[52:55], v[20:23], v[124:127]
    s_waitcnt vmcnt(9)
    v_mfma_f32_16x16x32_bf16 v[124:127], v[56:59], v[24:27], v[124:127]
    s_waitcnt vmcnt(8)
    v_mfma_f32_16x16x32_bf16 v[124:127], v[60:63], v[28:31], v[124:127]
    v_cndmask_b32 v120, v12, v120, s[76:77]
    v_cndmask_b32 v121, v12, v121, s[78:79]
    v_cndmask_b32 v122, v12, v122, s[80:81]
    v_cndmask_b32 v123, v12, v123, s[82:83]
    s_nop 3
    v_cndmask_b32 v124, v12, v124, s[84:85]
    v_cndmask_b32 v125, v12, v125, s[86:87]
    v_cndmask_b32 v126, v12, v126, s[88:89]
    v_cndmask_b32 v127, v12, v127, s[90:91]
    v_max3_f32 v168, v120, v121, v122
    v_max3_f32 v168, v168, v123, v124
    v_max3_f32 v168, v168, v125, v126
    v_max_f32 v168, v168, v127
    v_mov_b32 v170, v168
    s_nop 1
    v_permlane16_swap_b32 v168, v170
    v_max_f32 v168, v168, v170
    v_mov_b32 v170, v168
    s_nop 1
    v_permlane32_swap_b32 v168, v170
    v_max_f32 v168, v168, v170
    v_mul_f32 v168, s54, v168
    v_fma_f32 v120, v120, s54, -v168
    v_fma_f32 v121, v121, s54, -v168
    v_fma_f32 v122, v122, s54, -v168
    v_fma_f32 v123, v123, s54, -v168
    v_fma_f32 v124, v124, s54, -v168
    v_fma_f32 v125, v125, s54, -v168
    v_fma_f32 v126, v126, s54, -v168
    v_fma_f32 v127, v127, s54, -v168
    v_exp_f32 v120, v120
    v_exp_f32 v121, v121
    v_exp_f32 v122, v122
    v_exp_f32 v123, v123
    v_exp_f32 v124, v124
    v_exp_f32 v125, v125
    v_exp_f32 v126, v126
    v_exp_f32 v127, v127
    v_cvt_pk_bf16_f32 v176, v120, v121
    v_cvt_pk_bf16_f32 v177, v122, v123
    v_cvt_pk_bf16_f32 v178, v124, v125
    v_cvt_pk_bf16_f32 v179, v126, v127
    s_waitcnt vmcnt(7)
    s_nop 0
    v_mfma_f32_16x16x32_bf16 v[136:139], v[64:67], v[176:179], 0
    s_waitcnt vmcnt(6)
    v_mfma_f32_16x16x32_bf16 v[140:143], v[68:71], v[176:179], 0
    s_waitcnt vmcnt(5)
    v_mfma_f32_16x16x32_bf16 v[144:147], v[72:75], v[176:179], 0
    s_waitcnt vmcnt(4)
    v_mfma_f32_16x16x32_bf16 v[148:151], v[76:79], v[176:179], 0
    s_waitcnt vmcnt(3)
    v_mfma_f32_16x16x32_bf16 v[152:155], v[80:83], v[176:179], 0
    s_waitcnt vmcnt(2)
    v_mfma_f32_16x16x32_bf16 v[156:159], v[84:87], v[176:179], 0
    s_waitcnt vmcnt(1)
    v_mfma_f32_16x16x32_bf16 v[160:163], v[88:91], v[176:179], 0
    s_waitcnt vmcnt(0)
    v_mfma_f32_16x16x32_bf16 v[164:167], v[92:95], v[176:179], 0
    v_add_f32 v171, v120, v121
    v_add_f32 v171, v171, v122
    v_add_f32 v171, v171, v123
    v_add_f32 v171, v171, v124
    v_add_f32 v171, v171, v125
    v_add_f32 v171, v171, v126
    v_add_f32 v171, v171, v127
    v_and_b32 v4, 128, v0
    s_mov_b32 s34, 0
LA_p:
    buffer_load_dword v6, v4, s[12:15], s49 offen sc1
    s_add_u32 s34, s34, 1
    s_cmp_gt_u32 s34, 4000000
    s_cbranch_scc1 L_wend
    s_waitcnt vmcnt(0)
    v_readlane_b32 s35, v6, 0
    v_readlane_b32 s56, v6, 8
    s_nop 0
    s_min_u32 s35, s35, s56
    s_cmp_gt_u32 s35, s46
    s_cbranch_scc1 LA_p_ok
    s_sleep 2
    s_cmp_ge_u32 s35, 62
    s_cbranch_scc1 LA_p
    s_sleep 40
    s_branch LA_p
LA_p_ok:
    s_add_u32 s53, s52, 83886080
    s_add_u32 s55, s53, 4096
    buffer_load_dwordx4 v[96:99], v0, s[12:15], s53 offen offset:0 sc1
    buffer_load_dwordx4 v[100:103], v0, s[12:15], s53 offen offset:1024 sc1
    buffer_load_dwordx4 v[104:107], v0, s[12:15], s53 offen offset:2048 sc1
    buffer_load_dwordx4 v[108:111], v0, s[12:15], s53 offen offset:3072 sc1
    buffer_load_dwordx2 v[112:113], v13, s[12:15], s55 offen offset:0 sc1
    buffer_load_dwordx2 v[114:115], v13, s[12:15], s55 offen offset:512 sc1
    buffer_load_dwordx2 v[116:117], v13, s[12:15], s55 offen offset:1024 sc1
    buffer_load_dwordx2 v[118:119], v13, s[12:15], s55 offen offset:1536 sc1
    s_add_u32 s53, s51, s50
    s_lshl_b32 s55, s46, 7
    s_add_u32 s55, s55, s60
    v_mov_b32 v4, 0
    v_mov_b32 v5, 1
    s_waitcnt vmcnt(7)
    v_mfma_f32_16x16x32_bf16 v[128:131], v[96:99], v[16:19], 0
    s_waitcnt vmcnt(6)
    v_mfma_f32_16x16x32_bf16 v[128:131], v[100:103], v[20:23], v[128:131]
    s_waitcnt vmcnt(5)
    v_mfma_f32_16x16x32_bf16 v[128:131], v[104:107], v[24:27], v[128:131]
    s_waitcnt vmcnt(4)
    v_mfma_f32_16x16x32_bf16 v[128:131], v[108:111], v[28:31], v[128:131]
    s_nop 7
    v_max_f32 v169, v128, v129
    v_mov_b32 v170, v169
    s_nop 1
    v_permlane16_swap_b32 v169, v170
    v_max_f32 v169, v169, v170
    v_mov_b32 v170, v169
    s_nop 1
    v_permlane32_swap_b32 v169, v170
    v_max_f32 v169, v169, v170
    v_mul_f32 v169, s54, v169
    v_max_f32 v169, v169, v168
    v_fma_f32 v128, v128, s54, -v169
    v_fma_f32 v129, v129, s54, -v169
    v_sub_f32 v172, v168, v169
    v_exp_f32 v128, v128
    v_exp_f32 v129, v129
    v_exp_f32 v172, v172
    v_add_f32 v169, v128, v129
    v_fma_f32 v169, v171, v172, v169
    v_mov_b32 v170, v169
    s_nop 1
    v_permlane16_swap_b32 v169, v170
    v_add_f32 v169, v169, v170
    v_mov_b32 v170, v169
    s_nop 1
    v_permlane32_swap_b32 v169, v170
    v_add_f32 v169, v169, v170
    v_rcp_f32 v169, v169
    s_nop 0
    v_mul_f32 v128, v128, v169
    v_mul_f32 v129, v129, v169
    v_mul_f32 v172, v172, v169
    v_cvt_pk_bf16_f32 v180, v128, v129
    v_cvt_pk_bf16_f32 v183, v128, v129
    v_pk_mul_f32 v[136:137], v[136:137], v[172:173] op_sel_hi:[1,0]
    v_pk_mul_f32 v[138:139], v[138:139], v[172:173] op_sel_hi:[1,0]
    v_pk_mul_f32 v[140:141], v[140:141], v[172:173] op_sel_hi:[1,0]
    v_pk_mul_f32 v[142:143], v[142:143], v[172:173] op_sel_hi:[1,0]
    v_pk_mul_f32 v[144:145], v[144:145], v[172:173] op_sel_hi:[1,0]
    v_pk_mul_f32 v[146:147], v[146:147], v[172:173] op_sel_hi:[1,0]
    v_pk_mul_f32 v[148:149], v[148:149], v[172:173] op_sel_hi:[1,0]
    v_pk_mul_f32 v[150:151], v[150:151], v[172:173] op_sel_hi:[1,0]
    v_pk_mul_f32 v[152:153], v[152:153], v[172:173] op_sel_hi:[1,0]
    v_pk_mul_f32 v[154:155], v[154:155], v[172:173] op_sel_hi:[1,0]
    v_pk_mul_f32 v[156:157], v[156:157], v[172:173] op_sel_hi:[1,0]
    v_pk_mul_f32 v[158:159], v[158:159], v[172:173] op_sel_hi:[1,0]
    v_pk_mul_f32 v[160:161], v[160:161], v[172:173] op_sel_hi:[1,0]
    v_pk_mul_f32 v[162:163], v[162:163], v[172:173] op_sel_hi:[1,0]
    v_pk_mul_f32 v[164:165], v[164:165], v[172:173] op_sel_hi:[1,0]
    v_pk_mul_f32 v[166:167], v[166:167], v[172:173] op_sel_hi:[1,0]
    s_waitcnt vmcnt(3)
    v_mfma_f32_16x16x16_bf16 v[136:139], v[112:113], v[180:181], v[136:139]
    v_mfma_f32_16x16x16_bf16 v[140:143], v[112:113], v[182:183], v[140:143]
    s_waitcnt vmcnt(2)
    v_mfma_f32_16x16x16_bf16 v[144:147], v[114:115], v[180:181], v[144:147]
    v_mfma_f32_16x16x16_bf16 v[148:151], v[114:115], v[182:183], v[148:151]
    s_waitcnt vmcnt(1)
    v_mfma_f32_16x16x16_bf16 v[152:155], v[116:117], v[180:181], v[152:155]
    v_mfma_f32_16x16x16_bf16 v[156:159], v[116:117], v[182:183], v[156:159]
    s_waitcnt vmcnt(0)
    v_mfma_f32_16x16x16_bf16 v[160:163], v[118:119], v[180:181], v[160:163]
    v_mfma_f32_16x16x16_bf16 v[164:167], v[118:119], v[182:183], v[164:167]
    v_cvt_pk_bf16_f32 v136, v136, v140
    v_cvt_pk_bf16_f32 v137, v137, v141
    v_cvt_pk_bf16_f32 v138, v138, v142
    v_cvt_pk_bf16_f32 v139, v139, v143
    buffer_store_dwordx4 v[136:139], v0, s[12:15], s53 offen offset:0 sc1
    v_cvt_pk_bf16_f32 v144, v144, v148
    v_cvt_pk_bf16_f32 v145, v145, v149
    v_cvt_pk_bf16_f32 v146, v146, v150
    v_cvt_pk_bf16_f32 v147, v147, v151
    buffer_store_dwordx4 v[144:147], v0, s[12:15], s53 offen offset:1024 sc1
    v_cvt_pk_bf16_f32 v152, v152, v156
    v_cvt_pk_bf16_f32 v153, v153, v157
    v_cvt_pk_bf16_f32 v154, v154, v158
    v_cvt_pk_bf16_f32 v155, v155, v159
    buffer_store_dwordx4 v[152:155], v0, s[12:15], s53 offen offset:2048 sc1
    v_cvt_pk_bf16_f32 v160, v160, v164
    v_cvt_pk_bf16_f32 v161, v161, v165
    v_cvt_pk_bf16_f32 v162, v162, v166
    v_cvt_pk_bf16_f32 v163, v163, v167
    buffer_store_dwordx4 v[160:163], v0, s[12:15], s53 offen offset:3072 sc1
    s_waitcnt vmcnt(0)
    s_barrier
    s_mov_b64 exec, 1
    buffer_atomic_add v5, v4, s[12:15], s55 offen
    s_mov_b64 exec, -1
    s_add_u32 s46, s46, 3
    s_cmp_lt_u32 s46, 64
    s_cbranch_scc1 LA_loop
L_wend:
    s_endpgm
L_chain:
    s_load_dwordx8 s[20:27], s[0:1], 8
    s_load_dwordx2 s[28:29], s[0:1], 40
    v_lshrrev_b32 v16, 6, v0
    s_nop 0
    v_readfirstlane_b32 s31, v16
    v_and_b32 v17, 63, v0
    s_mov_b32 s75, 0
    v_lshlrev_b32 v0, 4, v17
    v_lshrrev_b32 v18, 4, v17
    v_and_b32 v19, 15, v17
    v_bfe_u32 v20, v17, 1, 1
    s_mul_i32 s33, s31, 36864
    s_add_u32 s33, s33, 16384
    s_waitcnt lgkmcnt(0)
    s_mov_b32 s36, s22
    s_mov_b32 s37, s23
    s_mov_b32 s38, 0x500000
    s_mov_b32 s39, 0x00020000
    s_mov_b32 s40, s24
    s_mov_b32 s41, s25
    s_mov_b32 s42, 0x500000
    s_mov_b32 s43, 0x00020000
    s_mov_b32 s44, s26
    s_mov_b32 s45, s27
    s_mov_b32 s46, 0x500000
    s_mov_b32 s47, 0x00020000
    s_mov_b32 s68, s28
    s_mov_b32 s69, s29
    s_mov_b32 s70, 0x500000
    s_mov_b32 s71, 0x00020000
    s_mov_b32 s16, s20
    s_mov_b32 s17, s21
    s_mov_b32 s18, 0x2800
    s_mov_b32 s19, 0x00020000
    v_lshlrev_b32 v21, 1, v18
    v_xor_b32 v22, v21, v19
    v_xor_b32 v23, 8, v22
    v_and_b32 v28, 1, v18
    v_lshrrev_b32 v29, 1, v18
    v_lshl_add_u32 v26, v29, 3, v28
    v_lshlrev_b32 v26, 13, v26
    v_lshl_add_u32 v24, v23, 4, v26
    v_lshl_add_u32 v26, v22, 4, v26
    v_lshl_add_u32 v30, v29, 4, v28
    v_lshrrev_b32 v31, 3, v22
    v_lshl_add_u32 v31, v31, 6, v30
    v_mul_u32_u24 v31, 1280, v31
    v_and_b32 v32, 7, v22
    v_lshl_add_u32 v27, v32, 4, v31
    v_lshrrev_b32 v31, 3, v23
    v_lshl_add_u32 v31, v31, 6, v30
    v_mul_u32_u24 v31, 1280, v31
    v_and_b32 v32, 7, v23
    v_lshl_add_u32 v25, v32, 4, v31
    s_and_b32 s34, s31, 1
    s_lshl_b32 s34, s34, 1
    s_lshr_b32 s35, s31, 1
    s_lshl_b32 s80, s35, 5
    s_add_u32 s80, s80, s34
    s_lshl_b32 s80, s80, 13
    s_lshl_b32 s82, s30, 8
    s_add_u32 s80, s80, s82
    s_mul_i32 s82, s3, 2621440
    s_sub_u32 s83, s80, s82
    s_add_u32 s80, s80, s82
    s_lshl_b32 s81, s35, 3
    s_add_u32 s81, s81, s34
    s_mul_i32 s81, s81, 1280
    s_mul_i32 s82, s30, 163840
    s_add_u32 s81, s81, s82
    s_mul_i32 s82, s3, 640
    s_add_u32 s81, s81, s82
    s_add_u32 s34, s30, s3
    s_cmp_lg_u32 s34, 0
    s_cbranch_scc1 LC_nocal
    s_cmp_lg_u32 s31, 0
    s_cbranch_scc1 LC_calw
    v_mov_b32 v33, 111156224
    v_mov_b32 v35, 111164416
    v_mov_b32 v34, 0
    s_mov_b64 exec, 1
    buffer_store_dword v34, v33, s[12:15], 0 offen sc1
    buffer_store_dword v34, v35, s[12:15], 0 offen sc1
    s_waitcnt vmcnt(0)
    s_mov_b32 s54, -1
    s_mov_b32 s55, -1
    s_memtime s[48:49]
    s_waitcnt lgkmcnt(0)
    buffer_store_dword v34, v33, s[12:15], 0 offen sc1
    s_waitcnt vmcnt(0)
    s_memtime s[50:51]
    s_waitcnt lgkmcnt(0)
    s_sub_u32 s50, s50, s48
    s_min_u32 s54, s54, s50
    s_memtime s[48:49]
    s_waitcnt lgkmcnt(0)
    buffer_store_dword v34, v35, s[12:15], 0 offen sc1
    s_waitcnt vmcnt(0)
    s_memtime s[50:51]
    s_waitcnt lgkmcnt(0)
    s_sub_u32 s50, s50, s48
    s_min_u32 s55, s55, s50
    s_memtime s[48:49]
    s_waitcnt lgkmcnt(0)
    buffer_store_dword v34, v33, s[12:15], 0 offen sc1
    s_waitcnt vmcnt(0)
    s_memtime s[50:51]
    s_waitcnt lgkmcnt(0)
    s_sub_u32 s50, s50, s48
    s_min_u32 s54, s54, s50
    s_memtime s[48:49]
    s_waitcnt lgkmcnt(0)
    buffer_store_dword v34, v35, s[12:15], 0 offen sc1
    s_waitcnt vmcnt(0)
    s_memtime s[50:51]
    s_waitcnt lgkmcnt(0)
    s_sub_u32 s50, s50, s48
    s_min_u32 s55, s55, s50
    s_memtime s[48:49]
    s_waitcnt lgkmcnt(0)
    buffer_store_dword v34, v33, s[12:15], 0 offen sc1
    s_waitcnt vmcnt(0)
    s_memtime s[50:51]
    s_waitcnt lgkmcnt(0)
    s_sub_u32 s50, s50, s48
    s_min_u32 s54, s54, s50
    s_memtime s[48:49]
    s_waitcnt lgkmcnt(0)
    buffer_store_dword v34, v35, s[12:15], 0 offen sc1
    s_waitcnt vmcnt(0)
    s_memtime s[50:51]
    s_waitcnt lgkmcnt(0)
    s_sub_u32 s50, s50, s48
    s_min_u32 s55, s55, s50
    s_cmp_lt_u32 s55, s54
    s_cselect_b32 s34, 8192, 0
    v_mov_b32 v33, 240
    v_mov_b32 v34, s34
    buffer_atomic_or v34, v33, s[8:11], 0 offen
    s_mov_b64 exec, -1
LC_calw:
    s_barrier
LC_nocal:
    s_add_u32 s34, s80, 524288
    s_add_u32 m0, s33, 0
    s_nop 0
    buffer_load_dwordx4 v26, s[36:39], s34 offen lds
    s_add_u32 s34, s80, 557056
    s_add_u32 m0, s33, 1024
    s_nop 0
    buffer_load_dwordx4 v24, s[36:39], s34 offen lds
    s_add_u32 s34, s80, 655360
    s_add_u32 m0, s33, 2048
    s_nop 0
    buffer_load_dwordx4 v26, s[36:39], s34 offen lds
    s_add_u32 s34, s80, 688128
    s_add_u32 m0, s33, 3072
    s_nop 0
    buffer_load_dwordx4 v24, s[36:39], s34 offen lds
    s_add_u32 s34, s80, 1048576
    s_add_u32 m0, s33, 4096
    s_nop 0
    buffer_load_dwordx4 v26, s[36:39], s34 offen lds
    s_add_u32 s34, s80, 1081344
    s_add_u32 m0, s33, 5120
    s_nop 0
    buffer_load_dwordx4 v24, s[36:39], s34 offen lds
    s_add_u32 s34, s80, 1179648
    s_add_u32 m0, s33, 6144
    s_nop 0
    buffer_load_dwordx4 v26, s[36:39], s34 offen lds
    s_add_u32 s34, s80, 1212416
    s_add_u32 m0, s33, 7168
    s_nop 0
    buffer_load_dwordx4 v24, s[36:39], s34 offen lds
    s_add_u32 s34, s80, 1572864
    s_add_u32 m0, s33, 8192
    s_nop 0
    buffer_load_dwordx4 v26, s[36:39], s34 offen lds
    s_add_u32 s34, s80, 1605632
    s_add_u32 m0, s33, 9216
    s_nop 0
    buffer_load_dwordx4 v24, s[36:39], s34 offen lds
    s_add_u32 s34, s80, 1703936
    s_add_u32 m0, s33, 10240
    s_nop 0
    buffer_load_dwordx4 v26, s[36:39], s34 offen lds
    s_add_u32 s34, s80, 1736704
    s_add_u32 m0, s33, 11264
    s_nop 0
    buffer_load_dwordx4 v24, s[36:39], s34 offen lds
    s_add_u32 s34, s83, 2621440
    s_add_u32 m0, s33, 12288
    s_nop 0
    buffer_load_dwordx4 v26, s[36:39], s34 offen lds
    s_add_u32 s34, s83, 2654208
    s_add_u32 m0, s33, 13312
    s_nop 0
    buffer_load_dwordx4 v24, s[36:39], s34 offen lds
    s_add_u32 s34, s83, 2752512
    s_add_u32 m0, s33, 14336
    s_nop 0
    buffer_load_dwordx4 v26, s[36:39], s34 offen lds
    s_add_u32 s34, s83, 2785280
    s_add_u32 m0, s33, 15360
    s_nop 0
    buffer_load_dwordx4 v24, s[36:39], s34 offen lds
    s_add_u32 s34, s83, 3145728
    s_add_u32 m0, s33, 16384
    s_nop 0
    buffer_load_dwordx4 v26, s[36:39], s34 offen lds
    s_add_u32 s34, s83, 3178496
    s_add_u32 m0, s33, 17408
    s_nop 0
    buffer_load_dwordx4 v24, s[36:39], s34 offen lds
    s_add_u32 s34, s83, 3276800
    s_add_u32 m0, s33, 18432
    s_nop 0
    buffer_load_dwordx4 v26, s[36:39], s34 offen lds
    s_add_u32 s34, s83, 3309568
    s_add_u32 m0, s33, 19456
    s_nop 0
    buffer_load_dwordx4 v24, s[36:39], s34 offen lds
    s_cmp_eq_u32 s101, 0
    s_cbranch_scc1 LC_own
    s_waitcnt vmcnt(20)
    v_readfirstlane_b32 s34, v14
    s_nop 1
    v_mov_b32 v14, s34
    v_mov_b32 v15, 15360
    v_cmp_gt_u32 vcc, 64, v94
    s_nop 0
    s_cbranch_vccz L_rs2
    ds_write_b32 v15, v14
L_rs2:
    s_waitcnt lgkmcnt(0)
    s_barrier
    ds_read_b32 v14, v15
    s_waitcnt lgkmcnt(0)
    v_readfirstlane_b32 s34, v14
    s_nop 0
    s_bitcmp1_b32 s34, s30
    s_cbranch_scc0 LC_own
    s_waitcnt vmcnt(0)
    s_barrier
    s_branch L_wlost
LC_own:
    v_lshrrev_b32 v28, 2, v17
    v_and_b32 v29, 7, v28
    v_lshlrev_b32 v29, 1, v29
    v_and_b32 v31, 1, v17
    v_lshlrev_b32 v31, 3, v31
    v_lshl_add_u32 v31, v28, 8, v31
    s_lshl_b32 s34, s31, 2
    v_add_u32 v30, s34, v20
    v_add_u32 v32, 0, v30
    v_xor_b32 v32, v32, v29
    v_lshl_add_u32 v32, v32, 4, v31
    v_add_u32 v88, 16384, v32
    v_add_u32 v89, 53248, v32
    v_add_u32 v90, 90112, v32
    v_add_u32 v91, 126976, v32
    v_add_u32 v32, 2, v30
    v_xor_b32 v32, v32, v29
    v_lshl_add_u32 v32, v32, 4, v31
    v_add_u32 v92, 16384, v32
    v_add_u32 v93, 53248, v32
    v_add_u32 v94, 90112, v32
    v_add_u32 v95, 126976, v32
    s_lshl_b32 s34, s31, 1
    v_add_u32 v30, s34, v20
    v_add_u32 v32, 0, v30
    v_xor_b32 v32, v32, v29
    v_lshl_add_u32 v32, v32, 4, v31
    v_add_u32 v80, 16384, v32
    v_add_u32 v81, 53248, v32
    v_add_u32 v82, 90112, v32
    v_add_u32 v83, 126976, v32
    v_add_u32 v32, 8, v30
    v_xor_b32 v32, v32, v29
    v_lshl_add_u32 v32, v32, 4, v31
    v_add_u32 v84, 16384, v32
    v_add_u32 v85, 53248, v32
    v_add_u32 v86, 90112, v32
    v_add_u32 v87, 126976, v32
    v_mov_b32 v1, 0x4444
    v_mul_u32_u24 v21, 0xaaaa, v20
    v_add_u32 v1, v1, v21
    v_lshrrev_b32 v21, 2, v19
    v_and_b32 v22, 1, v19
    v_lshl_add_u32 v23, v21, 1, v22
    v_add_u32 v2, s33, v0
    v_lshrrev_b32 v28, 1, v18
    v_lshlrev_b32 v8, 12, v28
    v_and_b32 v28, 31, v17
    v_lshl_add_u32 v8, v28, 2, v8
    s_lshl_b32 s34, s31, 10
    v_add_u32 v3, s34, v0
    s_lshr_b32 s34, s31, 1
    s_lshl_b32 s34, s34, 10
    s_and_b32 s35, s31, 1
    s_lshl_b32 s35, s35, 3
    s_add_u32 s34, s34, s35
    v_add_u32 v9, s34, v0
    s_lshl_b32 s34, s31, 2
    v_add_u32 v10, s34, v0
    v_bfe_u32 v11, v17, 1, 2
    v_lshlrev_b32 v11, 5, v11
    v_lshl_add_u32 v11, v18, 4, v11
    v_lshl_add_u32 v11, v22, 3, v11
    v_lshlrev_b32 v28, 4, v22
    v_mov_b32 v29, 0x3f80
    v_lshlrev_b32 v29, v28, v29
    v_cmp_eq_u32 vcc, v18, v21
    s_nop 1
    v_cndmask_b32 v4, 0, v29, vcc
    v_mov_b32 v5, 0
    v_mov_b32 v6, 0
    v_mov_b32 v7, v4
    s_mov_b32 s52, 0xcccccccc
    s_mov_b32 s53, 0xcccccccc
    s_mov_b32 s54, 0x3e0293ee
    s_lshl_b32 s55, s31, 5
    s_add_u32 s55, s55, s30
    s_cmp_lt_u32 s55, 40
    s_cselect_b32 s57, 1, 0
    s_mul_i32 s34, s3, 20480
    s_add_u32 s59, s34, 105906176
    s_xor_b32 s35, s3, 1
    s_lshl_b32 s35, s35, 14
    s_add_u32 s60, s35, 111149056
    s_lshl_b32 s74, s55, 7
    s_lshl_b32 s35, s3, 14
    s_add_u32 s74, s74, s35
    s_add_u32 s91, s74, 111149056
    s_lshl_b32 s56, s55, 7
    s_add_u32 s56, s56, s59
    s_mul_i32 s34, s3, 327680
    s_add_u32 s34, s34, 104857600
    s_lshl_b32 s55, s55, 12
    s_add_u32 s55, s55, s34
    s_cmp_eq_u32 s57, 1
    s_cselect_b32 s55, s55, 1073741824
    s_cselect_b32 s56, s56, 1073741824
    s_cselect_b32 s91, s91, 1073741824
    s_lshl_b32 s90, s30, 12
    s_add_u32 s90, s90, s34
    s_cmp_lt_u32 s30, 8
    s_mov_b32 s74, 1073741824
    s_cselect_b32 s74, 131072, s74
    s_mov_b32 s29, s74
    s_lshl_b32 s58, s31, 13
    s_add_u32 s58, s58, s34
    s_lshl_b32 s34, s30, 7
    s_add_u32 s58, s58, s34
    s_lshl_b32 s34, s30, 13
    s_lshl_b32 s61, s31, 10
    s_add_u32 s61, s61, s34
    s_lshl_b32 s62, s31, 11
    s_add_u32 s62, s62, s34
    s_add_u32 s62, s62, 16777216
    s_add_u32 s63, s61, 83886080
    s_add_u32 s64, s34, 83890176
    s_cmp_eq_u32 s3, 0
    s_cselect_b32 s63, s63, 1073741824
    s_cselect_b32 s64, 1073741824, s64
    s_add_u32 s61, s61, 0
    s_lshl_b32 s93, s30, 1
    s_add_u32 s93, s93, s3
    s_lshl_b32 s93, s93, 7
    s_add_u32 s93, s93, 115359744
    s_cmp_eq_u32 s31, 3
    s_cselect_b32 s93, s93, 1073741824
    v_mov_b32 v76, -1
    v_mov_b32 v77, -1
    v_mov_b32 v78, -1
    v_mov_b32 v79, -1
    s_add_u32 s34, s55, 163840
    buffer_store_dwordx4 v[76:79], v0, s[12:15], s55 offen offset:0 sc1
    buffer_store_dwordx4 v[76:79], v0, s[12:15], s34 offen offset:0 sc1
    buffer_store_dwordx4 v[76:79], v0, s[12:15], s55 offen offset:1024 sc1
    buffer_store_dwordx4 v[76:79], v0, s[12:15], s34 offen offset:1024 sc1
    buffer_store_dwordx4 v[76:79], v0, s[12:15], s55 offen offset:2048 sc1
    buffer_store_dwordx4 v[76:79], v0, s[12:15], s34 offen offset:2048 sc1
    buffer_store_dwordx4 v[76:79], v0, s[12:15], s55 offen offset:3072 sc1
    buffer_store_dwordx4 v[76:79], v0, s[12:15], s34 offen offset:3072 sc1
    s_mov_b64 exec, 0xff
    s_add_u32 s34, s56, 0
    buffer_store_dwordx4 v[76:79], v0, s[12:15], s34 offen sc1
    s_add_u32 s34, s56, 5120
    buffer_store_dwordx4 v[76:79], v0, s[12:15], s34 offen sc1
    s_add_u32 s34, s56, 10240
    buffer_store_dwordx4 v[76:79], v0, s[12:15], s34 offen sc1
    s_add_u32 s34, s56, 15360
    buffer_store_dwordx4 v[76:79], v0, s[12:15], s34 offen sc1
    s_mov_b64 exec, -1
    s_lshl_b32 s34, s30, 1
    s_add_u32 s34, s34, s3
    s_lshl_b32 s34, s34, 2
    s_add_u32 s34, s34, s31
    s_lshl_b32 s34, s34, 13
    s_add_u32 s34, s34, 111149056
    s_add_u32 s35, s34, 4096
    buffer_store_dwordx4 v[76:79], v0, s[12:15], s34 offen offset:0 sc1
    buffer_store_dwordx4 v[76:79], v0, s[12:15], s34 offen offset:1024 sc1
    buffer_store_dwordx4 v[76:79], v0, s[12:15], s34 offen offset:2048 sc1
    buffer_store_dwordx4 v[76:79], v0, s[12:15], s34 offen offset:3072 sc1
    buffer_store_dwordx4 v[76:79], v0, s[12:15], s35 offen offset:0 sc1
    v_mul_u32_u24 v29, 1280, v23
    v_lshl_add_u32 v29, v20, 4, v29
    v_lshl_add_u32 v29, v18, 5, v29
    s_mul_i32 s34, s3, 640
    s_sub_u32 s35, 640, s34
    buffer_load_dwordx4 v[32:35], v29, s[16:19], s34 offen offset:0
    buffer_load_dwordx4 v[36:39], v29, s[16:19], s34 offen offset:128
    buffer_load_dwordx4 v[40:43], v29, s[16:19], s34 offen offset:256
    buffer_load_dwordx4 v[44:47], v29, s[16:19], s34 offen offset:384
    buffer_load_dwordx4 v[48:51], v29, s[16:19], s34 offen offset:512
    buffer_load_dwordx4 v[52:55], v29, s[16:19], s35 offen offset:0
    buffer_load_dwordx4 v[56:59], v29, s[16:19], s35 offen offset:128
    buffer_load_dwordx4 v[60:63], v29, s[16:19], s35 offen offset:256
    buffer_load_dwordx4 v[64:67], v29, s[16:19], s35 offen offset:384
    buffer_load_dwordx4 v[68:71], v29, s[16:19], s35 offen offset:512
    s_waitcnt vmcnt(9)
    ds_write_b128 v0, v[32:35] offset:0
    s_waitcnt vmcnt(8)
    ds_write_b128 v0, v[36:39] offset:1024
    s_waitcnt vmcnt(7)
    ds_write_b128 v0, v[40:43] offset:2048
    s_waitcnt vmcnt(6)
    ds_write_b128 v0, v[44:47] offset:3072
    s_waitcnt vmcnt(5)
    ds_write_b128 v0, v[48:51] offset:4096
    s_lshl_b32 s48, s2, 13
    s_add_u32 s48, s48, 106954752
    s_add_u32 s99, s48, 4096
    s_waitcnt vmcnt(4)
    v_min_u32 v52, -2, v52
    v_min_u32 v53, -2, v53
    v_min_u32 v54, -2, v54
    v_min_u32 v55, -2, v55
    s_waitcnt vmcnt(3)
    v_min_u32 v56, -2, v56
    v_min_u32 v57, -2, v57
    v_min_u32 v58, -2, v58
    v_min_u32 v59, -2, v59
    s_waitcnt vmcnt(2)
    v_min_u32 v60, -2, v60
    v_min_u32 v61, -2, v61
    v_min_u32 v62, -2, v62
    v_min_u32 v63, -2, v63
    s_waitcnt vmcnt(1)
    v_min_u32 v64, -2, v64
    v_min_u32 v65, -2, v65
    v_min_u32 v66, -2, v66
    v_min_u32 v67, -2, v67
    s_waitcnt vmcnt(0)
    v_min_u32 v68, -2, v68
    v_min_u32 v69, -2, v69
    v_min_u32 v70, -2, v70
    v_min_u32 v71, -2, v71
    buffer_store_dwordx4 v[52:55], v0, s[12:15], s48 offen offset:0
    buffer_store_dwordx4 v[56:59], v0, s[12:15], s48 offen offset:1024
    buffer_store_dwordx4 v[60:63], v0, s[12:15], s48 offen offset:2048
    buffer_store_dwordx4 v[64:67], v0, s[12:15], s48 offen offset:3072
    buffer_store_dwordx4 v[68:71], v0, s[12:15], s99 offen offset:0
    s_getreg_b32 s34, hwreg(HW_REG_XCC_ID)
    s_and_b32 s34, s34, 15
    s_lshl_b32 s34, 1, s34
    s_lshl_b32 s35, s3, 2
    s_add_u32 s35, s35, 244
    v_mov_b32 v72, s35
    v_mov_b32 v73, 1
    v_mov_b32 v74, s34
    v_mov_b32 v75, 252
    s_cmp_eq_u32 s31, 0
    s_cselect_b32 s82, 0, 1073741824
    s_mov_b64 exec, 1
    buffer_atomic_or v74, v72, s[8:11], s82 offen
    s_mov_b64 exec, -1
    s_waitcnt lgkmcnt(0)
    s_barrier
    s_add_u32 s34, s83, 3670016
    s_add_u32 m0, s33, 20480
    s_nop 0
    buffer_load_dwordx4 v26, s[36:39], s34 offen lds
    s_add_u32 s34, s83, 3702784
    s_add_u32 m0, s33, 21504
    s_nop 0
    buffer_load_dwordx4 v24, s[36:39], s34 offen lds
    s_add_u32 s34, s83, 3801088
    s_add_u32 m0, s33, 22528
    s_nop 0
    buffer_load_dwordx4 v26, s[36:39], s34 offen lds
    s_add_u32 s34, s83, 3833856
    s_add_u32 m0, s33, 23552
    s_nop 0
    buffer_load_dwordx4 v24, s[36:39], s34 offen lds
    ds_read_b64_tr_b16 a[0:1], v88 offset:0
    ds_read_b64_tr_b16 a[2:3], v89 offset:0
    ds_read_b64_tr_b16 a[4:5], v90 offset:0
    ds_read_b64_tr_b16 a[6:7], v91 offset:0
    ds_read_b64_tr_b16 a[8:9], v92 offset:0
    ds_read_b64_tr_b16 a[10:11], v93 offset:0
    ds_read_b64_tr_b16 a[12:13], v94 offset:0
    ds_read_b64_tr_b16 a[14:15], v95 offset:0
    s_waitcnt lgkmcnt(0)
    s_barrier
    s_add_u32 s34, s83, 4718592
    s_add_u32 m0, s33, 24576
    s_nop 0
    buffer_load_dwordx4 v26, s[36:39], s34 offen lds
    s_add_u32 s34, s83, 4751360
    s_add_u32 m0, s33, 25600
    s_nop 0
    buffer_load_dwordx4 v24, s[36:39], s34 offen lds
    s_add_u32 s34, s83, 4849664
    s_add_u32 m0, s33, 26624
    s_nop 0
    buffer_load_dwordx4 v26, s[36:39], s34 offen lds
    s_add_u32 s34, s83, 4882432
    s_add_u32 m0, s33, 27648
    s_nop 0
    buffer_load_dwordx4 v24, s[36:39], s34 offen lds
    ds_read_b64_tr_b16 a[16:17], v88 offset:4096
    ds_read_b64_tr_b16 a[18:19], v89 offset:4096
    ds_read_b64_tr_b16 a[20:21], v90 offset:4096
    ds_read_b64_tr_b16 a[22:23], v91 offset:4096
    ds_read_b64_tr_b16 a[24:25], v92 offset:4096
    ds_read_b64_tr_b16 a[26:27], v93 offset:4096
    ds_read_b64_tr_b16 a[28:29], v94 offset:4096
    ds_read_b64_tr_b16 a[30:31], v95 offset:4096
    s_waitcnt lgkmcnt(0)
    s_barrier
    s_add_u32 s34, s80, 0
    s_add_u32 m0, s33, 28672
    s_nop 0
    buffer_load_dwordx4 v26, s[40:43], s34 offen lds
    s_add_u32 s34, s80, 32768
    s_add_u32 m0, s33, 29696
    s_nop 0
    buffer_load_dwordx4 v24, s[40:43], s34 offen lds
    s_add_u32 s34, s80, 131072
    s_add_u32 m0, s33, 30720
    s_nop 0
    buffer_load_dwordx4 v26, s[40:43], s34 offen lds
    s_add_u32 s34, s80, 163840
    s_add_u32 m0, s33, 31744
    s_nop 0
    buffer_load_dwordx4 v24, s[40:43], s34 offen lds
    ds_read_b64_tr_b16 a[32:33], v88 offset:8192
    ds_read_b64_tr_b16 a[34:35], v89 offset:8192
    ds_read_b64_tr_b16 a[36:37], v90 offset:8192
    ds_read_b64_tr_b16 a[38:39], v91 offset:8192
    ds_read_b64_tr_b16 a[40:41], v92 offset:8192
    ds_read_b64_tr_b16 a[42:43], v93 offset:8192
    ds_read_b64_tr_b16 a[44:45], v94 offset:8192
    ds_read_b64_tr_b16 a[46:47], v95 offset:8192
    s_waitcnt lgkmcnt(0)
    s_barrier
    s_add_u32 s34, s80, 1048576
    s_add_u32 m0, s33, 32768
    s_nop 0
    buffer_load_dwordx4 v26, s[40:43], s34 offen lds
    s_add_u32 s34, s80, 1081344
    s_add_u32 m0, s33, 33792
    s_nop 0
    buffer_load_dwordx4 v24, s[40:43], s34 offen lds
    s_add_u32 s34, s80, 1179648
    s_add_u32 m0, s33, 34816
    s_nop 0
    buffer_load_dwordx4 v26, s[40:43], s34 offen lds
    s_add_u32 s34, s80, 1212416
    s_add_u32 m0, s33, 35840
    s_nop 0
    buffer_load_dwordx4 v24, s[40:43], s34 offen lds
    ds_read_b64_tr_b16 a[48:49], v88 offset:12288
    ds_read_b64_tr_b16 a[50:51], v89 offset:12288
    ds_read_b64_tr_b16 a[52:53], v90 offset:12288
    ds_read_b64_tr_b16 a[54:55], v91 offset:12288
    ds_read_b64_tr_b16 a[56:57], v92 offset:12288
    ds_read_b64_tr_b16 a[58:59], v93 offset:12288
    ds_read_b64_tr_b16 a[60:61], v94 offset:12288
    ds_read_b64_tr_b16 a[62:63], v95 offset:12288
    s_waitcnt lgkmcnt(0)
    s_barrier
    s_add_u32 s34, s80, 1572864
    s_add_u32 m0, s33, 0
    s_nop 0
    buffer_load_dwordx4 v26, s[40:43], s34 offen lds
    s_add_u32 s34, s80, 1605632
    s_add_u32 m0, s33, 1024
    s_nop 0
    buffer_load_dwordx4 v24, s[40:43], s34 offen lds
    s_add_u32 s34, s80, 1703936
    s_add_u32 m0, s33, 2048
    s_nop 0
    buffer_load_dwordx4 v26, s[40:43], s34 offen lds
    s_add_u32 s34, s80, 1736704
    s_add_u32 m0, s33, 3072
    s_nop 0
    buffer_load_dwordx4 v24, s[40:43], s34 offen lds
    ds_read_b64_tr_b16 a[64:65], v88 offset:16384
    ds_read_b64_tr_b16 a[66:67], v89 offset:16384
    ds_read_b64_tr_b16 a[68:69], v90 offset:16384
    ds_read_b64_tr_b16 a[70:71], v91 offset:16384
    ds_read_b64_tr_b16 a[72:73], v92 offset:16384
    ds_read_b64_tr_b16 a[74:75], v93 offset:16384
    ds_read_b64_tr_b16 a[76:77], v94 offset:16384
    ds_read_b64_tr_b16 a[78:79], v95 offset:16384
    s_waitcnt vmcnt(16)
    s_waitcnt lgkmcnt(0)
    s_barrier
    s_add_u32 s34, s80, 2097152
    s_add_u32 m0, s33, 4096
    s_nop 0
    buffer_load_dwordx4 v26, s[40:43], s34 offen lds
    s_add_u32 s34, s80, 2129920
    s_add_u32 m0, s33, 5120
    s_nop 0
    buffer_load_dwordx4 v24, s[40:43], s34 offen lds
    s_add_u32 s34, s80, 2228224
    s_add_u32 m0, s33, 6144
    s_nop 0
    buffer_load_dwordx4 v26, s[40:43], s34 offen lds
    s_add_u32 s34, s80, 2260992
    s_add_u32 m0, s33, 7168
    s_nop 0
    buffer_load_dwordx4 v24, s[40:43], s34 offen lds
    ds_read_b64_tr_b16 a[80:81], v88 offset:20480
    ds_read_b64_tr_b16 a[82:83], v89 offset:20480
    ds_read_b64_tr_b16 a[84:85], v90 offset:20480
    ds_read_b64_tr_b16 a[86:87], v91 offset:20480
    ds_read_b64_tr_b16 a[88:89], v92 offset:20480
    ds_read_b64_tr_b16 a[90:91], v93 offset:20480
    ds_read_b64_tr_b16 a[92:93], v94 offset:20480
    ds_read_b64_tr_b16 a[94:95], v95 offset:20480
    s_waitcnt vmcnt(16)
    s_waitcnt lgkmcnt(0)
    s_barrier
    s_add_u32 s34, s83, 3145728
    s_add_u32 m0, s33, 8192
    s_nop 0
    buffer_load_dwordx4 v26, s[40:43], s34 offen lds
    s_add_u32 s34, s83, 3178496
    s_add_u32 m0, s33, 9216
    s_nop 0
    buffer_load_dwordx4 v24, s[40:43], s34 offen lds
    s_add_u32 s34, s83, 3276800
    s_add_u32 m0, s33, 10240
    s_nop 0
    buffer_load_dwordx4 v26, s[40:43], s34 offen lds
    s_add_u32 s34, s83, 3309568
    s_add_u32 m0, s33, 11264
    s_nop 0
    buffer_load_dwordx4 v24, s[40:43], s34 offen lds
    ds_read_b64_tr_b16 a[96:97], v88 offset:24576
    ds_read_b64_tr_b16 a[98:99], v89 offset:24576
    ds_read_b64_tr_b16 a[100:101], v90 offset:24576
    ds_read_b64_tr_b16 a[102:103], v91 offset:24576
    ds_read_b64_tr_b16 a[104:105], v92 offset:24576
    ds_read_b64_tr_b16 a[106:107], v93 offset:24576
    ds_read_b64_tr_b16 a[108:109], v94 offset:24576
    ds_read_b64_tr_b16 a[110:111], v95 offset:24576
    s_waitcnt vmcnt(16)
    s_waitcnt lgkmcnt(0)
    s_barrier
    s_add_u32 s34, s83, 3670016
    s_add_u32 m0, s33, 12288
    s_nop 0
    buffer_load_dwordx4 v26, s[40:43], s34 offen lds
    s_add_u32 s34, s83, 3702784
    s_add_u32 m0, s33, 13312
    s_nop 0
    buffer_load_dwordx4 v24, s[40:43], s34 offen lds
    s_add_u32 s34, s83, 3801088
    s_add_u32 m0, s33, 14336
    s_nop 0
    buffer_load_dwordx4 v26, s[40:43], s34 offen lds
    s_add_u32 s34, s83, 3833856
    s_add_u32 m0, s33, 15360
    s_nop 0
    buffer_load_dwordx4 v24, s[40:43], s34 offen lds
    ds_read_b64_tr_b16 a[112:113], v88 offset:28672
    ds_read_b64_tr_b16 a[114:115], v89 offset:28672
    ds_read_b64_tr_b16 a[116:117], v90 offset:28672
    ds_read_b64_tr_b16 a[118:119], v91 offset:28672
    ds_read_b64_tr_b16 a[120:121], v92 offset:28672
    ds_read_b64_tr_b16 a[122:123], v93 offset:28672
    ds_read_b64_tr_b16 a[124:125], v94 offset:28672
    ds_read_b64_tr_b16 a[126:127], v95 offset:28672
    s_waitcnt vmcnt(16)
    s_waitcnt lgkmcnt(0)
    s_barrier
    s_add_u32 s34, s83, 4194304
    s_add_u32 m0, s33, 16384
    s_nop 0
    buffer_load_dwordx4 v26, s[40:43], s34 offen lds
    s_add_u32 s34, s83, 4227072
    s_add_u32 m0, s33, 17408
    s_nop 0
    buffer_load_dwordx4 v24, s[40:43], s34 offen lds
    s_add_u32 s34, s83, 4325376
    s_add_u32 m0, s33, 18432
    s_nop 0
    buffer_load_dwordx4 v26, s[40:43], s34 offen lds
    s_add_u32 s34, s83, 4358144
    s_add_u32 m0, s33, 19456
    s_nop 0
    buffer_load_dwordx4 v24, s[40:43], s34 offen lds
    ds_read_b64_tr_b16 a[128:129], v88 offset:32768
    ds_read_b64_tr_b16 a[130:131], v89 offset:32768
    ds_read_b64_tr_b16 a[132:133], v90 offset:32768
    ds_read_b64_tr_b16 a[134:135], v91 offset:32768
    ds_read_b64_tr_b16 a[136:137], v92 offset:32768
    ds_read_b64_tr_b16 a[138:139], v93 offset:32768
    ds_read_b64_tr_b16 a[140:141], v94 offset:32768
    ds_read_b64_tr_b16 a[142:143], v95 offset:32768
    s_waitcnt vmcnt(16)
    s_waitcnt lgkmcnt(0)
    s_barrier
    s_add_u32 s34, s83, 4718592
    s_add_u32 m0, s33, 20480
    s_nop 0
    buffer_load_dwordx4 v26, s[40:43], s34 offen lds
    s_add_u32 s34, s83, 4751360
    s_add_u32 m0, s33, 21504
    s_nop 0
    buffer_load_dwordx4 v24, s[40:43], s34 offen lds
    s_add_u32 s34, s83, 4849664
    s_add_u32 m0, s33, 22528
    s_nop 0
    buffer_load_dwordx4 v26, s[40:43], s34 offen lds
    s_add_u32 s34, s83, 4882432
    s_add_u32 m0, s33, 23552
    s_nop 0
    buffer_load_dwordx4 v24, s[40:43], s34 offen lds
    ds_read_b64_tr_b16 a[144:145], v88 offset:0
    ds_read_b64_tr_b16 a[146:147], v89 offset:0
    ds_read_b64_tr_b16 a[148:149], v90 offset:0
    ds_read_b64_tr_b16 a[150:151], v91 offset:0
    ds_read_b64_tr_b16 a[152:153], v92 offset:0
    ds_read_b64_tr_b16 a[154:155], v93 offset:0
    ds_read_b64_tr_b16 a[156:157], v94 offset:0
    ds_read_b64_tr_b16 a[158:159], v95 offset:0
    s_waitcnt vmcnt(16)
    s_waitcnt lgkmcnt(0)
    s_barrier
    s_add_u32 s34, s80, 0
    s_add_u32 m0, s33, 24576
    s_nop 0
    buffer_load_dwordx4 v26, s[44:47], s34 offen lds
    s_add_u32 s34, s80, 32768
    s_add_u32 m0, s33, 25600
    s_nop 0
    buffer_load_dwordx4 v24, s[44:47], s34 offen lds
    s_add_u32 s34, s80, 131072
    s_add_u32 m0, s33, 26624
    s_nop 0
    buffer_load_dwordx4 v26, s[44:47], s34 offen lds
    s_add_u32 s34, s80, 163840
    s_add_u32 m0, s33, 27648
    s_nop 0
    buffer_load_dwordx4 v24, s[44:47], s34 offen lds
    ds_read_b64_tr_b16 a[160:161], v88 offset:4096
    ds_read_b64_tr_b16 a[162:163], v89 offset:4096
    ds_read_b64_tr_b16 a[164:165], v90 offset:4096
    ds_read_b64_tr_b16 a[166:167], v91 offset:4096
    ds_read_b64_tr_b16 a[168:169], v92 offset:4096
    ds_read_b64_tr_b16 a[170:171], v93 offset:4096
    ds_read_b64_tr_b16 a[172:173], v94 offset:4096
    ds_read_b64_tr_b16 a[174:175], v95 offset:4096
    s_waitcnt vmcnt(16)
    s_waitcnt lgkmcnt(0)
    s_barrier
    s_add_u32 s34, s80, 524288
    s_add_u32 m0, s33, 28672
    s_nop 0
    buffer_load_dwordx4 v26, s[44:47], s34 offen lds
    s_add_u32 s34, s80, 557056
    s_add_u32 m0, s33, 29696
    s_nop 0
    buffer_load_dwordx4 v24, s[44:47], s34 offen lds
    s_add_u32 s34, s80, 655360
    s_add_u32 m0, s33, 30720
    s_nop 0
    buffer_load_dwordx4 v26, s[44:47], s34 offen lds
    s_add_u32 s34, s80, 688128
    s_add_u32 m0, s33, 31744
    s_nop 0
    buffer_load_dwordx4 v24, s[44:47], s34 offen lds
    ds_read_b64_tr_b16 a[176:177], v88 offset:8192
    ds_read_b64_tr_b16 a[178:179], v89 offset:8192
    ds_read_b64_tr_b16 a[180:181], v90 offset:8192
    ds_read_b64_tr_b16 a[182:183], v91 offset:8192
    ds_read_b64_tr_b16 a[184:185], v92 offset:8192
    ds_read_b64_tr_b16 a[186:187], v93 offset:8192
    ds_read_b64_tr_b16 a[188:189], v94 offset:8192
    ds_read_b64_tr_b16 a[190:191], v95 offset:8192
    s_waitcnt vmcnt(16)
    s_waitcnt lgkmcnt(0)
    s_barrier
    s_add_u32 s34, s80, 1572864
    s_add_u32 m0, s33, 32768
    s_nop 0
    buffer_load_dwordx4 v26, s[44:47], s34 offen lds
    s_add_u32 s34, s80, 1605632
    s_add_u32 m0, s33, 33792
    s_nop 0
    buffer_load_dwordx4 v24, s[44:47], s34 offen lds
    s_add_u32 s34, s80, 1703936
    s_add_u32 m0, s33, 34816
    s_nop 0
    buffer_load_dwordx4 v26, s[44:47], s34 offen lds
    s_add_u32 s34, s80, 1736704
    s_add_u32 m0, s33, 35840
    s_nop 0
    buffer_load_dwordx4 v24, s[44:47], s34 offen lds
    s_mov_b64 exec, 1
    buffer_atomic_add v73, v75, s[8:11], s82 offen
    s_mov_b64 exec, -1
    ds_read_b64_tr_b16 a[192:193], v88 offset:12288
    ds_read_b64_tr_b16 a[194:195], v89 offset:12288
    ds_read_b64_tr_b16 a[196:197], v90 offset:12288
    ds_read_b64_tr_b16 a[198:199], v91 offset:12288
    ds_read_b64_tr_b16 a[200:201], v92 offset:12288
    ds_read_b64_tr_b16 a[202:203], v93 offset:12288
    ds_read_b64_tr_b16 a[204:205], v94 offset:12288
    ds_read_b64_tr_b16 a[206:207], v95 offset:12288
    s_waitcnt vmcnt(17)
    s_waitcnt lgkmcnt(0)
    s_barrier
    s_add_u32 s34, s80, 2097152
    s_add_u32 m0, s33, 0
    s_nop 0
    buffer_load_dwordx4 v26, s[44:47], s34 offen lds
    s_add_u32 s34, s80, 2129920
    s_add_u32 m0, s33, 1024
    s_nop 0
    buffer_load_dwordx4 v24, s[44:47], s34 offen lds
    s_add_u32 s34, s80, 2228224
    s_add_u32 m0, s33, 2048
    s_nop 0
    buffer_load_dwordx4 v26, s[44:47], s34 offen lds
    s_add_u32 s34, s80, 2260992
    s_add_u32 m0, s33, 3072
    s_nop 0
    buffer_load_dwordx4 v24, s[44:47], s34 offen lds
    ds_read_b64_tr_b16 a[208:209], v88 offset:16384
    ds_read_b64_tr_b16 a[210:211], v89 offset:16384
    ds_read_b64_tr_b16 a[212:213], v90 offset:16384
    ds_read_b64_tr_b16 a[214:215], v91 offset:16384
    ds_read_b64_tr_b16 a[216:217], v92 offset:16384
    ds_read_b64_tr_b16 a[218:219], v93 offset:16384
    ds_read_b64_tr_b16 a[220:221], v94 offset:16384
    ds_read_b64_tr_b16 a[222:223], v95 offset:16384
    s_waitcnt vmcnt(17)
    s_waitcnt lgkmcnt(0)
    s_barrier
    s_add_u32 s34, s83, 2621440
    s_add_u32 m0, s33, 4096
    s_nop 0
    buffer_load_dwordx4 v26, s[44:47], s34 offen lds
    s_add_u32 s34, s83, 2654208
    s_add_u32 m0, s33, 5120
    s_nop 0
    buffer_load_dwordx4 v24, s[44:47], s34 offen lds
    s_add_u32 s34, s83, 2752512
    s_add_u32 m0, s33, 6144
    s_nop 0
    buffer_load_dwordx4 v26, s[44:47], s34 offen lds
    s_add_u32 s34, s83, 2785280
    s_add_u32 m0, s33, 7168
    s_nop 0
    buffer_load_dwordx4 v24, s[44:47], s34 offen lds
    ds_read_b64_tr_b16 a[224:225], v88 offset:20480
    ds_read_b64_tr_b16 a[226:227], v89 offset:20480
    ds_read_b64_tr_b16 a[228:229], v90 offset:20480
    ds_read_b64_tr_b16 a[230:231], v91 offset:20480
    ds_read_b64_tr_b16 a[232:233], v92 offset:20480
    ds_read_b64_tr_b16 a[234:235], v93 offset:20480
    ds_read_b64_tr_b16 a[236:237], v94 offset:20480
    ds_read_b64_tr_b16 a[238:239], v95 offset:20480
    s_waitcnt vmcnt(17)
    s_waitcnt lgkmcnt(0)
    s_barrier
    s_add_u32 s34, s83, 3145728
    s_add_u32 m0, s33, 8192
    s_nop 0
    buffer_load_dwordx4 v26, s[44:47], s34 offen lds
    s_add_u32 s34, s83, 3178496
    s_add_u32 m0, s33, 9216
    s_nop 0
    buffer_load_dwordx4 v24, s[44:47], s34 offen lds
    s_add_u32 s34, s83, 3276800
    s_add_u32 m0, s33, 10240
    s_nop 0
    buffer_load_dwordx4 v26, s[44:47], s34 offen lds
    s_add_u32 s34, s83, 3309568
    s_add_u32 m0, s33, 11264
    s_nop 0
    buffer_load_dwordx4 v24, s[44:47], s34 offen lds
    ds_read_b64_tr_b16 a[240:241], v88 offset:24576
    ds_read_b64_tr_b16 a[242:243], v89 offset:24576
    ds_read_b64_tr_b16 a[244:245], v90 offset:24576
    ds_read_b64_tr_b16 a[246:247], v91 offset:24576
    ds_read_b64_tr_b16 a[248:249], v92 offset:24576
    ds_read_b64_tr_b16 a[250:251], v93 offset:24576
    ds_read_b64_tr_b16 a[252:253], v94 offset:24576
    ds_read_b64_tr_b16 a[254:255], v95 offset:24576
    s_waitcnt vmcnt(17)
    s_waitcnt lgkmcnt(0)
    s_barrier
    s_add_u32 s34, s83, 3670016
    s_add_u32 m0, s33, 12288
    s_nop 0
    buffer_load_dwordx4 v26, s[44:47], s34 offen lds
    s_add_u32 s34, s83, 3702784
    s_add_u32 m0, s33, 13312
    s_nop 0
    buffer_load_dwordx4 v24, s[44:47], s34 offen lds
    s_add_u32 s34, s83, 3801088
    s_add_u32 m0, s33, 14336
    s_nop 0
    buffer_load_dwordx4 v26, s[44:47], s34 offen lds
    s_add_u32 s34, s83, 3833856
    s_add_u32 m0, s33, 15360
    s_nop 0
    buffer_load_dwordx4 v24, s[44:47], s34 offen lds
    ds_read_b64_tr_b16 v[96:97], v88 offset:28672
    ds_read_b64_tr_b16 v[98:99], v89 offset:28672
    ds_read_b64_tr_b16 v[100:101], v90 offset:28672
    ds_read_b64_tr_b16 v[102:103], v91 offset:28672
    ds_read_b64_tr_b16 v[104:105], v92 offset:28672
    ds_read_b64_tr_b16 v[106:107], v93 offset:28672
    ds_read_b64_tr_b16 v[108:109], v94 offset:28672
    ds_read_b64_tr_b16 v[110:111], v95 offset:28672
    s_waitcnt vmcnt(17)
    s_waitcnt lgkmcnt(0)
    s_barrier
    s_add_u32 s34, s83, 4194304
    s_add_u32 m0, s33, 16384
    s_nop 0
    buffer_load_dwordx4 v26, s[44:47], s34 offen lds
    s_add_u32 s34, s83, 4227072
    s_add_u32 m0, s33, 17408
    s_nop 0
    buffer_load_dwordx4 v24, s[44:47], s34 offen lds
    s_add_u32 s34, s83, 4325376
    s_add_u32 m0, s33, 18432
    s_nop 0
    buffer_load_dwordx4 v26, s[44:47], s34 offen lds
    s_add_u32 s34, s83, 4358144
    s_add_u32 m0, s33, 19456
    s_nop 0
    buffer_load_dwordx4 v24, s[44:47], s34 offen lds
    ds_read_b64_tr_b16 v[112:113], v88 offset:32768
    ds_read_b64_tr_b16 v[114:115], v89 offset:32768
    ds_read_b64_tr_b16 v[116:117], v90 offset:32768
    ds_read_b64_tr_b16 v[118:119], v91 offset:32768
    ds_read_b64_tr_b16 v[120:121], v92 offset:32768
    ds_read_b64_tr_b16 v[122:123], v93 offset:32768
    ds_read_b64_tr_b16 v[124:125], v94 offset:32768
    ds_read_b64_tr_b16 v[126:127], v95 offset:32768
    s_waitcnt vmcnt(16)
    s_waitcnt lgkmcnt(0)
    s_barrier
    s_add_u32 s34, s83, 4718592
    s_add_u32 m0, s33, 20480
    s_nop 0
    buffer_load_dwordx4 v26, s[44:47], s34 offen lds
    s_add_u32 s34, s83, 4751360
    s_add_u32 m0, s33, 21504
    s_nop 0
    buffer_load_dwordx4 v24, s[44:47], s34 offen lds
    s_add_u32 s34, s83, 4849664
    s_add_u32 m0, s33, 22528
    s_nop 0
    buffer_load_dwordx4 v26, s[44:47], s34 offen lds
    s_add_u32 s34, s83, 4882432
    s_add_u32 m0, s33, 23552
    s_nop 0
    buffer_load_dwordx4 v24, s[44:47], s34 offen lds
    ds_read_b64_tr_b16 v[128:129], v88 offset:0
    ds_read_b64_tr_b16 v[130:131], v89 offset:0
    ds_read_b64_tr_b16 v[132:133], v90 offset:0
    ds_read_b64_tr_b16 v[134:135], v91 offset:0
    ds_read_b64_tr_b16 v[136:137], v92 offset:0
    ds_read_b64_tr_b16 v[138:139], v93 offset:0
    ds_read_b64_tr_b16 v[140:141], v94 offset:0
    ds_read_b64_tr_b16 v[142:143], v95 offset:0
    s_waitcnt vmcnt(16)
    s_waitcnt lgkmcnt(0)
    s_barrier
    s_add_u32 s34, s81, 128
    s_add_u32 m0, s33, 24576
    s_nop 0
    buffer_load_dwordx4 v27, s[68:71], s34 offen lds
    s_add_u32 s34, s81, 41088
    s_add_u32 m0, s33, 25600
    s_nop 0
    buffer_load_dwordx4 v25, s[68:71], s34 offen lds
    s_add_u32 s34, s81, 5248
    s_add_u32 m0, s33, 26624
    s_nop 0
    buffer_load_dwordx4 v27, s[68:71], s34 offen lds
    s_add_u32 s34, s81, 46208
    s_add_u32 m0, s33, 27648
    s_nop 0
    buffer_load_dwordx4 v25, s[68:71], s34 offen lds
    ds_read_b64_tr_b16 v[144:145], v88 offset:4096
    ds_read_b64_tr_b16 v[146:147], v89 offset:4096
    ds_read_b64_tr_b16 v[148:149], v90 offset:4096
    ds_read_b64_tr_b16 v[150:151], v91 offset:4096
    ds_read_b64_tr_b16 v[152:153], v92 offset:4096
    ds_read_b64_tr_b16 v[154:155], v93 offset:4096
    ds_read_b64_tr_b16 v[156:157], v94 offset:4096
    ds_read_b64_tr_b16 v[158:159], v95 offset:4096
    s_waitcnt vmcnt(16)
    s_waitcnt lgkmcnt(0)
    s_barrier
    s_add_u32 s34, s81, 256
    s_add_u32 m0, s33, 28672
    s_nop 0
    buffer_load_dwordx4 v27, s[68:71], s34 offen lds
    s_add_u32 s34, s81, 41216
    s_add_u32 m0, s33, 29696
    s_nop 0
    buffer_load_dwordx4 v25, s[68:71], s34 offen lds
    s_add_u32 s34, s81, 5376
    s_add_u32 m0, s33, 30720
    s_nop 0
    buffer_load_dwordx4 v27, s[68:71], s34 offen lds
    s_add_u32 s34, s81, 46336
    s_add_u32 m0, s33, 31744
    s_nop 0
    buffer_load_dwordx4 v25, s[68:71], s34 offen lds
    ds_read_b64_tr_b16 v[160:161], v88 offset:8192
    ds_read_b64_tr_b16 v[162:163], v89 offset:8192
    ds_read_b64_tr_b16 v[164:165], v90 offset:8192
    ds_read_b64_tr_b16 v[166:167], v91 offset:8192
    ds_read_b64_tr_b16 v[168:169], v92 offset:8192
    ds_read_b64_tr_b16 v[170:171], v93 offset:8192
    ds_read_b64_tr_b16 v[172:173], v94 offset:8192
    ds_read_b64_tr_b16 v[174:175], v95 offset:8192
    s_waitcnt vmcnt(16)
    s_waitcnt lgkmcnt(0)
    s_barrier
    s_add_u32 s34, s80, 0
    s_add_u32 m0, s33, 32768
    s_nop 0
    buffer_load_dwordx4 v26, s[36:39], s34 offen lds
    s_add_u32 s34, s80, 32768
    s_add_u32 m0, s33, 33792
    s_nop 0
    buffer_load_dwordx4 v24, s[36:39], s34 offen lds
    s_add_u32 s34, s80, 131072
    s_add_u32 m0, s33, 34816
    s_nop 0
    buffer_load_dwordx4 v26, s[36:39], s34 offen lds
    s_add_u32 s34, s80, 163840
    s_add_u32 m0, s33, 35840
    s_nop 0
    buffer_load_dwordx4 v24, s[36:39], s34 offen lds
    ds_read_b64_tr_b16 v[176:177], v88 offset:12288
    ds_read_b64_tr_b16 v[178:179], v89 offset:12288
    ds_read_b64_tr_b16 v[180:181], v90 offset:12288
    ds_read_b64_tr_b16 v[182:183], v91 offset:12288
    ds_read_b64_tr_b16 v[184:185], v92 offset:12288
    ds_read_b64_tr_b16 v[186:187], v93 offset:12288
    ds_read_b64_tr_b16 v[188:189], v94 offset:12288
    ds_read_b64_tr_b16 v[190:191], v95 offset:12288
    s_waitcnt vmcnt(16)
    s_waitcnt lgkmcnt(0)
    s_barrier
    s_add_u32 s34, s80, 524288
    s_add_u32 m0, s33, 0
    s_nop 0
    buffer_load_dwordx4 v26, s[40:43], s34 offen lds
    s_add_u32 s34, s80, 557056
    s_add_u32 m0, s33, 1024
    s_nop 0
    buffer_load_dwordx4 v24, s[40:43], s34 offen lds
    s_add_u32 s34, s80, 655360
    s_add_u32 m0, s33, 2048
    s_nop 0
    buffer_load_dwordx4 v26, s[40:43], s34 offen lds
    s_add_u32 s34, s80, 688128
    s_add_u32 m0, s33, 3072
    s_nop 0
    buffer_load_dwordx4 v24, s[40:43], s34 offen lds
    ds_read_b64_tr_b16 v[192:193], v88 offset:16384
    ds_read_b64_tr_b16 v[194:195], v89 offset:16384
    ds_read_b64_tr_b16 v[196:197], v90 offset:16384
    ds_read_b64_tr_b16 v[198:199], v91 offset:16384
    ds_read_b64_tr_b16 v[200:201], v92 offset:16384
    ds_read_b64_tr_b16 v[202:203], v93 offset:16384
    ds_read_b64_tr_b16 v[204:205], v94 offset:16384
    ds_read_b64_tr_b16 v[206:207], v95 offset:16384
    s_waitcnt vmcnt(16)
    s_waitcnt lgkmcnt(0)
    s_barrier
    s_add_u32 s34, s80, 1048576
    s_add_u32 m0, s33, 4096
    s_nop 0
    buffer_load_dwordx4 v26, s[44:47], s34 offen lds
    s_add_u32 s34, s80, 1081344
    s_add_u32 m0, s33, 5120
    s_nop 0
    buffer_load_dwordx4 v24, s[44:47], s34 offen lds
    s_add_u32 s34, s80, 1179648
    s_add_u32 m0, s33, 6144
    s_nop 0
    buffer_load_dwordx4 v26, s[44:47], s34 offen lds
    s_add_u32 s34, s80, 1212416
    s_add_u32 m0, s33, 7168
    s_nop 0
    buffer_load_dwordx4 v24, s[44:47], s34 offen lds
    ds_read_b64_tr_b16 v[208:209], v88 offset:20480
    ds_read_b64_tr_b16 v[210:211], v89 offset:20480
    ds_read_b64_tr_b16 v[212:213], v90 offset:20480
    ds_read_b64_tr_b16 v[214:215], v91 offset:20480
    ds_read_b64_tr_b16 v[216:217], v92 offset:20480
    ds_read_b64_tr_b16 v[218:219], v93 offset:20480
    ds_read_b64_tr_b16 v[220:221], v94 offset:20480
    ds_read_b64_tr_b16 v[222:223], v95 offset:20480
    s_waitcnt vmcnt(16)
    s_waitcnt lgkmcnt(0)
    s_barrier
    s_add_u32 s34, s80, 2097152
    s_add_u32 m0, s33, 8192
    s_nop 0
    buffer_load_dwordx4 v26, s[36:39], s34 offen lds
    s_add_u32 s34, s80, 2129920
    s_add_u32 m0, s33, 9216
    s_nop 0
    buffer_load_dwordx4 v24, s[36:39], s34 offen lds
    s_add_u32 s34, s80, 2228224
    s_add_u32 m0, s33, 10240
    s_nop 0
    buffer_load_dwordx4 v26, s[36:39], s34 offen lds
    s_add_u32 s34, s80, 2260992
    s_add_u32 m0, s33, 11264
    s_nop 0
    buffer_load_dwordx4 v24, s[36:39], s34 offen lds
    ds_read_b64_tr_b16 v[224:225], v80 offset:24576
    ds_read_b64_tr_b16 v[226:227], v81 offset:24576
    ds_read_b64_tr_b16 v[228:229], v82 offset:24576
    ds_read_b64_tr_b16 v[230:231], v83 offset:24576
    ds_read_b64_tr_b16 v[232:233], v84 offset:24576
    ds_read_b64_tr_b16 v[234:235], v85 offset:24576
    ds_read_b64_tr_b16 v[236:237], v86 offset:24576
    ds_read_b64_tr_b16 v[238:239], v87 offset:24576
    s_waitcnt vmcnt(16)
    s_waitcnt lgkmcnt(0)
    s_barrier
    s_add_u32 s34, s83, 2621440
    s_add_u32 m0, s33, 12288
    s_nop 0
    buffer_load_dwordx4 v26, s[40:43], s34 offen lds
    s_add_u32 s34, s83, 2654208
    s_add_u32 m0, s33, 13312
    s_nop 0
    buffer_load_dwordx4 v24, s[40:43], s34 offen lds
    s_add_u32 s34, s83, 2752512
    s_add_u32 m0, s33, 14336
    s_nop 0
    buffer_load_dwordx4 v26, s[40:43], s34 offen lds
    s_add_u32 s34, s83, 2785280
    s_add_u32 m0, s33, 15360
    s_nop 0
    buffer_load_dwordx4 v24, s[40:43], s34 offen lds
    ds_read_b64_tr_b16 v[240:241], v80 offset:28672
    ds_read_b64_tr_b16 v[242:243], v81 offset:28672
    ds_read_b64_tr_b16 v[244:245], v82 offset:28672
    ds_read_b64_tr_b16 v[246:247], v83 offset:28672
    ds_read_b64_tr_b16 v[248:249], v84 offset:28672
    ds_read_b64_tr_b16 v[250:251], v85 offset:28672
    ds_read_b64_tr_b16 v[252:253], v86 offset:28672
    ds_read_b64_tr_b16 v[254:255], v87 offset:28672
    s_waitcnt vmcnt(16)
    s_waitcnt lgkmcnt(0)
    s_barrier
    s_add_u32 s34, s83, 4194304
    s_add_u32 m0, s33, 16384
    s_nop 0
    buffer_load_dwordx4 v26, s[36:39], s34 offen lds
    s_add_u32 s34, s83, 4227072
    s_add_u32 m0, s33, 17408
    s_nop 0
    buffer_load_dwordx4 v24, s[36:39], s34 offen lds
    s_add_u32 s34, s83, 4325376
    s_add_u32 m0, s33, 18432
    s_nop 0
    buffer_load_dwordx4 v26, s[36:39], s34 offen lds
    s_add_u32 s34, s83, 4358144
    s_add_u32 m0, s33, 19456
    s_nop 0
    buffer_load_dwordx4 v24, s[36:39], s34 offen lds
    ds_read_b64_tr_b16 v[32:33], v88 offset:32768
    ds_read_b64_tr_b16 v[34:35], v89 offset:32768
    ds_read_b64_tr_b16 v[36:37], v90 offset:32768
    ds_read_b64_tr_b16 v[38:39], v91 offset:32768
    ds_read_b64_tr_b16 v[40:41], v92 offset:32768
    ds_read_b64_tr_b16 v[42:43], v93 offset:32768
    ds_read_b64_tr_b16 v[44:45], v94 offset:32768
    ds_read_b64_tr_b16 v[46:47], v95 offset:32768
    s_waitcnt vmcnt(16)
    s_waitcnt lgkmcnt(0)
    s_barrier
    ds_write_b128 v2, v[32:35] offset:32768
    ds_write_b128 v2, v[36:39] offset:33792
    ds_write_b128 v2, v[40:43] offset:34816
    ds_write_b128 v2, v[44:47] offset:35840
    s_add_u32 s34, s81, 0
    s_add_u32 m0, s33, 20480
    s_nop 0
    buffer_load_dwordx4 v27, s[68:71], s34 offen lds
    s_add_u32 s34, s81, 40960
    s_add_u32 m0, s33, 21504
    s_nop 0
    buffer_load_dwordx4 v25, s[68:71], s34 offen lds
    s_add_u32 s34, s81, 5120
    s_add_u32 m0, s33, 22528
    s_nop 0
    buffer_load_dwordx4 v27, s[68:71], s34 offen lds
    s_add_u32 s34, s81, 46080
    s_add_u32 m0, s33, 23552
    s_nop 0
    buffer_load_dwordx4 v25, s[68:71], s34 offen lds
    ds_read_b64_tr_b16 v[48:49], v88 offset:0
    ds_read_b64_tr_b16 v[50:51], v89 offset:0
    ds_read_b64_tr_b16 v[52:53], v90 offset:0
    ds_read_b64_tr_b16 v[54:55], v91 offset:0
    ds_read_b64_tr_b16 v[56:57], v92 offset:0
    ds_read_b64_tr_b16 v[58:59], v93 offset:0
    ds_read_b64_tr_b16 v[60:61], v94 offset:0
    ds_read_b64_tr_b16 v[62:63], v95 offset:0
    s_waitcnt vmcnt(16)
    s_waitcnt lgkmcnt(0)
    s_barrier
    ds_write_b128 v2, v[48:51] offset:0
    ds_write_b128 v2, v[52:55] offset:1024
    ds_write_b128 v2, v[56:59] offset:2048
    ds_write_b128 v2, v[60:63] offset:3072
    s_add_u32 s34, s81, 384
    s_add_u32 m0, s33, 24576
    s_nop 0
    buffer_load_dwordx4 v27, s[68:71], s34 offen lds
    s_add_u32 s34, s81, 41344
    s_add_u32 m0, s33, 25600
    s_nop 0
    buffer_load_dwordx4 v25, s[68:71], s34 offen lds
    s_add_u32 s34, s81, 5504
    s_add_u32 m0, s33, 26624
    s_nop 0
    buffer_load_dwordx4 v27, s[68:71], s34 offen lds
    s_add_u32 s34, s81, 46464
    s_add_u32 m0, s33, 27648
    s_nop 0
    buffer_load_dwordx4 v25, s[68:71], s34 offen lds
    ds_read_b64_tr_b16 v[32:33], v88 offset:4096
    ds_read_b64_tr_b16 v[34:35], v89 offset:4096
    ds_read_b64_tr_b16 v[36:37], v90 offset:4096
    ds_read_b64_tr_b16 v[38:39], v91 offset:4096
    ds_read_b64_tr_b16 v[40:41], v92 offset:4096
    ds_read_b64_tr_b16 v[42:43], v93 offset:4096
    ds_read_b64_tr_b16 v[44:45], v94 offset:4096
    ds_read_b64_tr_b16 v[46:47], v95 offset:4096
    s_waitcnt vmcnt(16)
    s_waitcnt lgkmcnt(0)
    s_barrier
    ds_write_b128 v2, v[32:35] offset:4096
    ds_write_b128 v2, v[36:39] offset:5120
    ds_write_b128 v2, v[40:43] offset:6144
    ds_write_b128 v2, v[44:47] offset:7168
    s_add_u32 s34, s81, 512
    s_add_u32 m0, s33, 28672
    s_nop 0
    buffer_load_dwordx4 v27, s[68:71], s34 offen lds
    s_add_u32 s34, s81, 41472
    s_add_u32 m0, s33, 29696
    s_nop 0
    buffer_load_dwordx4 v25, s[68:71], s34 offen lds
    s_add_u32 s34, s81, 5632
    s_add_u32 m0, s33, 30720
    s_nop 0
    buffer_load_dwordx4 v27, s[68:71], s34 offen lds
    s_add_u32 s34, s81, 46592
    s_add_u32 m0, s33, 31744
    s_nop 0
    buffer_load_dwordx4 v25, s[68:71], s34 offen lds
    ds_read_b64_tr_b16 v[48:49], v88 offset:8192
    ds_read_b64_tr_b16 v[50:51], v89 offset:8192
    ds_read_b64_tr_b16 v[52:53], v90 offset:8192
    ds_read_b64_tr_b16 v[54:55], v91 offset:8192
    ds_read_b64_tr_b16 v[56:57], v92 offset:8192
    ds_read_b64_tr_b16 v[58:59], v93 offset:8192
    ds_read_b64_tr_b16 v[60:61], v94 offset:8192
    ds_read_b64_tr_b16 v[62:63], v95 offset:8192
    s_waitcnt vmcnt(16)
    s_waitcnt lgkmcnt(0)
    s_barrier
    ds_write_b128 v2, v[48:51] offset:8192
    ds_write_b128 v2, v[52:55] offset:9216
    ds_write_b128 v2, v[56:59] offset:10240
    ds_write_b128 v2, v[60:63] offset:11264
    ds_read_b64_tr_b16 v[32:33], v88 offset:12288
    ds_read_b64_tr_b16 v[34:35], v89 offset:12288
    ds_read_b64_tr_b16 v[36:37], v90 offset:12288
    ds_read_b64_tr_b16 v[38:39], v91 offset:12288
    ds_read_b64_tr_b16 v[40:41], v92 offset:12288
    ds_read_b64_tr_b16 v[42:43], v93 offset:12288
    ds_read_b64_tr_b16 v[44:45], v94 offset:12288
    ds_read_b64_tr_b16 v[46:47], v95 offset:12288
    s_waitcnt vmcnt(12)
    s_waitcnt lgkmcnt(0)
    s_barrier
    ds_write_b128 v2, v[32:35] offset:12288
    ds_write_b128 v2, v[36:39] offset:13312
    ds_write_b128 v2, v[40:43] offset:14336
    ds_write_b128 v2, v[44:47] offset:15360
    v_lshrrev_b32 v12, 2, v0
    buffer_load_dword v13, v12, s[8:11], 0 offen sc1
    ds_read_b64_tr_b16 v[48:49], v88 offset:16384
    ds_read_b64_tr_b16 v[50:51], v89 offset:16384
    ds_read_b64_tr_b16 v[52:53], v90 offset:16384
    ds_read_b64_tr_b16 v[54:55], v91 offset:16384
    ds_read_b64_tr_b16 v[56:57], v92 offset:16384
    ds_read_b64_tr_b16 v[58:59], v93 offset:16384
    ds_read_b64_tr_b16 v[60:61], v94 offset:16384
    ds_read_b64_tr_b16 v[62:63], v95 offset:16384
    s_waitcnt vmcnt(9)
    s_waitcnt lgkmcnt(0)
    s_barrier
    ds_write_b128 v2, v[48:51] offset:16384
    ds_write_b128 v2, v[52:55] offset:17408
    ds_write_b128 v2, v[56:59] offset:18432
    ds_write_b128 v2, v[60:63] offset:19456
    ds_read_b64_tr_b16 v[32:33], v80 offset:20480
    ds_read_b64_tr_b16 v[34:35], v81 offset:20480
    ds_read_b64_tr_b16 v[36:37], v82 offset:20480
    ds_read_b64_tr_b16 v[38:39], v83 offset:20480
    ds_read_b64_tr_b16 v[40:41], v84 offset:20480
    ds_read_b64_tr_b16 v[42:43], v85 offset:20480
    ds_read_b64_tr_b16 v[44:45], v86 offset:20480
    ds_read_b64_tr_b16 v[46:47], v87 offset:20480
    s_waitcnt vmcnt(5)
    s_waitcnt lgkmcnt(0)
    s_barrier
    ds_write_b128 v2, v[32:35] offset:20480
    ds_write_b128 v2, v[36:39] offset:21504
    ds_write_b128 v2, v[40:43] offset:22528
    ds_write_b128 v2, v[44:47] offset:23552
    ds_read_b64_tr_b16 v[48:49], v80 offset:24576
    ds_read_b64_tr_b16 v[50:51], v81 offset:24576
    ds_read_b64_tr_b16 v[52:53], v82 offset:24576
    ds_read_b64_tr_b16 v[54:55], v83 offset:24576
    ds_read_b64_tr_b16 v[56:57], v84 offset:24576
    ds_read_b64_tr_b16 v[58:59], v85 offset:24576
    ds_read_b64_tr_b16 v[60:61], v86 offset:24576
    ds_read_b64_tr_b16 v[62:63], v87 offset:24576
    s_waitcnt vmcnt(1)
    s_waitcnt lgkmcnt(0)
    s_barrier
    ds_write_b128 v2, v[48:51] offset:24576
    ds_write_b128 v2, v[52:55] offset:25600
    ds_write_b128 v2, v[56:59] offset:26624
    ds_write_b128 v2, v[60:63] offset:27648
    ds_read_b64_tr_b16 v[32:33], v80 offset:28672
    ds_read_b64_tr_b16 v[34:35], v81 offset:28672
    ds_read_b64_tr_b16 v[36:37], v82 offset:28672
    ds_read_b64_tr_b16 v[38:39], v83 offset:28672
    ds_read_b64_tr_b16 v[40:41], v84 offset:28672
    ds_read_b64_tr_b16 v[42:43], v85 offset:28672
    ds_read_b64_tr_b16 v[44:45], v86 offset:28672
    ds_read_b64_tr_b16 v[46:47], v87 offset:28672
    s_waitcnt lgkmcnt(0)
    s_barrier
    ds_write_b128 v2, v[32:35] offset:28672
    ds_write_b128 v2, v[36:39] offset:29696
    ds_write_b128 v2, v[40:43] offset:30720
    ds_write_b128 v2, v[44:47] offset:31744
    s_mov_b32 s89, 0
LC_st:
    s_waitcnt vmcnt(0)
    v_readlane_b32 s34, v13, 63
    v_cmp_gt_u32 vcc, 192, v13
    s_nop 0
    s_lshr_b64 vcc, vcc, 16
    s_ff1_i32_b64 s35, vcc
    s_lshl_b32 s35, s35, 3
    s_lshr_b32 s50, 0x40120600, s35
    s_and_b32 s50, s50, 255
    s_cmp_lt_u32 s34, 64
    s_cselect_b32 s35, 0, s50
    s_cmp_ge_u32 s35, 2
    s_cbranch_scc1 LC_stok
    s_sleep 12
    buffer_load_dword v13, v12, s[8:11], 0 offen sc1
    s_add_u32 s89, s89, 1
    s_cmp_gt_u32 s89, 2000000
    s_cbranch_scc0 LC_st
    s_branch LC_fail
LC_stok:
    v_readlane_b32 s34, v13, 61
    v_readlane_b32 s35, v13, 62
    s_nop 0
    s_bcnt1_i32_b64 s25, s[34:35]
    v_readlane_b32 s34, v13, 60
    s_nop 0
    s_add_u32 s60, s60, s34
    s_add_u32 s91, s91, s34
    s_cmp_eq_u32 s31, 3
    s_cselect_b32 s50, s50, 64
    s_mov_b32 s41, s61
    s_add_u32 s42, s41, 4096
    s_mov_b32 s43, s62
    s_waitcnt lgkmcnt(0)
    buffer_load_dwordx4 v[64:67], v0, s[12:15], s41 offen sc1
    buffer_load_dwordx4 v[68:71], v0, s[12:15], s42 offen sc1
    buffer_load_dwordx4 v[48:51], v0, s[12:15], s43 offen sc1
    buffer_load_dwordx4 v[52:55], v0, s[12:15], s43 offen offset:1024 sc1
    v_mov_b64 v[12:13], 0
    v_mov_b64 v[14:15], 0
    v_mov_b64 v[16:17], 0
    v_mov_b64 v[18:19], 0
    v_mov_b64 v[20:21], 0
    v_mov_b64 v[22:23], 0
    v_mov_b64 v[24:25], 0
    v_mov_b64 v[26:27], 0
    v_mov_b64 v[28:29], 0
    v_mov_b64 v[30:31], 0
    v_mov_b64 v[32:33], 0
    v_mov_b64 v[34:35], 0
    ds_read_b128 v[56:59], v2 offset:32768
    ds_read_b128 v[60:63], v2 offset:33792
    ds_read_b128 v[72:75], v2 offset:34816
    ds_read_b128 v[76:79], v2 offset:35840
    s_mov_b32 s32, -1
    s_mov_b32 s84, -262144
    s_mov_b32 s88, 0
    s_mov_b32 s89, 0
    s_mov_b32 s65, 0
    v_lshrrev_b32 v86, 2, v3
    s_add_u32 s32, s32, 1
    s_add_u32 s84, s84, 262144
    s_add_u32 s40, s84, 262144
    s_min_u32 s40, s40, 16515072
    s_add_u32 s41, s61, s40
    s_add_u32 s42, s41, 4096
    s_add_u32 s43, s62, s40
    s_and_b32 s85, s32, 1
    s_mul_i32 s85, s85, 163840
    s_add_u32 s92, s55, s85
    s_add_u32 s96, s32, 3
    s_and_b32 s96, s96, 3
    s_mul_i32 s96, s96, 5120
    s_add_u32 s96, s96, s56
    s_add_u32 s44, s63, s84
    s_add_u32 s45, s64, s84
    s_add_u32 s20, s58, s85
    s_add_u32 s21, s20, 32768
    s_add_u32 s22, s20, 65536
    s_add_u32 s23, s20, 98304
    s_add_u32 s24, s20, 131072
    s_cmp_lg_u32 s25, 2
    s_cbranch_scc1 LS_step
    s_branch LF_step
LF_stage:
    ds_write_b128 v3, v[88:91] offset:0
    ds_write_b32 v86, v92 offset:4096
LF_step:
    s_waitcnt lgkmcnt(0)
    s_barrier
    ds_read_b128 v[36:39], v0 offset:0
    buffer_load_dwordx4 v[80:83], v3, s[12:15], s48 offen sc1
    buffer_load_dword v84, v86, s[12:15], s99 offen sc1
    s_waitcnt lgkmcnt(0)
    v_smfmac_f32_16x16x64_bf16 v[12:15], v[36:39], v[56:63], v1
    ds_read_b128 v[40:43], v0 offset:1024
    v_smfmac_f32_16x16x64_bf16 v[16:19], v[36:39], v[72:79], v1
    ds_read_b128 v[44:47], v0 offset:2048
    v_smfmac_f32_16x16x64_bf16 v[20:23], v[36:39], a[112:119], v1
    ds_read_b128 v[56:59], v2 offset:0
    v_smfmac_f32_16x16x64_bf16 v[24:27], v[36:39], a[120:127], v1
    ds_read_b128 v[60:63], v2 offset:1024
    v_smfmac_f32_16x16x64_bf16 v[28:31], v[36:39], a[240:247], v1
    ds_read_b128 v[72:75], v2 offset:2048
    v_smfmac_f32_16x16x64_bf16 v[32:35], v[36:39], a[248:255], v1
    ds_read_b128 v[76:79], v2 offset:3072
    s_waitcnt lgkmcnt(5)
    v_smfmac_f32_16x16x64_bf16 v[12:15], v[40:43], a[0:7], v1
    ds_read_b128 v[36:39], v0 offset:3072
    v_smfmac_f32_16x16x64_bf16 v[16:19], v[40:43], a[8:15], v1
    s_waitcnt lgkmcnt(3)
    v_smfmac_f32_16x16x64_bf16 v[20:23], v[40:43], v[56:63], v1
    ds_read_b128 v[56:59], v2 offset:4096
    s_waitcnt lgkmcnt(2)
    v_smfmac_f32_16x16x64_bf16 v[24:27], v[40:43], v[72:79], v1
    ds_read_b128 v[60:63], v2 offset:5120
    v_smfmac_f32_16x16x64_bf16 v[28:31], v[40:43], v[96:103], v1
    ds_read_b128 v[72:75], v2 offset:6144
    v_smfmac_f32_16x16x64_bf16 v[32:35], v[40:43], v[104:111], v1
    ds_read_b128 v[76:79], v2 offset:7168
    v_smfmac_f32_16x16x64_bf16 v[12:15], v[44:47], a[16:23], v1
    ds_read_b128 v[40:43], v0 offset:4096
    v_mov_b32 v87, s32
    v_smfmac_f32_16x16x64_bf16 v[16:19], v[44:47], a[24:31], v1
    s_mov_b64 exec, 1
    buffer_store_dword v87, v0, s[12:15], s93 offen sc1
    s_mov_b64 exec, -1
    v_smfmac_f32_16x16x64_bf16 v[20:23], v[44:47], a[128:135], v1
    v_smfmac_f32_16x16x64_bf16 v[24:27], v[44:47], a[136:143], v1
    s_waitcnt lgkmcnt(3)
    v_smfmac_f32_16x16x64_bf16 v[28:31], v[44:47], v[56:63], v1
    ds_read_b128 v[56:59], v2 offset:8192
    s_waitcnt lgkmcnt(2)
    v_smfmac_f32_16x16x64_bf16 v[32:35], v[44:47], v[72:79], v1
    ds_read_b128 v[60:63], v2 offset:9216
    v_smfmac_f32_16x16x64_bf16 v[12:15], v[36:39], a[32:39], v1
    ds_read_b128 v[72:75], v2 offset:10240
    v_smfmac_f32_16x16x64_bf16 v[16:19], v[36:39], a[40:47], v1
    ds_read_b128 v[76:79], v2 offset:11264
    v_smfmac_f32_16x16x64_bf16 v[20:23], v[36:39], a[144:151], v1
    s_waitcnt vmcnt(1)
    v_max3_u32 v85, v80, v81, v82
    v_smfmac_f32_16x16x64_bf16 v[24:27], v[36:39], a[152:159], v1
    v_max3_u32 v85, v85, v83, v84
    v_cmp_eq_u32 vcc, -1, v85
    ds_write_b128 v3, v[80:83] offset:5120
    v_smfmac_f32_16x16x64_bf16 v[28:31], v[36:39], v[112:119], v1
    ds_write_b32 v86, v84 offset:9216
    v_smfmac_f32_16x16x64_bf16 v[32:35], v[36:39], v[120:127], v1
    s_cbranch_vccnz LF_rchk
LF_rok:
    s_waitcnt lgkmcnt(4)
    v_smfmac_f32_16x16x64_bf16 v[12:15], v[40:43], v[56:63], v1
    ds_read_b128 v[56:59], v2 offset:12288
    s_waitcnt lgkmcnt(3)
    v_smfmac_f32_16x16x64_bf16 v[16:19], v[40:43], v[72:79], v1
    ds_read_b128 v[60:63], v2 offset:13312
    s_waitcnt lgkmcnt(2)
    s_barrier
    ds_read_b128 v[44:47], v0 offset:5120
    ds_read_b128 v[36:39], v0 offset:6144
    v_smfmac_f32_16x16x64_bf16 v[20:23], v[40:43], a[160:167], v1
    ds_read_b128 v[72:75], v2 offset:14336
    v_smfmac_f32_16x16x64_bf16 v[24:27], v[40:43], a[168:175], v1
    ds_read_b128 v[76:79], v2 offset:15360
    v_smfmac_f32_16x16x64_bf16 v[28:31], v[40:43], v[128:135], v1
    v_smfmac_f32_16x16x64_bf16 v[32:35], v[40:43], v[136:143], v1
    s_waitcnt lgkmcnt(3)
    v_smfmac_f32_16x16x64_bf16 v[12:15], v[44:47], a[48:55], v1
    ds_read_b128 v[40:43], v0 offset:7168
    buffer_load_dwordx4 v[80:83], v0, s[12:15], s41 offen sc1
    v_smfmac_f32_16x16x64_bf16 v[16:19], v[44:47], a[56:63], v1
    s_add_u32 s97, s32, 1
    s_lshl_b32 s48, s97, 15
    v_smfmac_f32_16x16x64_bf16 v[20:23], v[44:47], v[56:63], v1
    ds_read_b128 v[56:59], v2 offset:16384
    s_waitcnt lgkmcnt(2)
    v_smfmac_f32_16x16x64_bf16 v[24:27], v[44:47], v[72:79], v1
    ds_read_b128 v[60:63], v2 offset:17408
    buffer_load_dwordx4 v[84:87], v0, s[12:15], s42 offen sc1
    v_smfmac_f32_16x16x64_bf16 v[12:15], v[36:39], a[64:71], v1
    ds_read_b128 v[44:47], v0 offset:8192
    s_and_b32 s97, s97, 3
    v_smfmac_f32_16x16x64_bf16 v[16:19], v[36:39], a[72:79], v1
    ds_read_b128 v[72:75], v2 offset:18432
    v_smfmac_f32_16x16x64_bf16 v[20:23], v[36:39], a[176:183], v1
    ds_read_b128 v[76:79], v2 offset:19456
    buffer_load_dwordx4 v[88:91], v0, s[12:15], s43 offen sc1
    v_smfmac_f32_16x16x64_bf16 v[24:27], v[36:39], a[184:191], v1
    s_add_u32 s51, s48, s91
    s_add_u32 s48, s48, s60
    s_waitcnt lgkmcnt(5)
    v_smfmac_f32_16x16x64_bf16 v[12:15], v[40:43], a[80:87], v1
    ds_read_b128 v[36:39], v0 offset:9216
    s_mul_i32 s97, s97, 5120
    v_smfmac_f32_16x16x64_bf16 v[16:19], v[40:43], a[88:95], v1
    buffer_load_dwordx4 v[92:95], v0, s[12:15], s43 offen offset:1024 sc1
    s_waitcnt lgkmcnt(3)
    v_smfmac_f32_16x16x64_bf16 v[12:15], v[44:47], v[56:63], v1
    ds_read_b128 v[56:59], v2 offset:20480
    s_waitcnt lgkmcnt(2)
    v_smfmac_f32_16x16x64_bf16 v[16:19], v[44:47], v[72:79], v1
    ds_read_b128 v[60:63], v2 offset:21504
    s_waitcnt lgkmcnt(2)
    v_smfmac_f32_16x16x64_bf16 v[12:15], v[36:39], a[96:103], v1
    s_add_u32 s46, s97, s56
    s_add_u32 s47, s97, s59
    v_smfmac_f32_16x16x64_bf16 v[16:19], v[36:39], a[104:111], v1
    s_add_u32 s98, s47, 4096
    s_add_u32 s99, s48, 4096
    v_smfmac_f32_16x16x64_bf16 v[20:23], v[40:43], a[192:199], v1
    v_smfmac_f32_16x16x64_bf16 v[24:27], v[40:43], a[200:207], v1
    v_smfmac_f32_16x16x64_bf16 v[20:23], v[44:47], a[208:215], v1
    v_add_f32 v12, v12, v14
    v_smfmac_f32_16x16x64_bf16 v[20:23], v[36:39], a[224:231], v1
    v_add_f32 v13, v13, v15
    v_add_f32 v16, v16, v18
    v_smfmac_f32_16x16x64_bf16 v[24:27], v[44:47], a[216:223], v1
    v_add_f32 v17, v17, v19
    v_cvt_pk_bf16_f32 v72, v12, v13
    v_cvt_pk_bf16_f32 v73, v16, v17
    v_smfmac_f32_16x16x64_bf16 v[24:27], v[36:39], a[232:239], v1
    s_nop 0
    v_mfma_f32_16x16x16_bf16 v[12:15], v[72:73], v[4:5], 0
    v_add_f32 v20, v20, v22
    v_add_f32 v21, v21, v23
    v_mfma_f32_16x16x16_bf16 v[16:19], v[72:73], v[6:7], 0
    v_cvt_pk_bf16_f32 v74, v20, v21
    v_add_f32 v24, v24, v26
    v_add_f32 v25, v25, v27
    v_cvt_pk_bf16_f32 v75, v24, v25
    v_smfmac_f32_16x16x64_bf16 v[28:31], v[40:43], v[176:183], v1
    s_nop 0
    v_mfma_f32_16x16x16_bf16 v[20:23], v[74:75], v[4:5], 0
    v_cvt_pk_bf16_f32 v12, v12, v16
    v_cvt_pk_bf16_f32 v13, v13, v17
    v_mfma_f32_16x16x16_bf16 v[24:27], v[74:75], v[6:7], 0
    v_cvt_pk_bf16_f32 v14, v14, v18
    v_cvt_pk_bf16_f32 v15, v15, v19
    s_nop 1
    v_mfma_f32_16x16x32_bf16 v[16:19], v[64:67], v[12:15], 0
    s_nop 2
    v_cvt_pk_bf16_f32 v20, v20, v24
    v_cvt_pk_bf16_f32 v21, v21, v25
    v_mfma_f32_16x16x32_bf16 v[76:79], v[68:71], v[12:15], 0
    v_cvt_pk_bf16_f32 v22, v22, v26
    v_cvt_pk_bf16_f32 v23, v23, v27
    v_smfmac_f32_16x16x64_bf16 v[32:35], v[40:43], v[184:191], v1
    ds_read_b128 v[40:43], v0 offset:5120
    v_mfma_f32_16x16x32_bf16 v[24:27], v[20:23], v[12:15], 0
    v_cndmask_b32 v16, v16, v76, s[52:53]
    v_cndmask_b32 v17, v17, v77, s[52:53]
    v_cndmask_b32 v18, v18, v78, s[52:53]
    v_cndmask_b32 v19, v19, v79, s[52:53]
    ds_write_b128 v3, v[16:19] offset:10240
    v_smfmac_f32_16x16x64_bf16 v[28:31], v[44:47], v[192:199], v1
    s_nop 1
    v_cndmask_b32 v24, v24, v25, s[52:53]
    ds_write_b32 v10, v24 offset:14336
    v_smfmac_f32_16x16x64_bf16 v[32:35], v[44:47], v[200:207], v1
    ds_read_b128 v[44:47], v0 offset:6144
    buffer_store_dwordx4 v[20:23], v0, s[12:15], s44 offen sc1
    v_smfmac_f32_16x16x64_bf16 v[28:31], v[36:39], v[208:215], v1
    s_waitcnt lgkmcnt(1)
    s_barrier
    ds_read_b128 v[12:15], v0 offset:10240
    ds_read_b128 v[16:19], v0 offset:11264
    ds_read_b128 v[20:23], v0 offset:12288
    ds_read_b128 v[24:27], v0 offset:13312
    ds_read_b128 v[76:79], v0 offset:14336
    v_smfmac_f32_16x16x64_bf16 v[32:35], v[36:39], v[216:223], v1
    v_smfmac_f32_16x16x64_bf16 v[28:31], v[40:43], v[144:151], v1
    v_smfmac_f32_16x16x64_bf16 v[32:35], v[40:43], v[152:159], v1
    s_waitcnt lgkmcnt(5)
    v_smfmac_f32_16x16x64_bf16 v[28:31], v[44:47], v[160:167], v1
    v_smfmac_f32_16x16x64_bf16 v[32:35], v[44:47], v[168:175], v1
    ds_read_b128 v[64:67], v2 offset:22528
    ds_read_b128 v[68:71], v2 offset:23552
    v_lshrrev_b32 v38, 1, v3
    s_cmp_ge_u32 s32, 63
    s_waitcnt lgkmcnt(5)
    v_add_f32 v12, v12, v16
    v_add_f32 v13, v13, v17
    v_add_f32 v14, v14, v18
    v_add_f32 v15, v15, v19
    s_waitcnt lgkmcnt(3)
    v_pk_add_f32 v[20:21], v[20:21], v[24:25]
    v_pk_add_f32 v[22:23], v[22:23], v[26:27]
    s_waitcnt lgkmcnt(2)
    v_pk_add_f32 v[76:77], v[76:77], v[78:79]
    v_pk_add_f32 v[12:13], v[12:13], v[20:21]
    v_pk_add_f32 v[14:15], v[14:15], v[22:23]
    v_add_f32_e64 v16, v76, v77
    v_max3_f32 v17, v12, v13, v14
    v_max3_f32 v17, v17, v15, v16
    v_pk_add_f32 v[28:29], v[28:29], v[30:31]
    v_pk_add_f32 v[32:33], v[32:33], v[34:35]
    v_max_f32_dpp v17, v17, v17 quad_perm:[2,3,0,1] row_mask:0xf bank_mask:0xf
    v_mov_b32 v18, v17
    v_cvt_pk_bf16_f32 v36, v28, v29
    v_cvt_pk_bf16_f32 v37, v32, v33
    v_permlane16_swap_b32 v17, v18
    v_max_f32 v17, v17, v18
    v_mov_b32 v18, v17
    buffer_store_dwordx2 v[36:37], v38, s[12:15], s45 offen sc1
    s_cbranch_scc1 LC_done
    v_permlane32_swap_b32 v17, v18
    v_max_f32 v17, v17, v18
    v_mul_f32 v17, s54, v17
    v_fma_f32 v12, v12, s54, -v17
    v_fma_f32 v13, v13, s54, -v17
    v_fma_f32 v14, v14, s54, -v17
    v_fma_f32 v15, v15, s54, -v17
    v_fma_f32 v16, v16, s54, -v17
    v_exp_f32 v12, v12
    v_exp_f32 v13, v13
    v_exp_f32 v14, v14
    v_exp_f32 v15, v15
    v_exp_f32_e64 v16, v16
    v_cvt_pk_bf16_f32 v76, v12, v13
    v_cvt_pk_bf16_f32 v77, v14, v15
    v_mov_b32_dpp v78, v16 quad_perm:[0,1,0,1] row_mask:0xf bank_mask:0xf
    v_mov_b32_dpp v79, v16 quad_perm:[2,3,2,3] row_mask:0xf bank_mask:0xf
    v_mov_b32_dpp v20, v76 quad_perm:[0,1,0,1] row_mask:0xf bank_mask:0xf
    v_mov_b32_dpp v21, v77 quad_perm:[0,1,0,1] row_mask:0xf bank_mask:0xf
    v_mov_b32_dpp v22, v76 quad_perm:[2,3,2,3] row_mask:0xf bank_mask:0xf
    v_mov_b32_dpp v23, v77 quad_perm:[2,3,2,3] row_mask:0xf bank_mask:0xf
    v_add_f32 v12, v12, v13
    v_add_f32 v14, v14, v15
    v_mfma_f32_16x16x32_bf16 v[28:31], v[48:51], v[20:23], 0
    v_cvt_pk_bf16_f32 v24, v78, v79
    v_mov_b32 v25, 0
    v_mfma_f32_16x16x32_bf16 v[32:35], v[52:55], v[20:23], 0
    v_add_f32 v12, v12, v16
    v_add_f32 v17, v12, v14
    v_mfma_f32_16x16x16_bf16 v[28:31], v[36:37], v[24:25], v[28:31]
    v_cvt_pk_bf16_f32 v27, v78, v79
    v_mov_b32 v26, 0
    v_add_f32_dpp v17, v17, v17 quad_perm:[2,3,0,1] row_mask:0xf bank_mask:0xf
    v_mov_b32 v18, v17
    v_mfma_f32_16x16x16_bf16 v[32:35], v[36:37], v[26:27], v[32:35]
    ds_read_b128 v[48:51], v2 offset:24576
    v_permlane16_swap_b32 v17, v18
    v_add_f32 v17, v17, v18
    v_mov_b32 v18, v17
    ds_read_b128 v[52:55], v2 offset:25600
    ds_read_b128 v[72:75], v2 offset:26624
    v_permlane32_swap_b32 v17, v18
    v_add_f32 v17, v17, v18
    v_rcp_f32_e64 v19, v17
    v_cndmask_b32 v28, v28, v32, s[52:53]
    v_cndmask_b32 v29, v29, v33, s[52:53]
    v_cndmask_b32 v30, v30, v34, s[52:53]
    v_cndmask_b32 v31, v31, v35, s[52:53]
    v_pk_mul_f32 v[28:29], v[28:29], v[18:19] op_sel:[0,1] op_sel_hi:[1,1]
    v_pk_mul_f32 v[30:31], v[30:31], v[18:19] op_sel:[0,1] op_sel_hi:[1,1]
    v_cvt_pk_bf16_f32 v44, v28, v29
    v_cvt_pk_bf16_f32 v45, v30, v31
    ds_write_b64 v9, v[44:45] offset:0
    ds_read_b128 v[76:79], v2 offset:27648
    v_mov_b64 v[12:13], 0
    v_mov_b64 v[14:15], 0
    v_mov_b64 v[16:17], 0
    v_mov_b64 v[18:19], 0
    v_mov_b64 v[20:21], 0
    v_mov_b64 v[22:23], 0
    s_waitcnt lgkmcnt(1)
    s_barrier
    ds_read_b128 v[36:39], v0 offset:0
    ds_read_b128 v[40:43], v0 offset:1024
    v_mov_b64 v[24:25], 0
    s_nop 1
    v_mov_b64 v[26:27], 0
    s_nop 1
    v_mov_b64 v[28:29], 0
    s_nop 1
    v_mov_b64 v[30:31], 0
    s_nop 1
    s_waitcnt lgkmcnt(1)
    v_smfmac_f32_16x16x64_bf16 v[12:15], v[36:39], v[56:63], v1
    ds_read_b128 v[56:59], v2 offset:28672
    v_smfmac_f32_16x16x64_bf16 v[16:19], v[36:39], v[224:231], v1
    ds_read_b128 v[60:63], v2 offset:29696
    s_waitcnt lgkmcnt(2)
    v_smfmac_f32_16x16x64_bf16 v[12:15], v[40:43], v[64:71], v1
    ds_read_b128 v[64:67], v2 offset:30720
    v_smfmac_f32_16x16x64_bf16 v[16:19], v[40:43], v[232:239], v1
    ds_read_b128 v[68:71], v2 offset:31744
    v_smfmac_f32_16x16x64_bf16 v[20:23], v[36:39], v[240:247], v1
    v_add_f32 v12, v12, v14
    v_add_f32 v13, v13, v15
    v_smfmac_f32_16x16x64_bf16 v[20:23], v[40:43], v[248:255], v1
    v_cvt_pk_bf16_f32 v44, v12, v13
    v_add_f32 v16, v16, v18
    v_smfmac_f32_16x16x64_bf16 v[24:27], v[36:39], v[48:55], v1
    buffer_store_dword v44, v8, s[12:15], s20 offen
    v_add_f32 v17, v17, v19
    v_cvt_pk_bf16_f32 v45, v16, v17
    v_smfmac_f32_16x16x64_bf16 v[24:27], v[40:43], v[72:79], v1
    buffer_store_dword v45, v8, s[12:15], s21 offen
    v_add_f32 v20, v20, v22
    s_waitcnt lgkmcnt(2)
    v_smfmac_f32_16x16x64_bf16 v[28:31], v[36:39], v[56:63], v1
    v_add_f32 v21, v21, v23
    v_cvt_pk_bf16_f32 v46, v20, v21
    s_waitcnt lgkmcnt(0)
    v_smfmac_f32_16x16x64_bf16 v[28:31], v[40:43], v[64:71], v1
    buffer_store_dword v46, v8, s[12:15], s22 offen
    v_add_f32 v24, v24, v26
    v_add_f32 v25, v25, v27
    v_cvt_pk_bf16_f32 v47, v24, v25
    buffer_store_dword v47, v8, s[12:15], s23 offen
    s_nop 2
    v_pk_add_f32 v[28:29], v[28:29], v[30:31]
    v_cvt_pk_bf16_f32 v44, v28, v29
    buffer_store_dword v44, v8, s[12:15], s24 offen
    s_waitcnt vmcnt(10)
    v_mov_b64 v[64:65], v[80:81]
    v_mov_b64 v[66:67], v[82:83]
    s_waitcnt vmcnt(9)
    v_mov_b64 v[68:69], v[84:85]
    v_mov_b64 v[70:71], v[86:87]
    s_waitcnt vmcnt(8)
    v_mov_b64 v[48:49], v[88:89]
    v_mov_b64 v[50:51], v[90:91]
    s_waitcnt vmcnt(7)
    v_mov_b64 v[52:53], v[92:93]
    v_mov_b64 v[54:55], v[94:95]
    s_cmp_eq_u32 s57, 0
    s_cbranch_scc1 LF_nored
    s_nop 3
    s_nop 3
    buffer_load_dwordx4 v[80:83], v0, s[12:15], s92 offen offset:0 sc1
    buffer_load_dwordx4 v[84:87], v0, s[12:15], s92 offen offset:1024 sc1
    buffer_load_dwordx4 v[88:91], v0, s[12:15], s92 offen offset:2048 sc1
    buffer_load_dwordx4 v[92:95], v0, s[12:15], s92 offen offset:3072 sc1
    v_bfe_u32 v44, v0, 6, 1
    v_lshlrev_b32 v44, 4, v44
    v_mov_b32 v45, 0x3f80
    v_lshlrev_b32 v45, v44, v45
    v_bfe_u32 v44, v0, 4, 2
    v_cmp_eq_u32 vcc, 0, v44
    v_mov_b64 v[12:13], 0
    v_mov_b64 v[14:15], 0
    v_cndmask_b32 v32, 0, v45, vcc
    v_cmp_eq_u32 vcc, 1, v44
    v_mov_b64 v[16:17], 0
    v_mov_b64 v[18:19], 0
    v_cndmask_b32 v33, 0, v45, vcc
    v_cmp_eq_u32 vcc, 2, v44
    v_mov_b64 v[20:21], 0
    v_mov_b64 v[22:23], 0
    v_cndmask_b32 v34, 0, v45, vcc
    v_cmp_eq_u32 vcc, 3, v44
    v_mov_b64 v[24:25], 0
    v_mov_b64 v[26:27], 0
    v_cndmask_b32 v35, 0, v45, vcc
    v_mov_b64 v[28:29], 0
    v_mov_b64 v[30:31], 0
    v_mov_b32 v36, -1
    v_mov_b32 v37, -1
    v_mov_b32 v38, -1
    v_mov_b32_e64 v39, -1
    ds_read_b128 v[56:59], v2 offset:32768
    ds_read_b128 v[60:63], v2 offset:33792
    ds_read_b128 v[72:75], v2 offset:34816
    ds_read_b128 v[76:79], v2 offset:35840
LF_p1:
    buffer_load_dwordx4 v[80:83], v0, s[12:15], s92 offen offset:0 sc1
    buffer_load_dwordx4 v[84:87], v0, s[12:15], s92 offen offset:1024 sc1
    buffer_load_dwordx4 v[88:91], v0, s[12:15], s92 offen offset:2048 sc1
    buffer_load_dwordx4 v[92:95], v0, s[12:15], s92 offen offset:3072 sc1
    s_mov_b64 exec, -1
    s_waitcnt vmcnt(7)
    v_max3_u32 v44, v80, v81, v82
    v_max_u32 v44, v44, v83
    v_mfma_f32_16x16x32_bf16 v[40:43], v[32:35], v[80:83], 0
    s_waitcnt vmcnt(6)
    v_max3_u32 v44, v44, v84, v85
    v_max3_u32 v44, v44, v86, v87
    v_mfma_f32_16x16x32_bf16 v[40:43], v[32:35], v[84:87], v[40:43]
    s_waitcnt vmcnt(5)
    v_max3_u32 v44, v44, v88, v89
    v_max3_u32 v44, v44, v90, v91
    v_mfma_f32_16x16x32_bf16 v[40:43], v[32:35], v[88:91], v[40:43]
    s_waitcnt vmcnt(4)
    v_max3_u32 v44, v44, v92, v93
    v_max3_u32 v44, v44, v94, v95
    v_mfma_f32_16x16x32_bf16 v[40:43], v[32:35], v[92:95], v[40:43]
    v_cmp_eq_u32 vcc, -1, v44
    s_nop 0
    s_cbranch_vccz LF_p1ok
    s_mov_b64 exec, vcc
    s_add_u32 s88, s88, 1
    s_cmp_gt_u32 s88, 4000000
    s_cbranch_scc0 LF_p1
    s_branch LC_fail
LF_p1ok:
    s_nop 4
    v_add_f32_dpp v40, v40, v40 row_ror:8 row_mask:0xf bank_mask:0xf
    v_add_f32_dpp v41, v41, v41 row_ror:8 row_mask:0xf bank_mask:0xf
    v_add_f32_dpp v42, v42, v42 row_ror:8 row_mask:0xf bank_mask:0xf
    v_add_f32_dpp v43, v43, v43 row_ror:8 row_mask:0xf bank_mask:0xf
    v_cvt_pk_bf16_f32 v44, v40, v41
    v_cvt_pk_bf16_f32 v45, v42, v43
    s_mov_b64 exec, 0x00ff00ff
    buffer_store_dwordx2 v[44:45], v11, s[12:15], s46 offen
    buffer_store_dwordx2 v[44:45], v11, s[12:15], s51 offen sc1
    s_mov_b64 exec, -1
    s_barrier
    v_mov_b64 v[32:33], 0
    v_mov_b64 v[34:35], 0
    s_waitcnt vmcnt(4)
    v_lshrrev_b32 v86, 2, v3
    s_nop 3
    s_nop 3
    s_nop 3
    buffer_load_dwordx4 v[88:91], v3, s[12:15], s47 offen sc1
    buffer_load_dword v92, v86, s[12:15], s98 offen sc1
    s_add_u32 s32, s32, 1
    s_add_u32 s84, s84, 262144
    s_add_u32 s40, s84, 262144
    s_min_u32 s40, s40, 16515072
    s_add_u32 s41, s61, s40
    s_add_u32 s42, s41, 4096
    s_add_u32 s43, s62, s40
    s_and_b32 s85, s32, 1
    s_mul_i32 s85, s85, 163840
    s_add_u32 s44, s63, s84
    s_add_u32 s45, s64, s84
    s_add_u32 s20, s58, s85
    s_add_u32 s21, s20, 32768
    s_add_u32 s22, s20, 65536
    s_add_u32 s23, s20, 98304
    s_add_u32 s24, s20, 131072
    s_nop 3
    s_nop 3
    buffer_load_dwordx4 v[88:91], v3, s[12:15], s47 offen sc1
    buffer_load_dword v92, v86, s[12:15], s98 offen sc1
    s_nop 3
    s_nop 3
    s_nop 3
    s_nop 3
    s_nop 3
    s_nop 3
    buffer_load_dwordx4 v[88:91], v3, s[12:15], s47 offen sc1
    buffer_load_dword v92, v86, s[12:15], s98 offen sc1
    s_mov_b64 exec, 0xff
    buffer_store_dwordx4 v[36:39], v0, s[12:15], s96 offen
    s_mov_b64 exec, -1
    buffer_store_dwordx4 v[36:39], v0, s[12:15], s92 offen offset:0
    buffer_store_dwordx4 v[36:39], v0, s[12:15], s92 offen offset:1024
    buffer_store_dwordx4 v[36:39], v0, s[12:15], s92 offen offset:2048
    buffer_store_dwordx4 v[36:39], v0, s[12:15], s92 offen offset:3072
    s_add_u32 s92, s55, s85
    s_add_u32 s96, s32, 3
    s_and_b32 s96, s96, 3
    s_mul_i32 s96, s96, 5120
    s_add_u32 s96, s96, s56
    s_waitcnt vmcnt(9)
    v_max3_u32 v44, v88, v89, v90
    v_max3_u32 v44, v44, v91, v92
    v_cmp_eq_u32 vcc, -1, v44
    s_nop 0
    s_cbranch_vccz LF_stage
    s_waitcnt vmcnt(7)
    v_max3_u32 v44, v88, v89, v90
    v_max3_u32 v44, v44, v91, v92
    v_cmp_eq_u32 vcc, -1, v44
    s_nop 0
    s_cbranch_vccz LF_stage
    s_waitcnt vmcnt(5)
    v_max3_u32 v44, v88, v89, v90
    v_max3_u32 v44, v44, v91, v92
    v_cmp_eq_u32 vcc, -1, v44
    s_nop 0
    s_cbranch_vccz LF_stage
    s_branch LF_p2r
LF_nored:
    v_mov_b64 v[12:13], 0
    v_mov_b64 v[14:15], 0
    v_mov_b64 v[16:17], 0
    v_mov_b64 v[18:19], 0
    v_mov_b64 v[20:21], 0
    v_mov_b64 v[22:23], 0
    v_mov_b64 v[24:25], 0
    v_mov_b64 v[26:27], 0
    v_mov_b64 v[28:29], 0
    v_mov_b64 v[30:31], 0
    v_mov_b64 v[32:33], 0
    v_mov_b64 v[34:35], 0
    ds_read_b128 v[56:59], v2 offset:32768
    ds_read_b128 v[60:63], v2 offset:33792
    ds_read_b128 v[72:75], v2 offset:34816
    ds_read_b128 v[76:79], v2 offset:35840
    v_lshrrev_b32 v86, 2, v3
    s_add_u32 s49, s32, 2
    s_min_u32 s49, s49, 63
    s_cmp_gt_u32 s50, s49
    s_cbranch_scc1 LF_nokv
    v_lshrrev_b32 v36, 2, v0
    v_min_u32 v36, 12, v36
    s_mov_b32 s34, 0
LF_kvw:
    buffer_load_dword v37, v36, s[8:11], 0 offen offset:64 sc1
    s_add_u32 s34, s34, 1
    s_cmp_gt_u32 s34, 2000000
    s_cbranch_scc1 LC_fail
    s_waitcnt vmcnt(0)
    v_cmp_gt_u32 vcc, 192, v37
    s_nop 0
    s_ff1_i32_b64 s35, vcc
    s_lshl_b32 s35, s35, 3
    s_lshr_b32 s50, 0x40120600, s35
    s_and_b32 s50, s50, 255
    s_cmp_gt_u32 s50, s49
    s_cbranch_scc1 LF_kvw_ok
    s_sleep 8
    s_branch LF_kvw
LF_kvw_ok:
LF_nokv:
    s_barrier
    s_nop 3
    s_nop 3
    s_nop 3
    s_nop 3
    buffer_load_dwordx4 v[88:91], v3, s[12:15], s47 offen sc1
    buffer_load_dword v92, v86, s[12:15], s98 offen sc1
    s_add_u32 s32, s32, 1
    s_add_u32 s84, s84, 262144
    s_add_u32 s40, s84, 262144
    s_min_u32 s40, s40, 16515072
    s_add_u32 s41, s61, s40
    s_add_u32 s42, s41, 4096
    s_add_u32 s43, s62, s40
    s_and_b32 s85, s32, 1
    s_mul_i32 s85, s85, 163840
    s_add_u32 s44, s63, s84
    s_add_u32 s45, s64, s84
    s_add_u32 s20, s58, s85
    s_add_u32 s21, s20, 32768
    s_add_u32 s22, s20, 65536
    s_add_u32 s23, s20, 98304
    s_add_u32 s24, s20, 131072
    s_nop 3
    s_nop 3
    buffer_load_dwordx4 v[88:91], v3, s[12:15], s47 offen sc1
    buffer_load_dword v92, v86, s[12:15], s98 offen sc1
    s_nop 3
    s_nop 3
    s_nop 3
    s_nop 3
    s_nop 3
    s_nop 3
    buffer_load_dwordx4 v[88:91], v3, s[12:15], s47 offen sc1
    buffer_load_dword v92, v86, s[12:15], s98 offen sc1
    s_waitcnt vmcnt(4)
    v_max3_u32 v44, v88, v89, v90
    v_max3_u32 v44, v44, v91, v92
    v_cmp_eq_u32 vcc, -1, v44
    s_nop 0
    s_cbranch_vccz LF_stage
    s_waitcnt vmcnt(2)
    v_max3_u32 v44, v88, v89, v90
    v_max3_u32 v44, v44, v91, v92
    v_cmp_eq_u32 vcc, -1, v44
    s_nop 0
    s_cbranch_vccz LF_stage
LF_p2:
    s_waitcnt vmcnt(0)
    v_max3_u32 v44, v88, v89, v90
    v_max3_u32 v44, v44, v91, v92
    v_cmp_eq_u32 vcc, -1, v44
    s_nop 0
    s_cbranch_vccz LF_stage
LF_p2r:
    s_mov_b64 exec, vcc
    buffer_load_dwordx4 v[88:91], v3, s[12:15], s47 offen sc1
    buffer_load_dword v92, v86, s[12:15], s98 offen sc1
    s_mov_b64 exec, -1
    s_add_u32 s89, s89, 1
    s_cmp_gt_u32 s89, 4000000
    s_cbranch_scc0 LF_p2
    s_branch LC_fail
LF_rretry:
    s_mov_b64 exec, vcc
    buffer_load_dwordx4 v[80:83], v3, s[12:15], s48 offen sc1
    buffer_load_dword v84, v86, s[12:15], s99 offen sc1
    s_mov_b64 exec, -1
    s_add_u32 s65, s65, 1
    s_cmp_gt_u32 s65, 4000000
    s_cbranch_scc1 LC_fail
LF_rchk:
    s_waitcnt vmcnt(1)
    v_max3_u32 v85, v80, v81, v82
    s_waitcnt vmcnt(0)
    v_max3_u32 v85, v85, v83, v84
    ds_write_b128 v3, v[80:83] offset:5120
    ds_write_b32 v86, v84 offset:9216
    v_cmp_eq_u32 vcc, -1, v85
    s_nop 0
    s_cbranch_vccnz LF_rretry
    s_branch LF_rok
    s_branch LS_step
LS_stage:
    ds_write_b128 v3, v[88:91] offset:0
    ds_write_b32 v86, v92 offset:4096
LS_step:
    s_waitcnt lgkmcnt(0)
    s_barrier
    ds_read_b128 v[36:39], v0 offset:0
    buffer_load_dwordx4 v[80:83], v3, s[12:15], s48 offen sc1
    buffer_load_dword v84, v86, s[12:15], s99 offen sc1
    s_waitcnt lgkmcnt(0)
    v_smfmac_f32_16x16x64_bf16 v[12:15], v[36:39], v[56:63], v1
    ds_read_b128 v[40:43], v0 offset:1024
    v_smfmac_f32_16x16x64_bf16 v[16:19], v[36:39], v[72:79], v1
    ds_read_b128 v[44:47], v0 offset:2048
    v_smfmac_f32_16x16x64_bf16 v[20:23], v[36:39], a[112:119], v1
    ds_read_b128 v[56:59], v2 offset:0
    v_smfmac_f32_16x16x64_bf16 v[24:27], v[36:39], a[120:127], v1
    ds_read_b128 v[60:63], v2 offset:1024
    v_smfmac_f32_16x16x64_bf16 v[28:31], v[36:39], a[240:247], v1
    ds_read_b128 v[72:75], v2 offset:2048
    v_smfmac_f32_16x16x64_bf16 v[32:35], v[36:39], a[248:255], v1
    ds_read_b128 v[76:79], v2 offset:3072
    s_waitcnt lgkmcnt(5)
    v_smfmac_f32_16x16x64_bf16 v[12:15], v[40:43], a[0:7], v1
    ds_read_b128 v[36:39], v0 offset:3072
    v_smfmac_f32_16x16x64_bf16 v[16:19], v[40:43], a[8:15], v1
    s_waitcnt lgkmcnt(3)
    v_smfmac_f32_16x16x64_bf16 v[20:23], v[40:43], v[56:63], v1
    ds_read_b128 v[56:59], v2 offset:4096
    s_waitcnt lgkmcnt(2)
    v_smfmac_f32_16x16x64_bf16 v[24:27], v[40:43], v[72:79], v1
    ds_read_b128 v[60:63], v2 offset:5120
    v_smfmac_f32_16x16x64_bf16 v[28:31], v[40:43], v[96:103], v1
    ds_read_b128 v[72:75], v2 offset:6144
    v_smfmac_f32_16x16x64_bf16 v[32:35], v[40:43], v[104:111], v1
    ds_read_b128 v[76:79], v2 offset:7168
    v_smfmac_f32_16x16x64_bf16 v[12:15], v[44:47], a[16:23], v1
    ds_read_b128 v[40:43], v0 offset:4096
    v_mov_b32 v87, s32
    v_smfmac_f32_16x16x64_bf16 v[16:19], v[44:47], a[24:31], v1
    s_mov_b64 exec, 1
    buffer_store_dword v87, v0, s[12:15], s93 offen sc1
    s_mov_b64 exec, -1
    v_smfmac_f32_16x16x64_bf16 v[20:23], v[44:47], a[128:135], v1
    v_smfmac_f32_16x16x64_bf16 v[24:27], v[44:47], a[136:143], v1
    s_waitcnt lgkmcnt(3)
    v_smfmac_f32_16x16x64_bf16 v[28:31], v[44:47], v[56:63], v1
    ds_read_b128 v[56:59], v2 offset:8192
    s_waitcnt lgkmcnt(2)
    v_smfmac_f32_16x16x64_bf16 v[32:35], v[44:47], v[72:79], v1
    ds_read_b128 v[60:63], v2 offset:9216
    v_smfmac_f32_16x16x64_bf16 v[12:15], v[36:39], a[32:39], v1
    ds_read_b128 v[72:75], v2 offset:10240
    v_smfmac_f32_16x16x64_bf16 v[16:19], v[36:39], a[40:47], v1
    ds_read_b128 v[76:79], v2 offset:11264
    v_smfmac_f32_16x16x64_bf16 v[20:23], v[36:39], a[144:151], v1
    s_waitcnt vmcnt(1)
    v_max3_u32 v85, v80, v81, v82
    v_smfmac_f32_16x16x64_bf16 v[24:27], v[36:39], a[152:159], v1
    v_max3_u32 v85, v85, v83, v84
    v_cmp_eq_u32 vcc, -1, v85
    ds_write_b128 v3, v[80:83] offset:5120
    v_smfmac_f32_16x16x64_bf16 v[28:31], v[36:39], v[112:119], v1
    ds_write_b32 v86, v84 offset:9216
    v_smfmac_f32_16x16x64_bf16 v[32:35], v[36:39], v[120:127], v1
    s_cbranch_vccnz LS_rchk
LS_rok:
    s_waitcnt lgkmcnt(4)
    v_smfmac_f32_16x16x64_bf16 v[12:15], v[40:43], v[56:63], v1
    ds_read_b128 v[56:59], v2 offset:12288
    s_waitcnt lgkmcnt(3)
    v_smfmac_f32_16x16x64_bf16 v[16:19], v[40:43], v[72:79], v1
    ds_read_b128 v[60:63], v2 offset:13312
    s_waitcnt lgkmcnt(2)
    s_barrier
    ds_read_b128 v[44:47], v0 offset:5120
    ds_read_b128 v[36:39], v0 offset:6144
    v_smfmac_f32_16x16x64_bf16 v[20:23], v[40:43], a[160:167], v1
    ds_read_b128 v[72:75], v2 offset:14336
    v_smfmac_f32_16x16x64_bf16 v[24:27], v[40:43], a[168:175], v1
    ds_read_b128 v[76:79], v2 offset:15360
    v_smfmac_f32_16x16x64_bf16 v[28:31], v[40:43], v[128:135], v1
    v_smfmac_f32_16x16x64_bf16 v[32:35], v[40:43], v[136:143], v1
    s_waitcnt lgkmcnt(3)
    v_smfmac_f32_16x16x64_bf16 v[12:15], v[44:47], a[48:55], v1
    ds_read_b128 v[40:43], v0 offset:7168
    buffer_load_dwordx4 v[80:83], v0, s[12:15], s41 offen sc1
    v_smfmac_f32_16x16x64_bf16 v[16:19], v[44:47], a[56:63], v1
    s_add_u32 s97, s32, 1
    s_lshl_b32 s48, s97, 15
    v_smfmac_f32_16x16x64_bf16 v[20:23], v[44:47], v[56:63], v1
    ds_read_b128 v[56:59], v2 offset:16384
    s_waitcnt lgkmcnt(2)
    v_smfmac_f32_16x16x64_bf16 v[24:27], v[44:47], v[72:79], v1
    ds_read_b128 v[60:63], v2 offset:17408
    buffer_load_dwordx4 v[84:87], v0, s[12:15], s42 offen sc1
    v_smfmac_f32_16x16x64_bf16 v[12:15], v[36:39], a[64:71], v1
    ds_read_b128 v[44:47], v0 offset:8192
    s_and_b32 s97, s97, 3
    v_smfmac_f32_16x16x64_bf16 v[16:19], v[36:39], a[72:79], v1
    ds_read_b128 v[72:75], v2 offset:18432
    v_smfmac_f32_16x16x64_bf16 v[20:23], v[36:39], a[176:183], v1
    ds_read_b128 v[76:79], v2 offset:19456
    buffer_load_dwordx4 v[88:91], v0, s[12:15], s43 offen sc1
    v_smfmac_f32_16x16x64_bf16 v[24:27], v[36:39], a[184:191], v1
    s_add_u32 s51, s48, s91
    s_add_u32 s48, s48, s60
    s_waitcnt lgkmcnt(5)
    v_smfmac_f32_16x16x64_bf16 v[12:15], v[40:43], a[80:87], v1
    ds_read_b128 v[36:39], v0 offset:9216
    s_mul_i32 s97, s97, 5120
    v_smfmac_f32_16x16x64_bf16 v[16:19], v[40:43], a[88:95], v1
    buffer_load_dwordx4 v[92:95], v0, s[12:15], s43 offen offset:1024 sc1
    s_waitcnt lgkmcnt(3)
    v_smfmac_f32_16x16x64_bf16 v[12:15], v[44:47], v[56:63], v1
    ds_read_b128 v[56:59], v2 offset:20480
    s_waitcnt lgkmcnt(2)
    v_smfmac_f32_16x16x64_bf16 v[16:19], v[44:47], v[72:79], v1
    ds_read_b128 v[60:63], v2 offset:21504
    s_waitcnt lgkmcnt(2)
    v_smfmac_f32_16x16x64_bf16 v[12:15], v[36:39], a[96:103], v1
    s_add_u32 s46, s97, s56
    s_add_u32 s47, s97, s59
    v_smfmac_f32_16x16x64_bf16 v[16:19], v[36:39], a[104:111], v1
    s_add_u32 s98, s47, 4096
    s_add_u32 s99, s48, 4096
    v_smfmac_f32_16x16x64_bf16 v[20:23], v[40:43], a[192:199], v1
    v_smfmac_f32_16x16x64_bf16 v[24:27], v[40:43], a[200:207], v1
    v_smfmac_f32_16x16x64_bf16 v[20:23], v[44:47], a[208:215], v1
    v_add_f32 v12, v12, v14
    v_smfmac_f32_16x16x64_bf16 v[20:23], v[36:39], a[224:231], v1
    v_add_f32 v13, v13, v15
    v_add_f32 v16, v16, v18
    v_smfmac_f32_16x16x64_bf16 v[24:27], v[44:47], a[216:223], v1
    v_add_f32 v17, v17, v19
    v_cvt_pk_bf16_f32 v72, v12, v13
    v_cvt_pk_bf16_f32 v73, v16, v17
    v_smfmac_f32_16x16x64_bf16 v[24:27], v[36:39], a[232:239], v1
    s_nop 0
    v_mfma_f32_16x16x16_bf16 v[12:15], v[72:73], v[4:5], 0
    v_add_f32 v20, v20, v22
    v_add_f32 v21, v21, v23
    v_mfma_f32_16x16x16_bf16 v[16:19], v[72:73], v[6:7], 0
    v_cvt_pk_bf16_f32 v74, v20, v21
    v_add_f32 v24, v24, v26
    v_add_f32 v25, v25, v27
    v_cvt_pk_bf16_f32 v75, v24, v25
    v_smfmac_f32_16x16x64_bf16 v[28:31], v[40:43], v[176:183], v1
    s_nop 0
    v_mfma_f32_16x16x16_bf16 v[20:23], v[74:75], v[4:5], 0
    v_cvt_pk_bf16_f32 v12, v12, v16
    v_cvt_pk_bf16_f32 v13, v13, v17
    v_mfma_f32_16x16x16_bf16 v[24:27], v[74:75], v[6:7], 0
    v_cvt_pk_bf16_f32 v14, v14, v18
    v_cvt_pk_bf16_f32 v15, v15, v19
    s_nop 1
    v_mfma_f32_16x16x32_bf16 v[16:19], v[64:67], v[12:15], 0
    s_nop 2
    v_cvt_pk_bf16_f32 v20, v20, v24
    v_cvt_pk_bf16_f32 v21, v21, v25
    v_mfma_f32_16x16x32_bf16 v[76:79], v[68:71], v[12:15], 0
    v_cvt_pk_bf16_f32 v22, v22, v26
    v_cvt_pk_bf16_f32 v23, v23, v27
    v_smfmac_f32_16x16x64_bf16 v[32:35], v[40:43], v[184:191], v1
    ds_read_b128 v[40:43], v0 offset:5120
    v_mfma_f32_16x16x32_bf16 v[24:27], v[20:23], v[12:15], 0
    v_cndmask_b32 v16, v16, v76, s[52:53]
    v_cndmask_b32 v17, v17, v77, s[52:53]
    v_cndmask_b32 v18, v18, v78, s[52:53]
    v_cndmask_b32 v19, v19, v79, s[52:53]
    ds_write_b128 v3, v[16:19] offset:10240
    v_smfmac_f32_16x16x64_bf16 v[28:31], v[44:47], v[192:199], v1
    s_nop 1
    v_cndmask_b32 v24, v24, v25, s[52:53]
    ds_write_b32 v10, v24 offset:14336
    v_smfmac_f32_16x16x64_bf16 v[32:35], v[44:47], v[200:207], v1
    ds_read_b128 v[44:47], v0 offset:6144
    buffer_store_dwordx4 v[20:23], v0, s[12:15], s44 offen sc1
    v_smfmac_f32_16x16x64_bf16 v[28:31], v[36:39], v[208:215], v1
    s_waitcnt lgkmcnt(1)
    s_barrier
    ds_read_b128 v[12:15], v0 offset:10240
    ds_read_b128 v[16:19], v0 offset:11264
    ds_read_b128 v[20:23], v0 offset:12288
    ds_read_b128 v[24:27], v0 offset:13312
    ds_read_b128 v[76:79], v0 offset:14336
    v_smfmac_f32_16x16x64_bf16 v[32:35], v[36:39], v[216:223], v1
    v_smfmac_f32_16x16x64_bf16 v[28:31], v[40:43], v[144:151], v1
    v_smfmac_f32_16x16x64_bf16 v[32:35], v[40:43], v[152:159], v1
    s_waitcnt lgkmcnt(5)
    v_smfmac_f32_16x16x64_bf16 v[28:31], v[44:47], v[160:167], v1
    v_smfmac_f32_16x16x64_bf16 v[32:35], v[44:47], v[168:175], v1
    ds_read_b128 v[64:67], v2 offset:22528
    ds_read_b128 v[68:71], v2 offset:23552
    v_lshrrev_b32 v38, 1, v3
    s_cmp_ge_u32 s32, 63
    s_waitcnt lgkmcnt(5)
    v_add_f32 v12, v12, v16
    v_add_f32 v13, v13, v17
    v_add_f32 v14, v14, v18
    v_add_f32 v15, v15, v19
    s_waitcnt lgkmcnt(3)
    v_pk_add_f32 v[20:21], v[20:21], v[24:25]
    v_pk_add_f32 v[22:23], v[22:23], v[26:27]
    s_waitcnt lgkmcnt(2)
    v_pk_add_f32 v[76:77], v[76:77], v[78:79]
    v_pk_add_f32 v[12:13], v[12:13], v[20:21]
    v_pk_add_f32 v[14:15], v[14:15], v[22:23]
    v_add_f32 v16, v76, v77
    v_max3_f32 v17, v12, v13, v14
    v_max3_f32 v17, v17, v15, v16
    v_pk_add_f32 v[28:29], v[28:29], v[30:31]
    v_pk_add_f32 v[32:33], v[32:33], v[34:35]
    v_max_f32_dpp v17, v17, v17 quad_perm:[2,3,0,1] row_mask:0xf bank_mask:0xf
    v_mov_b32 v18, v17
    v_cvt_pk_bf16_f32 v36, v28, v29
    v_cvt_pk_bf16_f32 v37, v32, v33
    v_permlane16_swap_b32 v17, v18
    v_max_f32 v17, v17, v18
    v_mov_b32 v18, v17
    buffer_store_dwordx2 v[36:37], v38, s[12:15], s45 offen sc1
    s_cbranch_scc1 LC_done
    v_permlane32_swap_b32 v17, v18
    v_max_f32 v17, v17, v18
    v_mul_f32 v17, s54, v17
    v_fma_f32 v12, v12, s54, -v17
    v_fma_f32 v13, v13, s54, -v17
    v_fma_f32 v14, v14, s54, -v17
    v_fma_f32 v15, v15, s54, -v17
    v_fma_f32 v16, v16, s54, -v17
    v_exp_f32 v12, v12
    v_exp_f32 v13, v13
    v_exp_f32 v14, v14
    v_exp_f32 v15, v15
    v_exp_f32 v16, v16
    v_cvt_pk_bf16_f32 v76, v12, v13
    v_cvt_pk_bf16_f32 v77, v14, v15
    v_mov_b32_dpp v78, v16 quad_perm:[0,1,0,1] row_mask:0xf bank_mask:0xf
    v_mov_b32_dpp v79, v16 quad_perm:[2,3,2,3] row_mask:0xf bank_mask:0xf
    v_mov_b32_dpp v20, v76 quad_perm:[0,1,0,1] row_mask:0xf bank_mask:0xf
    v_mov_b32_dpp v21, v77 quad_perm:[0,1,0,1] row_mask:0xf bank_mask:0xf
    v_mov_b32_dpp v22, v76 quad_perm:[2,3,2,3] row_mask:0xf bank_mask:0xf
    v_mov_b32_dpp v23, v77 quad_perm:[2,3,2,3] row_mask:0xf bank_mask:0xf
    v_add_f32 v12, v12, v13
    v_add_f32 v14, v14, v15
    v_mfma_f32_16x16x32_bf16 v[28:31], v[48:51], v[20:23], 0
    v_cvt_pk_bf16_f32 v24, v78, v79
    v_mov_b32 v25, 0
    v_mfma_f32_16x16x32_bf16 v[32:35], v[52:55], v[20:23], 0
    v_add_f32 v12, v12, v16
    v_add_f32 v17, v12, v14
    v_mfma_f32_16x16x16_bf16 v[28:31], v[36:37], v[24:25], v[28:31]
    v_cvt_pk_bf16_f32 v27, v78, v79
    v_mov_b32 v26, 0
    v_add_f32_dpp v17, v17, v17 quad_perm:[2,3,0,1] row_mask:0xf bank_mask:0xf
    v_mov_b32 v18, v17
    v_mfma_f32_16x16x16_bf16 v[32:35], v[36:37], v[26:27], v[32:35]
    ds_read_b128 v[48:51], v2 offset:24576
    v_permlane16_swap_b32 v17, v18
    v_add_f32 v17, v17, v18
    v_mov_b32 v18, v17
    ds_read_b128 v[52:55], v2 offset:25600
    ds_read_b128 v[72:75], v2 offset:26624
    v_permlane32_swap_b32 v17, v18
    v_add_f32 v17, v17, v18
    v_rcp_f32 v19, v17
    v_cndmask_b32 v28, v28, v32, s[52:53]
    v_cndmask_b32 v29, v29, v33, s[52:53]
    v_cndmask_b32 v30, v30, v34, s[52:53]
    v_cndmask_b32 v31, v31, v35, s[52:53]
    v_pk_mul_f32 v[28:29], v[28:29], v[18:19] op_sel:[0,1] op_sel_hi:[1,1]
    v_pk_mul_f32 v[30:31], v[30:31], v[18:19] op_sel:[0,1] op_sel_hi:[1,1]
    v_cvt_pk_bf16_f32 v44, v28, v29
    v_cvt_pk_bf16_f32 v45, v30, v31
    ds_write_b64 v9, v[44:45] offset:0
    ds_read_b128 v[76:79], v2 offset:27648
    v_mov_b64 v[12:13], 0
    v_mov_b64 v[14:15], 0
    v_mov_b64 v[16:17], 0
    v_mov_b64 v[18:19], 0
    v_mov_b64 v[20:21], 0
    v_mov_b64 v[22:23], 0
    s_waitcnt lgkmcnt(1)
    s_barrier
    ds_read_b128 v[36:39], v0 offset:0
    ds_read_b128 v[40:43], v0 offset:1024
    v_mov_b64 v[24:25], 0
    s_nop 1
    v_mov_b64 v[26:27], 0
    s_nop 1
    v_mov_b64 v[28:29], 0
    s_nop 1
    v_mov_b64 v[30:31], 0
    s_nop 1
    s_waitcnt lgkmcnt(1)
    v_smfmac_f32_16x16x64_bf16 v[12:15], v[36:39], v[56:63], v1
    ds_read_b128 v[56:59], v2 offset:28672
    v_smfmac_f32_16x16x64_bf16 v[16:19], v[36:39], v[224:231], v1
    ds_read_b128 v[60:63], v2 offset:29696
    s_waitcnt lgkmcnt(2)
    v_smfmac_f32_16x16x64_bf16 v[12:15], v[40:43], v[64:71], v1
    ds_read_b128 v[64:67], v2 offset:30720
    v_smfmac_f32_16x16x64_bf16 v[16:19], v[40:43], v[232:239], v1
    ds_read_b128 v[68:71], v2 offset:31744
    v_smfmac_f32_16x16x64_bf16 v[20:23], v[36:39], v[240:247], v1
    v_add_f32 v12, v12, v14
    v_add_f32 v13, v13, v15
    v_smfmac_f32_16x16x64_bf16 v[20:23], v[40:43], v[248:255], v1
    v_cvt_pk_bf16_f32 v44, v12, v13
    v_add_f32 v16, v16, v18
    v_smfmac_f32_16x16x64_bf16 v[24:27], v[36:39], v[48:55], v1
    buffer_store_dword v44, v8, s[12:15], s20 offen sc1
    v_add_f32 v17, v17, v19
    v_cvt_pk_bf16_f32 v45, v16, v17
    v_smfmac_f32_16x16x64_bf16 v[24:27], v[40:43], v[72:79], v1
    buffer_store_dword v45, v8, s[12:15], s21 offen sc1
    v_add_f32 v20, v20, v22
    s_waitcnt lgkmcnt(2)
    v_smfmac_f32_16x16x64_bf16 v[28:31], v[36:39], v[56:63], v1
    v_add_f32 v21, v21, v23
    v_cvt_pk_bf16_f32 v46, v20, v21
    s_waitcnt lgkmcnt(0)
    v_smfmac_f32_16x16x64_bf16 v[28:31], v[40:43], v[64:71], v1
    buffer_store_dword v46, v8, s[12:15], s22 offen sc1
    v_add_f32 v24, v24, v26
    v_add_f32 v25, v25, v27
    v_cvt_pk_bf16_f32 v47, v24, v25
    buffer_store_dword v47, v8, s[12:15], s23 offen sc1
    s_nop 2
    v_pk_add_f32 v[28:29], v[28:29], v[30:31]
    v_cvt_pk_bf16_f32 v44, v28, v29
    buffer_store_dword v44, v8, s[12:15], s24 offen sc1
    s_waitcnt vmcnt(10)
    v_mov_b64 v[64:65], v[80:81]
    v_mov_b64 v[66:67], v[82:83]
    s_waitcnt vmcnt(9)
    v_mov_b64 v[68:69], v[84:85]
    v_mov_b64 v[70:71], v[86:87]
    s_waitcnt vmcnt(8)
    v_mov_b64 v[48:49], v[88:89]
    v_mov_b64 v[50:51], v[90:91]
    s_waitcnt vmcnt(7)
    v_mov_b64 v[52:53], v[92:93]
    v_mov_b64 v[54:55], v[94:95]
    s_cmp_eq_u32 s57, 0
    s_cbranch_scc1 LS_nored
    s_nop 3
    s_nop 3
    buffer_load_dwordx4 v[80:83], v0, s[12:15], s92 offen offset:0 sc1
    buffer_load_dwordx4 v[84:87], v0, s[12:15], s92 offen offset:1024 sc1
    buffer_load_dwordx4 v[88:91], v0, s[12:15], s92 offen offset:2048 sc1
    buffer_load_dwordx4 v[92:95], v0, s[12:15], s92 offen offset:3072 sc1
    v_bfe_u32 v44, v0, 6, 1
    v_lshlrev_b32 v44, 4, v44
    v_mov_b32 v45, 0x3f80
    v_lshlrev_b32 v45, v44, v45
    v_bfe_u32 v44, v0, 4, 2
    v_cmp_eq_u32 vcc, 0, v44
    v_mov_b64 v[12:13], 0
    v_mov_b64 v[14:15], 0
    v_cndmask_b32 v32, 0, v45, vcc
    v_cmp_eq_u32 vcc, 1, v44
    v_mov_b64 v[16:17], 0
    v_mov_b64 v[18:19], 0
    v_cndmask_b32 v33, 0, v45, vcc
    v_cmp_eq_u32 vcc, 2, v44
    v_mov_b64 v[20:21], 0
    v_mov_b64 v[22:23], 0
    v_cndmask_b32 v34, 0, v45, vcc
    v_cmp_eq_u32 vcc, 3, v44
    v_mov_b64 v[24:25], 0
    v_mov_b64 v[26:27], 0
    v_cndmask_b32 v35, 0, v45, vcc
    v_mov_b64 v[28:29], 0
    v_mov_b64 v[30:31], 0
    v_mov_b32 v36, -1
    v_mov_b32 v37, -1
    v_mov_b32 v38, -1
    v_mov_b32 v39, -1
    ds_read_b128 v[56:59], v2 offset:32768
    ds_read_b128 v[60:63], v2 offset:33792
    ds_read_b128 v[72:75], v2 offset:34816
    ds_read_b128 v[76:79], v2 offset:35840
LS_p1:
    buffer_load_dwordx4 v[80:83], v0, s[12:15], s92 offen offset:0 sc1
    buffer_load_dwordx4 v[84:87], v0, s[12:15], s92 offen offset:1024 sc1
    buffer_load_dwordx4 v[88:91], v0, s[12:15], s92 offen offset:2048 sc1
    buffer_load_dwordx4 v[92:95], v0, s[12:15], s92 offen offset:3072 sc1
    s_mov_b64 exec, -1
    s_waitcnt vmcnt(7)
    v_max3_u32 v44, v80, v81, v82
    v_max_u32 v44, v44, v83
    v_mfma_f32_16x16x32_bf16 v[40:43], v[32:35], v[80:83], 0
    s_waitcnt vmcnt(6)
    v_max3_u32 v44, v44, v84, v85
    v_max3_u32 v44, v44, v86, v87
    v_mfma_f32_16x16x32_bf16 v[40:43], v[32:35], v[84:87], v[40:43]
    s_waitcnt vmcnt(5)
    v_max3_u32 v44, v44, v88, v89
    v_max3_u32 v44, v44, v90, v91
    v_mfma_f32_16x16x32_bf16 v[40:43], v[32:35], v[88:91], v[40:43]
    s_waitcnt vmcnt(4)
    v_max3_u32 v44, v44, v92, v93
    v_max3_u32 v44, v44, v94, v95
    v_mfma_f32_16x16x32_bf16 v[40:43], v[32:35], v[92:95], v[40:43]
    v_cmp_eq_u32 vcc, -1, v44
    s_nop 0
    s_cbranch_vccz LS_p1ok
    s_mov_b64 exec, vcc
    s_add_u32 s88, s88, 1
    s_cmp_gt_u32 s88, 4000000
    s_cbranch_scc0 LS_p1
    s_branch LC_fail
LS_p1ok:
    s_nop 4
    v_add_f32_dpp v40, v40, v40 row_ror:8 row_mask:0xf bank_mask:0xf
    v_add_f32_dpp v41, v41, v41 row_ror:8 row_mask:0xf bank_mask:0xf
    v_add_f32_dpp v42, v42, v42 row_ror:8 row_mask:0xf bank_mask:0xf
    v_add_f32_dpp v43, v43, v43 row_ror:8 row_mask:0xf bank_mask:0xf
    v_cvt_pk_bf16_f32 v44, v40, v41
    v_cvt_pk_bf16_f32 v45, v42, v43
    s_mov_b64 exec, 0x00ff00ff
    buffer_store_dwordx2 v[44:45], v11, s[12:15], s46 offen sc1
    buffer_store_dwordx2 v[44:45], v11, s[12:15], s51 offen sc1
    s_mov_b64 exec, -1
    s_barrier
    v_mov_b64 v[32:33], 0
    v_mov_b64 v[34:35], 0
    s_waitcnt vmcnt(4)
    v_lshrrev_b32 v86, 2, v3
    s_nop 3
    s_nop 3
    s_nop 3
    buffer_load_dwordx4 v[88:91], v3, s[12:15], s47 offen sc1
    buffer_load_dword v92, v86, s[12:15], s98 offen sc1
    s_add_u32 s32, s32, 1
    s_add_u32 s84, s84, 262144
    s_add_u32 s40, s84, 262144
    s_min_u32 s40, s40, 16515072
    s_add_u32 s41, s61, s40
    s_add_u32 s42, s41, 4096
    s_add_u32 s43, s62, s40
    s_and_b32 s85, s32, 1
    s_mul_i32 s85, s85, 163840
    s_add_u32 s44, s63, s84
    s_add_u32 s45, s64, s84
    s_add_u32 s20, s58, s85
    s_add_u32 s21, s20, 32768
    s_add_u32 s22, s20, 65536
    s_add_u32 s23, s20, 98304
    s_add_u32 s24, s20, 131072
    s_nop 3
    s_nop 3
    buffer_load_dwordx4 v[88:91], v3, s[12:15], s47 offen sc1
    buffer_load_dword v92, v86, s[12:15], s98 offen sc1
    s_nop 3
    s_nop 3
    s_nop 3
    s_nop 3
    s_nop 3
    s_nop 3
    buffer_load_dwordx4 v[88:91], v3, s[12:15], s47 offen sc1
    buffer_load_dword v92, v86, s[12:15], s98 offen sc1
    s_mov_b64 exec, 0xff
    buffer_store_dwordx4 v[36:39], v0, s[12:15], s96 offen sc1
    s_mov_b64 exec, -1
    buffer_store_dwordx4 v[36:39], v0, s[12:15], s92 offen offset:0 sc1
    buffer_store_dwordx4 v[36:39], v0, s[12:15], s92 offen offset:1024 sc1
    buffer_store_dwordx4 v[36:39], v0, s[12:15], s92 offen offset:2048 sc1
    buffer_store_dwordx4 v[36:39], v0, s[12:15], s92 offen offset:3072 sc1
    s_add_u32 s92, s55, s85
    s_add_u32 s96, s32, 3
    s_and_b32 s96, s96, 3
    s_mul_i32 s96, s96, 5120
    s_add_u32 s96, s96, s56
    s_waitcnt vmcnt(9)
    v_max3_u32 v44, v88, v89, v90
    v_max3_u32 v44, v44, v91, v92
    v_cmp_eq_u32 vcc, -1, v44
    s_nop 0
    s_cbranch_vccz LS_stage
    s_waitcnt vmcnt(7)
    v_max3_u32 v44, v88, v89, v90
    v_max3_u32 v44, v44, v91, v92
    v_cmp_eq_u32 vcc, -1, v44
    s_nop 0
    s_cbranch_vccz LS_stage
    s_waitcnt vmcnt(5)
    v_max3_u32 v44, v88, v89, v90
    v_max3_u32 v44, v44, v91, v92
    v_cmp_eq_u32 vcc, -1, v44
    s_nop 0
    s_cbranch_vccz LS_stage
    s_branch LS_p2r
LS_nored:
    v_mov_b64 v[12:13], 0
    v_mov_b64 v[14:15], 0
    v_mov_b64 v[16:17], 0
    v_mov_b64 v[18:19], 0
    v_mov_b64 v[20:21], 0
    v_mov_b64 v[22:23], 0
    v_mov_b64 v[24:25], 0
    v_mov_b64 v[26:27], 0
    v_mov_b64 v[28:29], 0
    v_mov_b64 v[30:31], 0
    v_mov_b64 v[32:33], 0
    v_mov_b64 v[34:35], 0
    ds_read_b128 v[56:59], v2 offset:32768
    ds_read_b128 v[60:63], v2 offset:33792
    ds_read_b128 v[72:75], v2 offset:34816
    ds_read_b128 v[76:79], v2 offset:35840
    v_lshrrev_b32 v86, 2, v3
    s_add_u32 s49, s32, 2
    s_min_u32 s49, s49, 63
    s_cmp_gt_u32 s50, s49
    s_cbranch_scc1 LS_nokv
    v_lshrrev_b32 v36, 2, v0
    v_min_u32 v36, 12, v36
    s_mov_b32 s34, 0
LS_kvw:
    buffer_load_dword v37, v36, s[8:11], 0 offen offset:64 sc1
    s_add_u32 s34, s34, 1
    s_cmp_gt_u32 s34, 2000000
    s_cbranch_scc1 LC_fail
    s_waitcnt vmcnt(0)
    v_cmp_gt_u32 vcc, 192, v37
    s_nop 0
    s_ff1_i32_b64 s35, vcc
    s_lshl_b32 s35, s35, 3
    s_lshr_b32 s50, 0x40120600, s35
    s_and_b32 s50, s50, 255
    s_cmp_gt_u32 s50, s49
    s_cbranch_scc1 LS_kvw_ok
    s_sleep 8
    s_branch LS_kvw
LS_kvw_ok:
LS_nokv:
    s_barrier
    s_nop 3
    s_nop 3
    s_nop 3
    s_nop 3
    buffer_load_dwordx4 v[88:91], v3, s[12:15], s47 offen sc1
    buffer_load_dword v92, v86, s[12:15], s98 offen sc1
    s_add_u32 s32, s32, 1
    s_add_u32 s84, s84, 262144
    s_add_u32 s40, s84, 262144
    s_min_u32 s40, s40, 16515072
    s_add_u32 s41, s61, s40
    s_add_u32 s42, s41, 4096
    s_add_u32 s43, s62, s40
    s_and_b32 s85, s32, 1
    s_mul_i32 s85, s85, 163840
    s_add_u32 s44, s63, s84
    s_add_u32 s45, s64, s84
    s_add_u32 s20, s58, s85
    s_add_u32 s21, s20, 32768
    s_add_u32 s22, s20, 65536
    s_add_u32 s23, s20, 98304
    s_add_u32 s24, s20, 131072
    s_nop 3
    s_nop 3
    buffer_load_dwordx4 v[88:91], v3, s[12:15], s47 offen sc1
    buffer_load_dword v92, v86, s[12:15], s98 offen sc1
    s_nop 3
    s_nop 3
    s_nop 3
    s_nop 3
    s_nop 3
    s_nop 3
    buffer_load_dwordx4 v[88:91], v3, s[12:15], s47 offen sc1
    buffer_load_dword v92, v86, s[12:15], s98 offen sc1
    s_waitcnt vmcnt(4)
    v_max3_u32 v44, v88, v89, v90
    v_max3_u32 v44, v44, v91, v92
    v_cmp_eq_u32 vcc, -1, v44
    s_nop 0
    s_cbranch_vccz LS_stage
    s_waitcnt vmcnt(2)
    v_max3_u32 v44, v88, v89, v90
    v_max3_u32 v44, v44, v91, v92
    v_cmp_eq_u32 vcc, -1, v44
    s_nop 0
    s_cbranch_vccz LS_stage
LS_p2:
    s_waitcnt vmcnt(0)
    v_max3_u32 v44, v88, v89, v90
    v_max3_u32 v44, v44, v91, v92
    v_cmp_eq_u32 vcc, -1, v44
    s_nop 0
    s_cbranch_vccz LS_stage
LS_p2r:
    s_mov_b64 exec, vcc
    buffer_load_dwordx4 v[88:91], v3, s[12:15], s47 offen sc1
    buffer_load_dword v92, v86, s[12:15], s98 offen sc1
    s_mov_b64 exec, -1
    s_add_u32 s89, s89, 1
    s_cmp_gt_u32 s89, 4000000
    s_cbranch_scc0 LS_p2
    s_branch LC_fail
LS_rretry:
    s_mov_b64 exec, vcc
    buffer_load_dwordx4 v[80:83], v3, s[12:15], s48 offen sc1
    buffer_load_dword v84, v86, s[12:15], s99 offen sc1
    s_mov_b64 exec, -1
    s_add_u32 s65, s65, 1
    s_cmp_gt_u32 s65, 4000000
    s_cbranch_scc1 LC_fail
LS_rchk:
    s_waitcnt vmcnt(1)
    v_max3_u32 v85, v80, v81, v82
    s_waitcnt vmcnt(0)
    v_max3_u32 v85, v85, v83, v84
    ds_write_b128 v3, v[80:83] offset:5120
    ds_write_b32 v86, v84 offset:9216
    v_cmp_eq_u32 vcc, -1, v85
    s_nop 0
    s_cbranch_vccnz LS_rretry
    s_branch LS_rok
LC_fail:
    s_mov_b64 exec, -1
    v_mov_b32 v16, 232
    v_mov_b32 v18, 0xdead
    v_mov_b32 v19, s32
    s_mov_b64 exec, 1
    buffer_store_dwordx2 v[18:19], v16, s[8:11], 0 offen
    s_endpgm
LC_done:
    v_mov_b32 v41, 64
    s_waitcnt vmcnt(0)
    s_barrier
    s_mov_b64 exec, 1
    buffer_store_dword v41, v0, s[12:15], s93 offen sc1
    s_mov_b64 exec, -1
LC_end:
    s_endpgm
.section .rodata,"a"
.p2align 6
.amdhsa_kernel gated_mix__memory_aug_recurrent_mem_tr__glu_gated_swiglu__prompt_kernel
  .amdhsa_next_free_vgpr 512
  .amdhsa_next_free_sgpr 102
  .amdhsa_accum_offset 256
  .amdhsa_group_segment_fixed_size 0
  .amdhsa_kernarg_size 120
  .amdhsa_user_sgpr_count 2
  .amdhsa_user_sgpr_kernarg_segment_ptr 1
  .amdhsa_system_sgpr_workgroup_id_x 1
  .amdhsa_float_denorm_mode_32 3
.end_amdhsa_kernel
```
